```python
import torch

def _softmax(x, axis=-1):
    return torch.softmax(x, dim=axis)
def _gelu(x):
    return torch.nn.functional.gelu(x, approximate="tanh")
def _silu(x):
    return torch.nn.functional.silu(x)
def _sigmoid(x):
    return torch.sigmoid(x)
def _layernorm(x, axis=-1, eps=1e-5):
    m = x.mean(dim=axis, keepdim=True)
    v = x.var(dim=axis, keepdim=True, unbiased=False)
    return (x - m) / torch.sqrt(v + eps)
def _scatter_add(tgt, idx, src, axis=0):
    return tgt.clone().index_add_(axis, idx, src)
def _segment_sum(src, seg, n):
    out = torch.zeros((n,) + src.shape[1:], dtype=src.dtype)
    return out.index_add_(0, seg, src)
def _pad(x, pw):
    flat = tuple(v for pair in reversed(pw) for v in pair)
    return torch.nn.functional.pad(x, flat)

kernel_name = 'parallel_sum__linear_kernel_hedgehog__glu_gated_glu__prompt'

def setup_inputs():

    _w = (lambda a: (lambda t: t.to(torch.bfloat16) if t.is_floating_point() else t)(torch.as_tensor(a)))
    def _A_setup():
        B, S, D, H = 1, 2048, 640, 32
        Dh = D // H
        return {
            "x": _w((lambda *s: torch.randn(*s, dtype=torch.bfloat16) * 0.05)(B, S, D)),
            "wqkv": _w((lambda *s: torch.randn(*s, dtype=torch.bfloat16) * 0.4)(D, 3 * D)),
            "w_phi": _w((lambda *s: torch.randn(*s, dtype=torch.bfloat16) * 0.4)(H, Dh, Dh) * (Dh ** -0.5)),
            "wo": _w((lambda *s: torch.randn(*s, dtype=torch.bfloat16) * 0.1)(D, D)),
        }
    _A_in = _A_setup()

    def _B_setup():
        B, S, D, F = 1, 2048, 640, 1536
        return {
            "x": _w((lambda *s: torch.randn(*s, dtype=torch.bfloat16) * 0.05)(B, S, D)),
            "w_gate": _w((lambda *s: torch.randn(*s, dtype=torch.bfloat16) * 0.05)(D, F)),
            "w_up": _w((lambda *s: torch.randn(*s, dtype=torch.bfloat16) * 0.05)(D, F)),
            "w_down": _w((lambda *s: torch.randn(*s, dtype=torch.bfloat16) * 0.05)(F, D)),
        }
    _B_in = _B_setup()

    return {
        "A_x": _A_in["x"],
        "A_wqkv": _A_in["wqkv"],
        "A_w_phi": _A_in["w_phi"],
        "A_wo": _A_in["wo"],
        "B_x": _B_in["x"],
        "B_w_gate": _B_in["w_gate"],
        "B_w_up": _B_in["w_up"],
        "B_w_down": _B_in["w_down"],
    }

def reference(A_x, A_wqkv, A_w_phi, A_wo, B_x, B_w_gate, B_w_up, B_w_down):
    def _A_ref(x, wqkv, w_phi, wo):
        B, S, D = x.shape
        H = 32; Dh = D // H
        qkv = (lambda x, *d: x.permute(*d))((x @ wqkv).reshape(B, S, 3, H, Dh), 2, 0, 3, 1, 4)
        q, k, v = qkv[0], qkv[1], qkv[2]
        pq = torch.einsum("bhsd,hdf->bhsf", q, w_phi)
        pk = torch.einsum("bhsd,hdf->bhsf", k, w_phi)
        phi_q = torch.concatenate([_softmax(pq, axis=-1), _softmax(-pq, axis=-1)], axis=-1)
        phi_k = torch.concatenate([_softmax(pk, axis=-1), _softmax(-pk, axis=-1)], axis=-1)
        kv = torch.einsum("bhsf,bhsd->bhfd", phi_k, v)
        z  = torch.einsum("bhsf->bhf", phi_k)
        num = torch.einsum("bhqf,bhfd->bhqd", phi_q, kv)
        den = torch.einsum("bhqf,bhf->bhq", phi_q, z)[..., None] + 1e-6
        o = num / den
        return (lambda x, *d: x.permute(*d))(o, 0, 2, 1, 3).reshape(B, S, D) @ wo

    def _B_ref(x, w_gate, w_up, w_down):
        g = torch.einsum("bsd,df->bsf", x, w_gate)
        u = torch.einsum("bsd,df->bsf", x, w_up)
        h = _sigmoid(g) * u
        return torch.einsum("bsf,fd->bsd", h, w_down)

    x = A_x
    xn = _layernorm(x, axis=-1)
    return x + _A_ref(xn, A_wqkv, A_w_phi, A_wo) + _B_ref(xn, B_w_gate, B_w_up, B_w_down)
```

```asm
; @launch grid=(256,1,1) block=(256,1,1) lds=163840
.amdgcn_target "amdgcn-amd-amdhsa--gfx950"
.text
.globl parallel_sum__linear_kernel_hedgehog__glu_gated_glu__prompt_kernel
.p2align 8
.type parallel_sum__linear_kernel_hedgehog__glu_gated_glu__prompt_kernel,@function
parallel_sum__linear_kernel_hedgehog__glu_gated_glu__prompt_kernel:
    s_cmp_ge_u32 s2, 256
    s_cbranch_scc1 L_end
    s_load_dwordx16 s[32:47], s[0:1], 0
    s_load_dwordx4 s[48:51], s[0:1], 64
    s_load_dwordx2 s[12:13], s[0:1], 80
    s_bitcmp1_b32 s2, 7
    s_cbranch_scc1 L_qkv
    v_lshrrev_b32 v68, 6, v0
    v_and_b32 v1, 63, v0
    v_readfirstlane_b32 s28, v68
    v_lshlrev_b32 v2, 4, v1
    s_and_b32 s3, s2, 7
    s_lshr_b32 s58, s2, 3
    s_and_b32 s29, s3, 1
    s_lshl_b32 s29, s29, 3
    s_and_b32 s59, s58, 7
    s_add_u32 s29, s29, s59
    s_and_b32 s30, s3, 6
    s_bfe_u32 s60, s2, 0x10006
    s_add_u32 s30, s30, s60
    s_lshl_b32 s31, s3, 2
    s_and_b32 s60, s58, 3
    s_add_u32 s31, s31, s60
    s_lshr_b32 s52, s58, 2
    s_lshl_b32 s60, s30, 1
    s_add_u32 s60, s60, s29
    s_mul_i32 s59, s60, 26
    s_lshr_b32 s59, s59, 8
    s_mul_i32 s59, s59, 10
    s_sub_u32 s53, s60, s59
    v_mov_b32 v15, 0x7f000000
    v_cmp_eq_u32 vcc, 0, v0
    v_accvgpr_write_b32 a255, 1
    v_lshrrev_b32 v68, 3, v1
    v_cndmask_b32 v15, v15, 0, vcc
    v_mul_u32_u24 v68, 1280, v68
    v_lshrrev_b32 v69, 4, v1
    v_and_b32 v70, 7, v1
    v_xor_b32 v69, v69, v70
    v_lshl_add_u32 v3, v69, 4, v68
    v_xor_b32 v69, 4, v69
    v_lshl_add_u32 v4, v69, 4, v68
    v_add_u32 v4, 9216, v4
    v_add_u32 v112, 18432, v3
    v_add_u32 v113, 18432, v4
    s_mov_b32 s6, 2621440
    s_mov_b32 s7, 0x20000
    s_mov_b32 s14, 16777216
    s_mov_b32 s15, 0x20000
    s_mov_b32 s18, 256
    s_mov_b32 s19, 0x20000
    s_mov_b32 s22, 2621440
    s_mov_b32 s23, 0x20000
    s_mov_b32 s11, 0x20000
    s_mov_b32 s27, 0x20000
    s_lshl_b32 s54, s29, 2
    s_add_u32 s54, s54, s28
    s_mul_i32 s64, s54, 139264
    s_add_u32 s64, s64, 1048576
    s_mul_i32 s54, s54, 40960
    s_lshl_b32 s62, s28, 14
    s_lshl_b32 s56, s53, 7
    s_add_u32 s56, s56, s54
    s_add_u32 s90, s54, 1280
    v_lshrrev_b32 v68, 3, v1
    v_mul_u32_u24 v68, 3072, v68
    v_bfe_u32 v69, v1, 4, 1
    s_and_b32 s58, s28, 2
    v_or_b32 v69, s58, v69
    v_lshlrev_b32 v69, 1, v69
    v_and_b32 v70, 7, v1
    v_xor_b32 v69, v69, v70
    v_lshl_add_u32 v5, v69, 4, v68
    s_and_b32 s55, s28, 1
    s_mul_i32 s55, s55, 98304
    s_mul_i32 s58, s30, 384
    s_add_u32 s55, s55, s58
    s_lshl_b32 s63, s28, 12
    v_add_u32 v10, 23552, v5
    v_add_u32 v11, 47104, v5
    v_add_u32 v12, 70656, v5
    s_mul_i32 s80, s53, 196608
    s_add_u32 s80, s80, s55
    s_add_u32 s91, s55, 1966080
    s_add_u32 s81, s80, 196608
    s_cmp_eq_u32 s81, s91
    s_cselect_b32 s81, s55, s81
    s_add_u32 s82, s81, 196608
    s_cmp_eq_u32 s82, s91
    s_cselect_b32 s82, s55, s82
    s_add_u32 s83, s82, 196608
    s_cmp_eq_u32 s83, s91
    s_cselect_b32 s83, s55, s83
    s_add_u32 s84, s83, 196608
    s_cmp_eq_u32 s84, s91
    s_cselect_b32 s84, s55, s84
    s_add_u32 s85, s84, 196608
    s_cmp_eq_u32 s85, s91
    s_cselect_b32 s85, s55, s85
    s_add_u32 s86, s85, 196608
    s_cmp_eq_u32 s86, s91
    s_cselect_b32 s86, s55, s86
    s_add_u32 s87, s86, 196608
    s_cmp_eq_u32 s87, s91
    s_cselect_b32 s87, s55, s87
    s_add_u32 s88, s87, 196608
    s_cmp_eq_u32 s88, s91
    s_cselect_b32 s88, s55, s88
    s_add_u32 s89, s88, 196608
    s_cmp_eq_u32 s89, s91
    s_cselect_b32 s89, s55, s89
    s_mov_b32 s10, 1966080
    s_waitcnt lgkmcnt(0)
    s_mov_b32 s4, s32
    s_mov_b32 s5, s33
    s_add_u32 m0, s62, 0
    s_nop 0
    buffer_load_dwordx4 v3, s[4:7], s56 offen offset:0 lds
    buffer_load_dwordx4 v4, s[4:7], s56 offen offset:1024 lds
    buffer_load_dwordx4 v112, s[4:7], s56 offen offset:2048 lds
    buffer_load_dwordx4 v113, s[4:7], s56 offen offset:3072 lds
    s_add_u32 s56, s56, 128
    s_cmp_eq_u32 s56, s90
    s_cselect_b32 s56, s54, s56
    s_cmp_lt_u32 s28, 2
    s_cselect_b32 s8, s42, s44
    s_cselect_b32 s9, s43, s45
    s_add_u32 m0, s63, 65536
    s_nop 0
    buffer_load_dwordx4 v5, s[8:11], s80 offen offset:0 lds
    buffer_load_dwordx4 v10, s[8:11], s80 offen offset:1024 lds
    buffer_load_dwordx4 v11, s[8:11], s80 offen offset:2048 lds
    buffer_load_dwordx4 v12, s[8:11], s80 offen offset:3072 lds
    s_mov_b32 s16, s50
    s_mov_b32 s17, s51
    s_mov_b32 s20, s48
    s_mov_b32 s21, s49
    s_lshl_b32 s32, s29, 3
    s_add_u32 s32, s32, s30
    s_lshl_b32 s32, s32, 2
    s_add_u32 s32, s32, s28
    s_add_u32 s33, s32, 512
    s_lshl_b32 s34, s29, 7
    s_lshl_b32 s35, s30, 2
    s_add_u32 s34, s34, s35
    s_add_u32 s34, s34, 9216
    s_add_u32 m0, s62, 4096
    s_nop 0
    buffer_load_dwordx4 v3, s[4:7], s56 offen offset:0 lds
    buffer_load_dwordx4 v4, s[4:7], s56 offen offset:1024 lds
    buffer_load_dwordx4 v112, s[4:7], s56 offen offset:2048 lds
    buffer_load_dwordx4 v113, s[4:7], s56 offen offset:3072 lds
    s_add_u32 s56, s56, 128
    s_cmp_eq_u32 s56, s90
    s_cselect_b32 s56, s54, s56
    s_add_u32 m0, s63, 81920
    s_nop 0
    buffer_load_dwordx4 v5, s[8:11], s81 offen offset:0 lds
    buffer_load_dwordx4 v10, s[8:11], s81 offen offset:1024 lds
    buffer_load_dwordx4 v11, s[8:11], s81 offen offset:2048 lds
    buffer_load_dwordx4 v12, s[8:11], s81 offen offset:3072 lds
    s_getpc_b64 s[48:49]
L_pcg:
    s_sub_u32 s48, s48, (L_pcg-parallel_sum__linear_kernel_hedgehog__glu_gated_glu__prompt_kernel)
    s_subb_u32 s49, s49, 0
    s_lshr_b32 s50, s2, 3
    s_lshl_b32 s50, s50, 2
    s_add_u32 s50, s50, s28
    s_lshl_b32 s50, s50, 10
    v_and_b32 v68, 7, v1
    v_lshl_add_u32 v68, v68, 7, s50
    v_min_u32 v68, (L_end-parallel_sum__linear_kernel_hedgehog__glu_gated_glu__prompt_kernel), v68
    global_load_dword a254, v68, s[48:49]
    v_lshrrev_b32 v68, 3, v1
    v_mul_u32_u24 v68, 1280, v68
    v_and_b32 v69, 7, v1
    v_lshl_add_u32 v108, v69, 4, v68
    v_lshrrev_b32 v68, 4, v1
    v_bfe_u32 v69, v1, 2, 2
    v_lshl_add_u32 v68, v68, 3, v69
    v_lshlrev_b32 v68, 7, v68
    v_and_b32 v69, 3, v1
    v_lshl_add_u32 v68, v69, 3, v68
    s_lshl_b32 s58, s28, 12
    s_add_u32 s58, s58, 147456
    v_add_u32 v109, s58, v68
    s_mul_i32 s51, s32, 6554
    s_lshr_b32 s51, s51, 16
    s_mul_i32 s43, s51, 10
    s_sub_u32 s43, s32, s43
    s_cmp_lt_u32 s51, 48
    s_cselect_b32 s40, s46, s38
    s_cselect_b32 s41, s47, s39
    s_mov_b32 s42, 819200
    s_cselect_b32 s42, 1966080, s42
    s_lshl_b32 s50, s51, 1
    s_bfe_u32 s48, s50, 0x30002
    s_mul_i32 s48, s48, 3
    s_lshr_b32 s3, s50, 5
    s_add_u32 s48, s48, s3
    s_lshl_b32 s48, s48, 2
    s_and_b32 s3, s50, 3
    s_add_u32 s48, s48, s3
    s_lshl_b32 s48, s48, 4
    s_sub_u32 s50, s50, 96
    s_max_i32 s50, s50, 0
    s_mul_i32 s3, s50, 52
    s_lshr_b32 s3, s3, 8
    s_mul_i32 s3, s3, 40
    s_lshl_b32 s50, s50, 3
    s_add_u32 s50, s50, s3
    s_cmp_lt_u32 s51, 48
    s_cselect_b32 s48, s48, s50
    s_cselect_b32 s49, 10240, s49
    s_mov_b32 s3, 51200
    s_cselect_b32 s49, s49, s3
    s_mul_i32 s48, s48, 1280
    s_lshl_b32 s3, s43, 7
    s_add_u32 s48, s48, s3
    s_sub_u32 s3, s48, 0
    v_add_u32 v88, s3, v108
    s_add_u32 s48, s48, s49
    s_sub_u32 s3, s48, 1024
    v_add_u32 v89, s3, v108
    s_lshl_b32 s50, s51, 1
    s_add_u32 s50, s50, 1
    s_bfe_u32 s48, s50, 0x30002
    s_mul_i32 s48, s48, 3
    s_lshr_b32 s3, s50, 5
    s_add_u32 s48, s48, s3
    s_lshl_b32 s48, s48, 2
    s_and_b32 s3, s50, 3
    s_add_u32 s48, s48, s3
    s_lshl_b32 s48, s48, 4
    s_sub_u32 s50, s50, 96
    s_max_i32 s50, s50, 0
    s_mul_i32 s3, s50, 52
    s_lshr_b32 s3, s3, 8
    s_mul_i32 s3, s3, 40
    s_lshl_b32 s50, s50, 3
    s_add_u32 s50, s50, s3
    s_cmp_lt_u32 s51, 48
    s_cselect_b32 s48, s48, s50
    s_cselect_b32 s49, 10240, s49
    s_mov_b32 s3, 51200
    s_cselect_b32 s49, s49, s3
    s_mul_i32 s48, s48, 1280
    s_lshl_b32 s3, s43, 7
    s_add_u32 s48, s48, s3
    s_sub_u32 s3, s48, 2048
    v_add_u32 v90, s3, v108
    s_add_u32 s48, s48, s49
    s_sub_u32 s3, s48, 3072
    v_add_u32 v91, s3, v108
    s_lshl_b32 s48, s43, 2
    s_mul_i32 s49, s48, 52
    s_lshr_b32 s49, s49, 8
    s_mul_i32 s49, s49, 335
    s_add_u32 s48, s48, s49
    s_mul_i32 s49, s51, 5
    s_add_u32 s48, s48, s49
    s_lshl_b32 s48, s48, 10
    s_add_u32 s48, s48, 12582912
    v_add_u32 v92, s48, v2
    s_lshl_b32 s48, s43, 2
    s_add_u32 s48, s48, 1
    s_mul_i32 s49, s48, 52
    s_lshr_b32 s49, s49, 8
    s_mul_i32 s49, s49, 335
    s_add_u32 s48, s48, s49
    s_mul_i32 s49, s51, 5
    s_add_u32 s48, s48, s49
    s_lshl_b32 s48, s48, 10
    s_add_u32 s48, s48, 12582912
    v_add_u32 v93, s48, v2
    s_lshl_b32 s48, s43, 2
    s_add_u32 s48, s48, 2
    s_mul_i32 s49, s48, 52
    s_lshr_b32 s49, s49, 8
    s_mul_i32 s49, s49, 335
    s_add_u32 s48, s48, s49
    s_mul_i32 s49, s51, 5
    s_add_u32 s48, s48, s49
    s_lshl_b32 s48, s48, 10
    s_add_u32 s48, s48, 12582912
    v_add_u32 v94, s48, v2
    s_lshl_b32 s48, s43, 2
    s_add_u32 s48, s48, 3
    s_mul_i32 s49, s48, 52
    s_lshr_b32 s49, s49, 8
    s_mul_i32 s49, s49, 335
    s_add_u32 s48, s48, s49
    s_mul_i32 s49, s51, 5
    s_add_u32 s48, s48, s49
    s_lshl_b32 s48, s48, 10
    s_add_u32 s48, s48, 12582912
    v_add_u32 v95, s48, v2
    s_mul_i32 s51, s33, 6554
    s_lshr_b32 s51, s51, 16
    s_mul_i32 s43, s51, 10
    s_sub_u32 s43, s33, s43
    s_lshl_b32 s50, s51, 1
    s_bfe_u32 s48, s50, 0x30002
    s_mul_i32 s48, s48, 3
    s_lshr_b32 s3, s50, 5
    s_add_u32 s48, s48, s3
    s_lshl_b32 s48, s48, 2
    s_and_b32 s3, s50, 3
    s_add_u32 s48, s48, s3
    s_lshl_b32 s48, s48, 4
    s_sub_u32 s50, s50, 96
    s_max_i32 s50, s50, 0
    s_mul_i32 s3, s50, 52
    s_lshr_b32 s3, s3, 8
    s_mul_i32 s3, s3, 40
    s_lshl_b32 s50, s50, 3
    s_add_u32 s50, s50, s3
    s_cmp_lt_u32 s51, 48
    s_cselect_b32 s48, s48, s50
    s_cselect_b32 s49, 10240, s49
    s_mov_b32 s3, 51200
    s_cselect_b32 s49, s49, s3
    s_mul_i32 s48, s48, 1280
    s_lshl_b32 s3, s43, 7
    s_add_u32 s48, s48, s3
    s_sub_u32 s3, s48, 0
    s_cmp_lt_u32 s33, 680
    s_cselect_b32 s3, s3, 0x7f000000
    v_add_u32 v96, s3, v108
    s_add_u32 s48, s48, s49
    s_sub_u32 s3, s48, 1024
    s_cmp_lt_u32 s33, 680
    s_cselect_b32 s3, s3, 0x7f000000
    v_add_u32 v97, s3, v108
    s_lshl_b32 s50, s51, 1
    s_add_u32 s50, s50, 1
    s_bfe_u32 s48, s50, 0x30002
    s_mul_i32 s48, s48, 3
    s_lshr_b32 s3, s50, 5
    s_add_u32 s48, s48, s3
    s_lshl_b32 s48, s48, 2
    s_and_b32 s3, s50, 3
    s_add_u32 s48, s48, s3
    s_lshl_b32 s48, s48, 4
    s_sub_u32 s50, s50, 96
    s_max_i32 s50, s50, 0
    s_mul_i32 s3, s50, 52
    s_lshr_b32 s3, s3, 8
    s_mul_i32 s3, s3, 40
    s_lshl_b32 s50, s50, 3
    s_add_u32 s50, s50, s3
    s_cmp_lt_u32 s51, 48
    s_cselect_b32 s48, s48, s50
    s_cselect_b32 s49, 10240, s49
    s_mov_b32 s3, 51200
    s_cselect_b32 s49, s49, s3
    s_mul_i32 s48, s48, 1280
    s_lshl_b32 s3, s43, 7
    s_add_u32 s48, s48, s3
    s_sub_u32 s3, s48, 2048
    s_cmp_lt_u32 s33, 680
    s_cselect_b32 s3, s3, 0x7f000000
    v_add_u32 v98, s3, v108
    s_add_u32 s48, s48, s49
    s_sub_u32 s3, s48, 3072
    s_cmp_lt_u32 s33, 680
    s_cselect_b32 s3, s3, 0x7f000000
    v_add_u32 v99, s3, v108
    s_lshl_b32 s48, s43, 2
    s_mul_i32 s49, s48, 52
    s_lshr_b32 s49, s49, 8
    s_mul_i32 s49, s49, 335
    s_add_u32 s48, s48, s49
    s_mul_i32 s49, s51, 5
    s_add_u32 s48, s48, s49
    s_lshl_b32 s48, s48, 10
    s_add_u32 s48, s48, 12582912
    s_cmp_lt_u32 s33, 680
    s_cselect_b32 s48, s48, 0x7f000000
    v_add_u32 v100, s48, v2
    s_lshl_b32 s48, s43, 2
    s_add_u32 s48, s48, 1
    s_mul_i32 s49, s48, 52
    s_lshr_b32 s49, s49, 8
    s_mul_i32 s49, s49, 335
    s_add_u32 s48, s48, s49
    s_mul_i32 s49, s51, 5
    s_add_u32 s48, s48, s49
    s_lshl_b32 s48, s48, 10
    s_add_u32 s48, s48, 12582912
    s_cmp_lt_u32 s33, 680
    s_cselect_b32 s48, s48, 0x7f000000
    v_add_u32 v101, s48, v2
    s_lshl_b32 s48, s43, 2
    s_add_u32 s48, s48, 2
    s_mul_i32 s49, s48, 52
    s_lshr_b32 s49, s49, 8
    s_mul_i32 s49, s49, 335
    s_add_u32 s48, s48, s49
    s_mul_i32 s49, s51, 5
    s_add_u32 s48, s48, s49
    s_lshl_b32 s48, s48, 10
    s_add_u32 s48, s48, 12582912
    s_cmp_lt_u32 s33, 680
    s_cselect_b32 s48, s48, 0x7f000000
    v_add_u32 v102, s48, v2
    s_lshl_b32 s48, s43, 2
    s_add_u32 s48, s48, 3
    s_mul_i32 s49, s48, 52
    s_lshr_b32 s49, s49, 8
    s_mul_i32 s49, s49, 335
    s_add_u32 s48, s48, s49
    s_mul_i32 s49, s51, 5
    s_add_u32 s48, s48, s49
    s_lshl_b32 s48, s48, 10
    s_add_u32 s48, s48, 12582912
    s_cmp_lt_u32 s33, 680
    s_cselect_b32 s48, s48, 0x7f000000
    v_add_u32 v103, s48, v2
    v_and_b32 v68, 31, v1
    v_bfe_u32 v69, v1, 1, 3
    v_lshrrev_b32 v70, 5, v1
    v_xor_b32 v69, v69, v70
    v_lshlrev_b32 v68, 7, v68
    v_add_u32 v68, s62, v68
    v_xor_b32 v70, 0, v69
    v_lshl_add_u32 v16, v70, 4, v68
    v_xor_b32 v70, 2, v69
    v_lshl_add_u32 v17, v70, 4, v68
    v_xor_b32 v70, 4, v69
    v_lshl_add_u32 v18, v70, 4, v68
    v_xor_b32 v70, 6, v69
    v_lshl_add_u32 v19, v70, 4, v68
    v_lshrrev_b32 v68, 4, v1
    v_xor_b32 v68, v68, v1
    v_and_b32 v68, 1, v68
    v_cmp_eq_u32 vcc, 0, v68
    v_mov_b32 v69, 0x3f803f80
    s_nop 0
    v_cndmask_b32 v36, 0, v69, vcc
    v_cndmask_b32 v37, 0, v69, vcc
    v_cndmask_b32 v38, 0, v69, vcc
    v_cndmask_b32 v39, 0, v69, vcc
    s_mov_b32 s96, 0x0000ffff
    s_mov_b32 s97, 0x0000ffff
    v_bfe_u32 v68, v1, 4, 1
    v_lshrrev_b32 v69, 5, v1
    v_bfe_u32 v70, v1, 2, 2
    v_lshl_add_u32 v69, v69, 3, v70
    v_lshlrev_b32 v69, 7, v69
    v_lshl_add_u32 v69, v68, 13, v69
    v_and_b32 v71, 1, v1
    v_bfe_u32 v72, v1, 1, 1
    v_lshl_add_u32 v71, v71, 1, v72
    v_lshl_add_u32 v69, v71, 3, v69
    v_add_u32 v69, 65536, v69
    v_lshrrev_b32 v70, 1, v70
    v_lshl_add_u32 v70, v68, 1, v70
    v_xor_b32 v70, s28, v70
    v_xor_b32 v71, 0, v70
    v_lshl_add_u32 v20, v71, 5, v69
    v_add_u32 v24, 0x10000, v20
    v_subrev_u32 v104, 0x10000, v20
    v_xor_b32 v71, 1, v70
    v_lshl_add_u32 v21, v71, 5, v69
    v_add_u32 v25, 0x10000, v21
    v_subrev_u32 v105, 0x10000, v21
    v_xor_b32 v71, 2, v70
    v_lshl_add_u32 v22, v71, 5, v69
    v_add_u32 v26, 0x10000, v22
    v_subrev_u32 v106, 0x10000, v22
    v_xor_b32 v71, 3, v70
    v_lshl_add_u32 v23, v71, 5, v69
    v_add_u32 v27, 0x10000, v23
    v_subrev_u32 v107, 0x10000, v23
    s_lshl_b32 s58, s30, 12
    s_add_u32 s64, s64, s58
    s_xor_b32 s70, s28, 0
    s_lshl_b32 s70, s70, 10
    s_add_u32 s70, s70, s64
    s_xor_b32 s71, s28, 1
    s_lshl_b32 s71, s71, 10
    s_add_u32 s71, s71, s64
    s_xor_b32 s72, s28, 2
    s_lshl_b32 s72, s72, 10
    s_add_u32 s72, s72, s64
    s_xor_b32 s73, s28, 3
    s_lshl_b32 s73, s73, 10
    s_add_u32 s73, s73, s64
    s_lshl_b32 s77, s29, 9
    s_lshl_b32 s58, s30, 2
    s_add_u32 s77, s77, s58
    s_add_u32 s60, s28, s52
    s_and_b32 s65, s60, 3
    s_mul_i32 s60, s52, 348160
    s_add_u32 s60, s60, 12582912
    s_mul_i32 s66, s65, 20480
    s_add_u32 s66, s66, s60
    s_add_u32 s67, s66, 81920
    s_add_u32 s68, s66, 163840
    s_mul_i32 s69, s65, 25600
    s_add_u32 s69, s69, s60
    s_add_u32 s69, s69, 245760
    s_lshl_b32 s92, s28, 10
    v_lshrrev_b32 v76, 4, v1
    v_and_b32 v77, 15, v1
    v_lshlrev_b32 v79, 9, v76
    v_lshl_add_u32 v79, v77, 4, v79
    s_add_u32 s60, s28, 0
    s_and_b32 s3, s60, 1
    s_lshl_b32 s3, s3, 8
    s_bfe_u32 s60, s60, 0x10001
    s_mul_i32 s60, s60, 139264
    s_add_u32 s60, s60, s3
    v_add_u32 v29, s60, v79
    s_add_u32 s60, s28, 1
    s_and_b32 s3, s60, 1
    s_lshl_b32 s3, s3, 8
    s_bfe_u32 s60, s60, 0x10001
    s_mul_i32 s60, s60, 139264
    s_add_u32 s60, s60, s3
    v_add_u32 v30, s60, v79
    s_add_u32 s60, s28, 2
    s_and_b32 s3, s60, 1
    s_lshl_b32 s3, s3, 8
    s_bfe_u32 s60, s60, 0x10001
    s_mul_i32 s60, s60, 139264
    s_add_u32 s60, s60, s3
    v_add_u32 v31, s60, v79
    s_add_u32 s60, s28, 3
    s_and_b32 s3, s60, 1
    s_lshl_b32 s3, s3, 8
    s_bfe_u32 s60, s60, 0x10001
    s_mul_i32 s60, s60, 139264
    s_add_u32 s60, s60, s3
    v_add_u32 v32, s60, v79
    v_and_b32 v6, 7, v1
    v_lshlrev_b32 v6, 2, v6
    s_lshr_b32 s57, s31, 1
    s_lshl_b32 s57, s57, 9
    v_mul_u32_u24 v9, 1280, v77
    v_lshl_add_u32 v9, v76, 3, v9
    s_lshl_b32 s76, s31, 2
    s_add_u32 s76, s76, s28
    s_mul_i32 s76, s76, 20480
    s_mul_i32 s60, s52, 160
    s_add_u32 s76, s76, s60
    s_mul_i32 s60, s31, 278528
    s_add_u32 s60, s60, 1048576
    s_lshl_b32 s44, s65, 13
    s_add_u32 s44, s44, s60
    s_mul_i32 s45, s65, 10240
    s_add_u32 s45, s45, s60
    s_add_u32 s45, s45, 98304
    v_min_u32 v110, 39, v1
    v_mul_u32_u24 v110, 3072, v110
    s_and_b32 s48, s29, 7
    s_lshl_b32 s48, s48, 1
    s_and_b32 s49, s28, 1
    s_add_u32 s48, s48, s49
    s_mul_i32 s48, s48, 122880
    s_mul_i32 s49, s30, 384
    s_add_u32 s48, s48, s49
    v_add_u32 v110, s48, v110
    v_and_b32 v35, 31, v1
    v_lshlrev_b32 v35, 2, v35
    v_add_u32 v68, 8192, v35
    s_cmp_lt_u32 s29, 10
    s_cselect_b32 s98, -1, 0
    s_mov_b32 s99, 0
    v_mov_b32 v28, 0x7f000000
    v_cndmask_b32 v28, v28, v35, s[98:99]
    s_cmp_lt_u32 s30, 5
    s_cselect_b32 s98, -1, 0
    s_mov_b32 s99, 0
    v_mov_b32 v13, 0x7f000000
    v_cndmask_b32 v13, v13, v35, s[98:99]
    s_cmp_lt_u32 s30, 5
    s_cselect_b32 s98, -1, 0
    s_mov_b32 s99, s98
    v_mov_b32 v14, 0x7f000000
    v_cndmask_b32 v14, v14, v68, s[98:99]
    s_cmp_lt_u32 s29, 10
    s_cselect_b32 s98, -1, 0
    s_mov_b32 s99, s98
    v_mov_b32 v33, 0x7f000000
    v_cndmask_b32 v33, v33, v15, s[98:99]
    s_cmp_lt_u32 s30, 5
    s_cselect_b32 s98, -1, 0
    s_mov_b32 s99, s98
    v_mov_b32 v7, 0x7f000000
    v_cndmask_b32 v7, v7, v15, s[98:99]
    s_mul_i32 s43, s30, 384
    s_add_u32 s43, s43, 180224
    s_lshl_b32 s78, s29, 7
    s_add_u32 s78, s78, 183296
    v_and_b32 v68, 15, v1
    v_lshlrev_b32 v68, 2, v68
    v_add_u32 v34, s43, v68
    v_add_u32 v68, s78, v68
    v_cndmask_b32 v34, v68, v34, s[96:97]
    s_lshl_b32 s58, s29, 2
    s_add_u32 s43, s43, s58
    s_lshl_b32 s59, s30, 2
    s_add_u32 s78, s78, s59
    s_add_u32 s37, s58, s28
    s_lshl_b32 s37, s37, 7
    s_add_u32 s37, s37, 163840
    s_mul_i32 s58, s30, 1536
    s_add_u32 s58, s58, 143360
    s_xor_b32 s48, s28, 0
    s_lshl_b32 s48, s48, 7
    s_add_u32 s48, s48, s58
    s_xor_b32 s49, s28, 1
    s_lshl_b32 s49, s49, 7
    s_add_u32 s49, s49, s58
    s_xor_b32 s50, s28, 2
    s_lshl_b32 s50, s50, 7
    s_add_u32 s50, s50, s58
    s_xor_b32 s51, s28, 3
    s_lshl_b32 s51, s51, 7
    s_add_u32 s51, s51, s58
    s_waitcnt vmcnt(9)
    s_barrier
    ds_read_b128 a[0:3], v16 offset:0
    ds_read_b128 a[4:7], v17 offset:0
    ds_read_b128 a[8:11], v18 offset:0
    ds_read_b128 a[12:15], v19 offset:0
    ds_read_b64_tr_b16 a[160:161], v20 offset:0
    ds_read_b64_tr_b16 a[162:163], v20 offset:512
    ds_read_b64_tr_b16 a[164:165], v21 offset:0
    ds_read_b64_tr_b16 a[166:167], v21 offset:512
    ds_read_b64_tr_b16 a[168:169], v22 offset:0
    ds_read_b64_tr_b16 a[170:171], v22 offset:512
    ds_read_b64_tr_b16 a[172:173], v23 offset:0
    ds_read_b64_tr_b16 a[174:175], v23 offset:512
    ds_read_b64_tr_b16 a[176:177], v20 offset:2048
    ds_read_b64_tr_b16 a[178:179], v20 offset:2560
    ds_read_b64_tr_b16 a[180:181], v21 offset:2048
    ds_read_b64_tr_b16 a[182:183], v21 offset:2560
    ds_read_b64_tr_b16 a[184:185], v22 offset:2048
    ds_read_b64_tr_b16 a[186:187], v22 offset:2560
    s_waitcnt lgkmcnt(10)
    v_mfma_f32_32x32x16_bf16 v[128:143], a[160:163], a[0:3], 0
    ds_read_b64_tr_b16 a[188:189], v23 offset:2048
    ds_read_b64_tr_b16 a[190:191], v23 offset:2560
    s_add_u32 m0, s62, 8192
    s_nop 0
    buffer_load_dwordx4 v3, s[4:7], s56 offen offset:0 lds
    v_mfma_f32_16x16x32_bf16 v[48:51], v[36:39], a[160:163], 0
    v_mfma_f32_32x32x16_bf16 v[144:159], a[164:167], a[0:3], 0
    ds_read_b64_tr_b16 a[192:193], v20 offset:4096
    ds_read_b64_tr_b16 a[194:195], v20 offset:4608
    buffer_load_dwordx4 v4, s[4:7], s56 offen offset:1024 lds
    v_mfma_f32_16x16x32_bf16 v[116:119], v[36:39], a[0:3], 0
    s_waitcnt lgkmcnt(10)
    v_mfma_f32_32x32x16_bf16 v[160:175], a[168:171], a[0:3], 0
    ds_read_b64_tr_b16 a[196:197], v21 offset:4096
    ds_read_b64_tr_b16 a[198:199], v21 offset:4608
    buffer_load_dwordx4 v112, s[4:7], s56 offen offset:2048 lds
    v_mfma_f32_4x4x4_16b_bf16 v[120:123], a[0:1], a[0:1], 0
    v_mfma_f32_32x32x16_bf16 v[176:191], a[172:175], a[0:3], 0
    ds_read_b64_tr_b16 a[160:161], v22 offset:4096
    ds_read_b64_tr_b16 a[162:163], v22 offset:4608
    buffer_load_dwordx4 v113, s[4:7], s56 offen offset:3072 lds
    v_mfma_f32_4x4x4_16b_bf16 v[124:127], a[2:3], a[2:3], 0
    s_waitcnt lgkmcnt(10)
    v_mfma_f32_32x32x16_bf16 v[128:143], a[176:179], a[4:7], v[128:143]
    ds_read_b64_tr_b16 a[164:165], v23 offset:4096
    ds_read_b64_tr_b16 a[166:167], v23 offset:4608
    s_add_u32 s56, s56, 128
    s_cmp_eq_u32 s56, s90
    s_cselect_b32 s56, s54, s56
    s_add_u32 m0, s63, 98304
    s_nop 0
    buffer_load_dwordx4 v5, s[8:11], s82 offen offset:0 lds
    v_mfma_f32_16x16x32_bf16 v[48:51], v[36:39], a[176:179], v[48:51]
    v_mfma_f32_32x32x16_bf16 v[144:159], a[180:183], a[4:7], v[144:159]
    ds_read_b64_tr_b16 a[168:169], v20 offset:6144
    ds_read_b64_tr_b16 a[170:171], v20 offset:6656
    buffer_load_dwordx4 v10, s[8:11], s82 offen offset:1024 lds
    v_mfma_f32_16x16x32_bf16 v[116:119], v[36:39], a[4:7], v[116:119]
    s_waitcnt lgkmcnt(10)
    v_mfma_f32_32x32x16_bf16 v[160:175], a[184:187], a[4:7], v[160:175]
    ds_read_b64_tr_b16 a[172:173], v21 offset:6144
    ds_read_b64_tr_b16 a[174:175], v21 offset:6656
    buffer_load_dwordx4 v11, s[8:11], s82 offen offset:2048 lds
    v_mfma_f32_4x4x4_16b_bf16 v[120:123], a[4:5], a[4:5], v[120:123]
    v_mfma_f32_32x32x16_bf16 v[176:191], a[188:191], a[4:7], v[176:191]
    ds_read_b64_tr_b16 a[176:177], v22 offset:6144
    ds_read_b64_tr_b16 a[178:179], v22 offset:6656
    buffer_load_dwordx4 v12, s[8:11], s82 offen offset:3072 lds
    v_mfma_f32_4x4x4_16b_bf16 v[124:127], a[6:7], a[6:7], v[124:127]
    s_waitcnt lgkmcnt(10)
    v_mfma_f32_32x32x16_bf16 v[128:143], a[192:195], a[8:11], v[128:143]
    ds_read_b64_tr_b16 a[180:181], v23 offset:6144
    ds_read_b64_tr_b16 a[182:183], v23 offset:6656
    s_add_u32 m0, s62, 12288
    s_nop 0
    buffer_load_dwordx4 v3, s[4:7], s56 offen offset:0 lds
    v_mfma_f32_16x16x32_bf16 v[48:51], v[36:39], a[192:195], v[48:51]
    v_mfma_f32_32x32x16_bf16 v[144:159], a[196:199], a[8:11], v[144:159]
    s_waitcnt vmcnt(10)
    s_barrier
    ds_read_b64_tr_b16 a[184:185], v20 offset:16384
    ds_read_b64_tr_b16 a[186:187], v20 offset:16896
    buffer_load_dwordx4 v4, s[4:7], s56 offen offset:1024 lds
    ds_read_b128 a[16:19], v16 offset:4096
    v_mfma_f32_16x16x32_bf16 v[116:119], v[36:39], a[8:11], v[116:119]
    s_waitcnt lgkmcnt(11)
    v_mfma_f32_32x32x16_bf16 v[160:175], a[160:163], a[8:11], v[160:175]
    ds_read_b64_tr_b16 a[188:189], v21 offset:16384
    ds_read_b64_tr_b16 a[190:191], v21 offset:16896
    buffer_load_dwordx4 v112, s[4:7], s56 offen offset:2048 lds
    ds_read_b128 a[20:23], v17 offset:4096
    v_mfma_f32_4x4x4_16b_bf16 v[120:123], a[8:9], a[8:9], v[120:123]
    v_mfma_f32_32x32x16_bf16 v[176:191], a[164:167], a[8:11], v[176:191]
    ds_read_b64_tr_b16 a[192:193], v22 offset:16384
    ds_read_b64_tr_b16 a[194:195], v22 offset:16896
    buffer_load_dwordx4 v113, s[4:7], s56 offen offset:3072 lds
    ds_read_b128 a[24:27], v18 offset:4096
    v_mfma_f32_4x4x4_16b_bf16 v[124:127], a[10:11], a[10:11], v[124:127]
    s_waitcnt lgkmcnt(13)
    v_mfma_f32_32x32x16_bf16 v[128:143], a[168:171], a[12:15], v[128:143]
    ds_read_b64_tr_b16 a[196:197], v23 offset:16384
    ds_read_b64_tr_b16 a[198:199], v23 offset:16896
    s_add_u32 s56, s56, 128
    s_cmp_eq_u32 s56, s90
    s_cselect_b32 s56, s54, s56
    s_add_u32 m0, s63, 114688
    s_nop 0
    buffer_load_dwordx4 v5, s[8:11], s83 offen offset:0 lds
    ds_read_b128 a[28:31], v19 offset:4096
    v_mfma_f32_16x16x32_bf16 v[48:51], v[36:39], a[168:171], v[48:51]
    v_mfma_f32_32x32x16_bf16 v[144:159], a[172:175], a[12:15], v[144:159]
    ds_read_b64_tr_b16 a[160:161], v20 offset:18432
    ds_read_b64_tr_b16 a[162:163], v20 offset:18944
    buffer_load_dwordx4 v10, s[8:11], s83 offen offset:1024 lds
    v_mfma_f32_16x16x32_bf16 v[116:119], v[36:39], a[12:15], v[116:119]
    s_waitcnt lgkmcnt(14)
    v_mfma_f32_32x32x16_bf16 v[160:175], a[176:179], a[12:15], v[160:175]
    ds_read_b64_tr_b16 a[164:165], v21 offset:18432
    ds_read_b64_tr_b16 a[166:167], v21 offset:18944
    buffer_load_dwordx4 v11, s[8:11], s83 offen offset:2048 lds
    v_mfma_f32_4x4x4_16b_bf16 v[120:123], a[12:13], a[12:13], v[120:123]
    v_mfma_f32_32x32x16_bf16 v[176:191], a[180:183], a[12:15], v[176:191]
    ds_read_b64_tr_b16 a[168:169], v22 offset:18432
    ds_read_b64_tr_b16 a[170:171], v22 offset:18944
    buffer_load_dwordx4 v12, s[8:11], s83 offen offset:3072 lds
    v_mfma_f32_4x4x4_16b_bf16 v[124:127], a[14:15], a[14:15], v[124:127]
    s_waitcnt lgkmcnt(13)
    v_mfma_f32_32x32x16_bf16 v[128:143], a[184:187], a[16:19], v[128:143]
    ds_read_b64_tr_b16 a[172:173], v23 offset:18432
    ds_read_b64_tr_b16 a[174:175], v23 offset:18944
    s_add_u32 m0, s62, 0
    s_nop 0
    buffer_load_dwordx4 v3, s[4:7], s56 offen offset:0 lds
    v_mfma_f32_32x32x16_bf16 v[144:159], a[188:191], a[16:19], v[144:159]
    ds_read_b64_tr_b16 a[176:177], v20 offset:20480
    ds_read_b64_tr_b16 a[178:179], v20 offset:20992
    buffer_load_dwordx4 v4, s[4:7], s56 offen offset:1024 lds
    v_mfma_f32_16x16x32_bf16 v[116:119], v[36:39], a[16:19], v[116:119]
    s_waitcnt lgkmcnt(11)
    v_mfma_f32_32x32x16_bf16 v[160:175], a[192:195], a[16:19], v[160:175]
    ds_read_b64_tr_b16 a[180:181], v21 offset:20480
    ds_read_b64_tr_b16 a[182:183], v21 offset:20992
    buffer_load_dwordx4 v112, s[4:7], s56 offen offset:2048 lds
    v_mfma_f32_4x4x4_16b_bf16 v[120:123], a[16:17], a[16:17], v[120:123]
    v_mfma_f32_32x32x16_bf16 v[176:191], a[196:199], a[16:19], v[176:191]
    ds_read_b64_tr_b16 a[184:185], v22 offset:20480
    ds_read_b64_tr_b16 a[186:187], v22 offset:20992
    buffer_load_dwordx4 v113, s[4:7], s56 offen offset:3072 lds
    v_mfma_f32_4x4x4_16b_bf16 v[124:127], a[18:19], a[18:19], v[124:127]
    s_waitcnt lgkmcnt(10)
    v_mfma_f32_32x32x16_bf16 v[128:143], a[160:163], a[20:23], v[128:143]
    ds_read_b64_tr_b16 a[188:189], v23 offset:20480
    ds_read_b64_tr_b16 a[190:191], v23 offset:20992
    s_add_u32 s56, s56, 128
    s_cmp_eq_u32 s56, s90
    s_cselect_b32 s56, s54, s56
    s_add_u32 m0, s63, 131072
    s_nop 0
    buffer_load_dwordx4 v5, s[8:11], s84 offen offset:0 lds
    v_mfma_f32_32x32x16_bf16 v[144:159], a[164:167], a[20:23], v[144:159]
    ds_read_b64_tr_b16 a[192:193], v20 offset:22528
    ds_read_b64_tr_b16 a[194:195], v20 offset:23040
    buffer_load_dwordx4 v10, s[8:11], s84 offen offset:1024 lds
    v_mfma_f32_16x16x32_bf16 v[116:119], v[36:39], a[20:23], v[116:119]
    s_waitcnt lgkmcnt(10)
    v_mfma_f32_32x32x16_bf16 v[160:175], a[168:171], a[20:23], v[160:175]
    ds_read_b64_tr_b16 a[196:197], v21 offset:22528
    ds_read_b64_tr_b16 a[198:199], v21 offset:23040
    buffer_load_dwordx4 v11, s[8:11], s84 offen offset:2048 lds
    v_mfma_f32_4x4x4_16b_bf16 v[120:123], a[20:21], a[20:21], v[120:123]
    v_mfma_f32_32x32x16_bf16 v[176:191], a[172:175], a[20:23], v[176:191]
    ds_read_b64_tr_b16 a[160:161], v22 offset:22528
    ds_read_b64_tr_b16 a[162:163], v22 offset:23040
    buffer_load_dwordx4 v12, s[8:11], s84 offen offset:3072 lds
    v_mfma_f32_4x4x4_16b_bf16 v[124:127], a[22:23], a[22:23], v[124:127]
    s_waitcnt lgkmcnt(10)
    v_mfma_f32_32x32x16_bf16 v[128:143], a[176:179], a[24:27], v[128:143]
    ds_read_b64_tr_b16 a[164:165], v23 offset:22528
    ds_read_b64_tr_b16 a[166:167], v23 offset:23040
    v_and_b32 v86, 15, v1
    v_lshlrev_b32 v86, 2, v86
    buffer_load_dword v84, v86, s[16:19], 0 offen sc1
    v_mfma_f32_32x32x16_bf16 v[144:159], a[180:183], a[24:27], v[144:159]
    s_waitcnt vmcnt(17)
    s_barrier
    ds_read_b64_tr_b16 a[168:169], v20 offset:32768
    ds_read_b64_tr_b16 a[170:171], v20 offset:33280
    ds_read_b128 a[32:35], v16 offset:8192
    v_mfma_f32_16x16x32_bf16 v[116:119], v[36:39], a[24:27], v[116:119]
    s_waitcnt lgkmcnt(11)
    v_mfma_f32_32x32x16_bf16 v[160:175], a[184:187], a[24:27], v[160:175]
    ds_read_b64_tr_b16 a[172:173], v21 offset:32768
    ds_read_b64_tr_b16 a[174:175], v21 offset:33280
    ds_read_b128 a[36:39], v17 offset:8192
    s_add_u32 m0, s62, 4096
    s_nop 0
    buffer_load_dwordx4 v3, s[4:7], s56 offen offset:0 lds
    v_mfma_f32_4x4x4_16b_bf16 v[120:123], a[24:25], a[24:25], v[120:123]
    v_mfma_f32_32x32x16_bf16 v[176:191], a[188:191], a[24:27], v[176:191]
    ds_read_b64_tr_b16 a[176:177], v22 offset:32768
    ds_read_b64_tr_b16 a[178:179], v22 offset:33280
    ds_read_b128 a[40:43], v18 offset:8192
    buffer_load_dwordx4 v4, s[4:7], s56 offen offset:1024 lds
    v_mfma_f32_4x4x4_16b_bf16 v[124:127], a[26:27], a[26:27], v[124:127]
    s_waitcnt lgkmcnt(13)
    v_mfma_f32_32x32x16_bf16 v[128:143], a[192:195], a[28:31], v[128:143]
    ds_read_b64_tr_b16 a[180:181], v23 offset:32768
    ds_read_b64_tr_b16 a[182:183], v23 offset:33280
    ds_read_b128 a[44:47], v19 offset:8192
    buffer_load_dwordx4 v112, s[4:7], s56 offen offset:2048 lds
    v_mfma_f32_32x32x16_bf16 v[144:159], a[196:199], a[28:31], v[144:159]
    ds_read_b64_tr_b16 a[184:185], v20 offset:34816
    ds_read_b64_tr_b16 a[186:187], v20 offset:35328
    buffer_load_dwordx4 v113, s[4:7], s56 offen offset:3072 lds
    v_mfma_f32_16x16x32_bf16 v[116:119], v[36:39], a[28:31], v[116:119]
    s_waitcnt lgkmcnt(14)
    v_mfma_f32_32x32x16_bf16 v[160:175], a[160:163], a[28:31], v[160:175]
    ds_read_b64_tr_b16 a[188:189], v21 offset:34816
    ds_read_b64_tr_b16 a[190:191], v21 offset:35328
    s_add_u32 s56, s56, 128
    s_cmp_eq_u32 s56, s90
    s_cselect_b32 s56, s54, s56
    s_add_u32 m0, s63, 65536
    s_nop 0
    buffer_load_dwordx4 v5, s[8:11], s85 offen offset:0 lds
    v_mfma_f32_4x4x4_16b_bf16 v[120:123], a[28:29], a[28:29], v[120:123]
    v_mfma_f32_32x32x16_bf16 v[176:191], a[164:167], a[28:31], v[176:191]
    ds_read_b64_tr_b16 a[192:193], v22 offset:34816
    ds_read_b64_tr_b16 a[194:195], v22 offset:35328
    buffer_load_dwordx4 v10, s[8:11], s85 offen offset:1024 lds
    v_mfma_f32_4x4x4_16b_bf16 v[124:127], a[30:31], a[30:31], v[124:127]
    s_waitcnt lgkmcnt(13)
    v_mfma_f32_32x32x16_bf16 v[128:143], a[168:171], a[32:35], v[128:143]
    ds_read_b64_tr_b16 a[196:197], v23 offset:34816
    ds_read_b64_tr_b16 a[198:199], v23 offset:35328
    buffer_load_dwordx4 v11, s[8:11], s85 offen offset:2048 lds
    v_mfma_f32_32x32x16_bf16 v[144:159], a[172:175], a[32:35], v[144:159]
    ds_read_b64_tr_b16 a[160:161], v20 offset:36864
    ds_read_b64_tr_b16 a[162:163], v20 offset:37376
    buffer_load_dwordx4 v12, s[8:11], s85 offen offset:3072 lds
    s_waitcnt lgkmcnt(11)
    v_mfma_f32_32x32x16_bf16 v[160:175], a[176:179], a[32:35], v[160:175]
    ds_read_b64_tr_b16 a[164:165], v21 offset:36864
    ds_read_b64_tr_b16 a[166:167], v21 offset:37376
    v_mfma_f32_32x32x16_bf16 v[176:191], a[180:183], a[32:35], v[176:191]
    ds_read_b64_tr_b16 a[168:169], v22 offset:36864
    ds_read_b64_tr_b16 a[170:171], v22 offset:37376
    s_waitcnt lgkmcnt(10)
    v_mfma_f32_32x32x16_bf16 v[128:143], a[184:187], a[36:39], v[128:143]
    ds_read_b64_tr_b16 a[172:173], v23 offset:36864
    ds_read_b64_tr_b16 a[174:175], v23 offset:37376
    v_mfma_f32_32x32x16_bf16 v[144:159], a[188:191], a[36:39], v[144:159]
    ds_read_b64_tr_b16 a[176:177], v20 offset:38912
    ds_read_b64_tr_b16 a[178:179], v20 offset:39424
    s_waitcnt lgkmcnt(10)
    v_mfma_f32_32x32x16_bf16 v[160:175], a[192:195], a[36:39], v[160:175]
    ds_read_b64_tr_b16 a[180:181], v21 offset:38912
    ds_read_b64_tr_b16 a[182:183], v21 offset:39424
    v_mfma_f32_32x32x16_bf16 v[176:191], a[196:199], a[36:39], v[176:191]
    ds_read_b64_tr_b16 a[184:185], v22 offset:38912
    ds_read_b64_tr_b16 a[186:187], v22 offset:39424
    s_waitcnt lgkmcnt(10)
    v_mfma_f32_32x32x16_bf16 v[128:143], a[160:163], a[40:43], v[128:143]
    ds_read_b64_tr_b16 a[188:189], v23 offset:38912
    ds_read_b64_tr_b16 a[190:191], v23 offset:39424
    v_mfma_f32_32x32x16_bf16 v[144:159], a[164:167], a[40:43], v[144:159]
    s_waitcnt vmcnt(17)
    s_barrier
    ds_read_b64_tr_b16 a[192:193], v20 offset:49152
    ds_read_b64_tr_b16 a[194:195], v20 offset:49664
    ds_read_b128 a[48:51], v16 offset:12288
    s_waitcnt lgkmcnt(11)
    v_mfma_f32_32x32x16_bf16 v[160:175], a[168:171], a[40:43], v[160:175]
    ds_read_b64_tr_b16 a[196:197], v21 offset:49152
    ds_read_b64_tr_b16 a[198:199], v21 offset:49664
    ds_read_b128 a[52:55], v17 offset:12288
    s_add_u32 m0, s62, 8192
    s_nop 0
    buffer_load_dwordx4 v3, s[4:7], s56 offen offset:0 lds
    v_mfma_f32_32x32x16_bf16 v[176:191], a[172:175], a[40:43], v[176:191]
    ds_read_b64_tr_b16 a[160:161], v22 offset:49152
    ds_read_b64_tr_b16 a[162:163], v22 offset:49664
    ds_read_b128 a[56:59], v18 offset:12288
    buffer_load_dwordx4 v4, s[4:7], s56 offen offset:1024 lds
    s_waitcnt lgkmcnt(13)
    v_mfma_f32_32x32x16_bf16 v[128:143], a[176:179], a[44:47], v[128:143]
    ds_read_b64_tr_b16 a[164:165], v23 offset:49152
    ds_read_b64_tr_b16 a[166:167], v23 offset:49664
    ds_read_b128 a[60:63], v19 offset:12288
    buffer_load_dwordx4 v112, s[4:7], s56 offen offset:2048 lds
    v_mfma_f32_32x32x16_bf16 v[144:159], a[180:183], a[44:47], v[144:159]
    ds_read_b64_tr_b16 a[168:169], v20 offset:51200
    ds_read_b64_tr_b16 a[170:171], v20 offset:51712
    buffer_load_dwordx4 v113, s[4:7], s56 offen offset:3072 lds
    s_waitcnt lgkmcnt(14)
    v_mfma_f32_32x32x16_bf16 v[160:175], a[184:187], a[44:47], v[160:175]
    ds_read_b64_tr_b16 a[172:173], v21 offset:51200
    ds_read_b64_tr_b16 a[174:175], v21 offset:51712
    s_add_u32 s56, s56, 128
    s_cmp_eq_u32 s56, s90
    s_cselect_b32 s56, s54, s56
    s_add_u32 m0, s63, 81920
    s_nop 0
    buffer_load_dwordx4 v5, s[8:11], s86 offen offset:0 lds
    v_mfma_f32_32x32x16_bf16 v[176:191], a[188:191], a[44:47], v[176:191]
    ds_read_b64_tr_b16 a[176:177], v22 offset:51200
    ds_read_b64_tr_b16 a[178:179], v22 offset:51712
    buffer_load_dwordx4 v10, s[8:11], s86 offen offset:1024 lds
    s_waitcnt lgkmcnt(13)
    v_mfma_f32_32x32x16_bf16 v[128:143], a[192:195], a[48:51], v[128:143]
    ds_read_b64_tr_b16 a[180:181], v23 offset:51200
    ds_read_b64_tr_b16 a[182:183], v23 offset:51712
    buffer_load_dwordx4 v11, s[8:11], s86 offen offset:2048 lds
    v_mfma_f32_32x32x16_bf16 v[144:159], a[196:199], a[48:51], v[144:159]
    ds_read_b64_tr_b16 a[184:185], v20 offset:53248
    ds_read_b64_tr_b16 a[186:187], v20 offset:53760
    buffer_load_dwordx4 v12, s[8:11], s86 offen offset:3072 lds
    s_waitcnt lgkmcnt(11)
    v_mfma_f32_32x32x16_bf16 v[160:175], a[160:163], a[48:51], v[160:175]
    ds_read_b64_tr_b16 a[188:189], v21 offset:53248
    ds_read_b64_tr_b16 a[190:191], v21 offset:53760
    s_mov_b32 s24, s40
    s_mov_b32 s25, s41
    s_mov_b32 s26, s42
    s_add_u32 m0, s63, 147456
    s_nop 0
    buffer_load_dwordx4 v88, s[24:27], 0 offen offset:0 lds
    v_mfma_f32_32x32x16_bf16 v[176:191], a[164:167], a[48:51], v[176:191]
    ds_read_b64_tr_b16 a[192:193], v22 offset:53248
    ds_read_b64_tr_b16 a[194:195], v22 offset:53760
    buffer_load_dwordx4 v89, s[24:27], 0 offen offset:1024 lds
    s_waitcnt lgkmcnt(10)
    v_mfma_f32_32x32x16_bf16 v[128:143], a[168:171], a[52:55], v[128:143]
    ds_read_b64_tr_b16 a[196:197], v23 offset:53248
    ds_read_b64_tr_b16 a[198:199], v23 offset:53760
    buffer_load_dwordx4 v90, s[24:27], 0 offen offset:2048 lds
    v_mfma_f32_32x32x16_bf16 v[144:159], a[172:175], a[52:55], v[144:159]
    ds_read_b64_tr_b16 a[160:161], v20 offset:55296
    ds_read_b64_tr_b16 a[162:163], v20 offset:55808
    buffer_load_dwordx4 v91, s[24:27], 0 offen offset:3072 lds
    s_waitcnt lgkmcnt(10)
    v_mfma_f32_32x32x16_bf16 v[160:175], a[176:179], a[52:55], v[160:175]
    ds_read_b64_tr_b16 a[164:165], v21 offset:55296
    ds_read_b64_tr_b16 a[166:167], v21 offset:55808
    s_waitcnt vmcnt(20)
    v_cmp_ne_u32 vcc, 1, v84
    s_nop 0
    s_and_b32 s58, vcc_lo, 0xffff
    s_cbranch_scc1 L_slow_ig
L_back_ig:
    v_cndmask_b32 v48, v49, v48, s[96:97]
    buffer_atomic_add_f32 v48, v28, s[12:15], s48 offen offset:0
    v_mfma_f32_32x32x16_bf16 v[176:191], a[180:183], a[52:55], v[176:191]
    ds_read_b64_tr_b16 a[168:169], v22 offset:55296
    ds_read_b64_tr_b16 a[170:171], v22 offset:55808
    v_cndmask_b32 v116, v117, v116, s[96:97]
    buffer_atomic_add_f32 v116, v13, s[12:15], s37 offen
    s_waitcnt lgkmcnt(10)
    v_mfma_f32_32x32x16_bf16 v[128:143], a[184:187], a[56:59], v[128:143]
    ds_read_b64_tr_b16 a[172:173], v23 offset:55296
    ds_read_b64_tr_b16 a[174:175], v23 offset:55808
    v_add_f32 v120, v120, v124
    v_add_f32 v121, v121, v125
    v_add_f32 v122, v122, v126
    v_add_f32 v123, v123, v127
    s_mov_b32 s98, 0xaaaaaaaa
    s_mov_b32 s99, 0xaaaaaaaa
    v_cndmask_b32 v120, v120, v121, s[98:99]
    v_cndmask_b32 v122, v122, v123, s[98:99]
    s_mov_b32 s98, 0xcccccccc
    s_mov_b32 s99, 0xcccccccc
    v_cndmask_b32 v120, v120, v122, s[98:99]
    buffer_atomic_add_f32 v120, v14, s[12:15], s37 offen
    v_mfma_f32_32x32x16_bf16 v[144:159], a[188:191], a[56:59], v[144:159]
    s_barrier
    ds_read_b64_tr_b16 a[176:177], v24 offset:0
    ds_read_b64_tr_b16 a[178:179], v24 offset:512
    ds_read_b128 a[64:67], v16 offset:0
    s_waitcnt lgkmcnt(11)
    v_mfma_f32_32x32x16_bf16 v[160:175], a[192:195], a[56:59], v[160:175]
    ds_read_b64_tr_b16 a[180:181], v25 offset:0
    ds_read_b64_tr_b16 a[182:183], v25 offset:512
    ds_read_b128 a[68:71], v17 offset:0
    s_add_u32 m0, s62, 12288
    s_nop 0
    buffer_load_dwordx4 v3, s[4:7], s56 offen offset:0 lds
    v_mfma_f32_32x32x16_bf16 v[176:191], a[196:199], a[56:59], v[176:191]
    ds_read_b64_tr_b16 a[184:185], v26 offset:0
    ds_read_b64_tr_b16 a[186:187], v26 offset:512
    ds_read_b128 a[72:75], v18 offset:0
    buffer_load_dwordx4 v4, s[4:7], s56 offen offset:1024 lds
    s_waitcnt lgkmcnt(13)
    v_mfma_f32_32x32x16_bf16 v[128:143], a[160:163], a[60:63], v[128:143]
    ds_read_b64_tr_b16 a[188:189], v27 offset:0
    ds_read_b64_tr_b16 a[190:191], v27 offset:512
    ds_read_b128 a[76:79], v19 offset:0
    buffer_load_dwordx4 v112, s[4:7], s56 offen offset:2048 lds
    v_mfma_f32_32x32x16_bf16 v[144:159], a[164:167], a[60:63], v[144:159]
    ds_read_b64_tr_b16 a[192:193], v24 offset:2048
    ds_read_b64_tr_b16 a[194:195], v24 offset:2560
    buffer_load_dwordx4 v113, s[4:7], s56 offen offset:3072 lds
    s_waitcnt lgkmcnt(14)
    v_mfma_f32_32x32x16_bf16 v[160:175], a[168:171], a[60:63], v[160:175]
    ds_read_b64_tr_b16 a[196:197], v25 offset:2048
    ds_read_b64_tr_b16 a[198:199], v25 offset:2560
    s_add_u32 s56, s56, 128
    s_cmp_eq_u32 s56, s90
    s_cselect_b32 s56, s54, s56
    s_add_u32 m0, s63, 98304
    s_nop 0
    buffer_load_dwordx4 v5, s[8:11], s87 offen offset:0 lds
    v_mfma_f32_32x32x16_bf16 v[176:191], a[172:175], a[60:63], v[176:191]
    ds_read_b64_tr_b16 a[160:161], v26 offset:2048
    ds_read_b64_tr_b16 a[162:163], v26 offset:2560
    buffer_load_dwordx4 v10, s[8:11], s87 offen offset:1024 lds
    s_waitcnt lgkmcnt(13)
    v_mfma_f32_32x32x16_bf16 v[128:143], a[176:179], a[64:67], v[128:143]
    ds_read_b64_tr_b16 a[164:165], v27 offset:2048
    ds_read_b64_tr_b16 a[166:167], v27 offset:2560
    buffer_load_dwordx4 v11, s[8:11], s87 offen offset:2048 lds
    v_mfma_f32_32x32x16_bf16 v[144:159], a[180:183], a[64:67], v[144:159]
    ds_read_b64_tr_b16 a[168:169], v24 offset:4096
    ds_read_b64_tr_b16 a[170:171], v24 offset:4608
    buffer_load_dwordx4 v12, s[8:11], s87 offen offset:3072 lds
    s_waitcnt lgkmcnt(11)
    v_mfma_f32_32x32x16_bf16 v[160:175], a[184:187], a[64:67], v[160:175]
    ds_read_b64_tr_b16 a[172:173], v25 offset:4096
    ds_read_b64_tr_b16 a[174:175], v25 offset:4608
    v_mfma_f32_32x32x16_bf16 v[176:191], a[188:191], a[64:67], v[176:191]
    ds_read_b64_tr_b16 a[176:177], v26 offset:4096
    ds_read_b64_tr_b16 a[178:179], v26 offset:4608
    s_waitcnt lgkmcnt(10)
    v_mfma_f32_32x32x16_bf16 v[128:143], a[192:195], a[68:71], v[128:143]
    ds_read_b64_tr_b16 a[180:181], v27 offset:4096
    ds_read_b64_tr_b16 a[182:183], v27 offset:4608
    v_mfma_f32_32x32x16_bf16 v[144:159], a[196:199], a[68:71], v[144:159]
    ds_read_b64_tr_b16 a[184:185], v24 offset:6144
    ds_read_b64_tr_b16 a[186:187], v24 offset:6656
    s_waitcnt lgkmcnt(10)
    v_mfma_f32_32x32x16_bf16 v[160:175], a[160:163], a[68:71], v[160:175]
    ds_read_b64_tr_b16 a[188:189], v25 offset:6144
    ds_read_b64_tr_b16 a[190:191], v25 offset:6656
    v_mfma_f32_32x32x16_bf16 v[176:191], a[164:167], a[68:71], v[176:191]
    ds_read_b64_tr_b16 a[192:193], v26 offset:6144
    ds_read_b64_tr_b16 a[194:195], v26 offset:6656
    s_waitcnt lgkmcnt(10)
    v_mfma_f32_32x32x16_bf16 v[128:143], a[168:171], a[72:75], v[128:143]
    ds_read_b64_tr_b16 a[196:197], v27 offset:6144
    ds_read_b64_tr_b16 a[198:199], v27 offset:6656
    v_mfma_f32_32x32x16_bf16 v[144:159], a[172:175], a[72:75], v[144:159]
    s_waitcnt vmcnt(8)
    s_barrier
    ds_read_b64_tr_b16 a[160:161], v20 offset:0
    ds_read_b64_tr_b16 a[162:163], v20 offset:512
    ds_read_b128 a[80:83], v16 offset:4096
    s_waitcnt lgkmcnt(11)
    v_mfma_f32_32x32x16_bf16 v[160:175], a[176:179], a[72:75], v[160:175]
    ds_read_b64_tr_b16 a[164:165], v21 offset:0
    ds_read_b64_tr_b16 a[166:167], v21 offset:512
    ds_read_b128 a[84:87], v17 offset:4096
    s_add_u32 m0, s62, 0
    s_nop 0
    buffer_load_dwordx4 v3, s[4:7], s56 offen offset:0 lds
    v_mfma_f32_32x32x16_bf16 v[176:191], a[180:183], a[72:75], v[176:191]
    ds_read_b64_tr_b16 a[168:169], v22 offset:0
    ds_read_b64_tr_b16 a[170:171], v22 offset:512
    ds_read_b128 a[88:91], v18 offset:4096
    buffer_load_dwordx4 v4, s[4:7], s56 offen offset:1024 lds
    s_waitcnt lgkmcnt(13)
    v_mfma_f32_32x32x16_bf16 v[128:143], a[184:187], a[76:79], v[128:143]
    ds_read_b64_tr_b16 a[172:173], v23 offset:0
    ds_read_b64_tr_b16 a[174:175], v23 offset:512
    ds_read_b128 a[92:95], v19 offset:4096
    buffer_load_dwordx4 v112, s[4:7], s56 offen offset:2048 lds
    v_mfma_f32_32x32x16_bf16 v[144:159], a[188:191], a[76:79], v[144:159]
    ds_read_b64_tr_b16 a[176:177], v20 offset:2048
    ds_read_b64_tr_b16 a[178:179], v20 offset:2560
    buffer_load_dwordx4 v113, s[4:7], s56 offen offset:3072 lds
    s_waitcnt lgkmcnt(14)
    v_mfma_f32_32x32x16_bf16 v[160:175], a[192:195], a[76:79], v[160:175]
    ds_read_b64_tr_b16 a[180:181], v21 offset:2048
    ds_read_b64_tr_b16 a[182:183], v21 offset:2560
    s_add_u32 s56, s56, 128
    s_cmp_eq_u32 s56, s90
    s_cselect_b32 s56, s54, s56
    s_add_u32 m0, s63, 114688
    s_nop 0
    buffer_load_dwordx4 v5, s[8:11], s88 offen offset:0 lds
    v_mfma_f32_32x32x16_bf16 v[176:191], a[196:199], a[76:79], v[176:191]
    ds_read_b64_tr_b16 a[184:185], v22 offset:2048
    ds_read_b64_tr_b16 a[186:187], v22 offset:2560
    buffer_load_dwordx4 v10, s[8:11], s88 offen offset:1024 lds
    s_waitcnt lgkmcnt(13)
    v_mfma_f32_32x32x16_bf16 v[128:143], a[160:163], a[80:83], v[128:143]
    ds_read_b64_tr_b16 a[188:189], v23 offset:2048
    ds_read_b64_tr_b16 a[190:191], v23 offset:2560
    buffer_load_dwordx4 v11, s[8:11], s88 offen offset:2048 lds
    v_mfma_f32_32x32x16_bf16 v[144:159], a[164:167], a[80:83], v[144:159]
    ds_read_b64_tr_b16 a[192:193], v20 offset:4096
    ds_read_b64_tr_b16 a[194:195], v20 offset:4608
    buffer_load_dwordx4 v12, s[8:11], s88 offen offset:3072 lds
    s_waitcnt lgkmcnt(11)
    v_mfma_f32_32x32x16_bf16 v[160:175], a[168:171], a[80:83], v[160:175]
    ds_read_b64_tr_b16 a[196:197], v21 offset:4096
    ds_read_b64_tr_b16 a[198:199], v21 offset:4608
    buffer_store_dword a255, v33, s[12:15], s43 offen offset:0 sc1
    v_mfma_f32_32x32x16_bf16 v[176:191], a[172:175], a[80:83], v[176:191]
    ds_read_b64_tr_b16 a[160:161], v22 offset:4096
    ds_read_b64_tr_b16 a[162:163], v22 offset:4608
    buffer_store_dword a255, v7, s[12:15], s78 offen sc1
    s_waitcnt lgkmcnt(10)
    v_mfma_f32_32x32x16_bf16 v[128:143], a[176:179], a[84:87], v[128:143]
    ds_read_b64_tr_b16 a[164:165], v23 offset:4096
    ds_read_b64_tr_b16 a[166:167], v23 offset:4608
    v_mfma_f32_32x32x16_bf16 v[144:159], a[180:183], a[84:87], v[144:159]
    ds_read_b64_tr_b16 a[168:169], v20 offset:6144
    ds_read_b64_tr_b16 a[170:171], v20 offset:6656
    s_waitcnt lgkmcnt(10)
    v_mfma_f32_32x32x16_bf16 v[160:175], a[184:187], a[84:87], v[160:175]
    ds_read_b64_tr_b16 a[172:173], v21 offset:6144
    ds_read_b64_tr_b16 a[174:175], v21 offset:6656
    v_mfma_f32_32x32x16_bf16 v[176:191], a[188:191], a[84:87], v[176:191]
    ds_read_b64_tr_b16 a[176:177], v22 offset:6144
    ds_read_b64_tr_b16 a[178:179], v22 offset:6656
    s_waitcnt lgkmcnt(10)
    v_mfma_f32_32x32x16_bf16 v[128:143], a[192:195], a[88:91], v[128:143]
    ds_read_b64_tr_b16 a[180:181], v23 offset:6144
    ds_read_b64_tr_b16 a[182:183], v23 offset:6656
    v_mfma_f32_32x32x16_bf16 v[144:159], a[196:199], a[88:91], v[144:159]
    s_barrier
    ds_read_b64_tr_b16 a[184:185], v20 offset:16384
    ds_read_b64_tr_b16 a[186:187], v20 offset:16896
    ds_read_b128 a[96:99], v16 offset:8192
    s_waitcnt lgkmcnt(11)
    v_mfma_f32_32x32x16_bf16 v[160:175], a[160:163], a[88:91], v[160:175]
    ds_read_b64_tr_b16 a[188:189], v21 offset:16384
    ds_read_b64_tr_b16 a[190:191], v21 offset:16896
    ds_read_b128 a[100:103], v17 offset:8192
    s_add_u32 m0, s62, 4096
    s_nop 0
    buffer_load_dwordx4 v3, s[4:7], s56 offen offset:0 lds
    v_mfma_f32_32x32x16_bf16 v[176:191], a[164:167], a[88:91], v[176:191]
    ds_read_b64_tr_b16 a[192:193], v22 offset:16384
    ds_read_b64_tr_b16 a[194:195], v22 offset:16896
    ds_read_b128 a[104:107], v18 offset:8192
    buffer_load_dwordx4 v4, s[4:7], s56 offen offset:1024 lds
    s_waitcnt lgkmcnt(13)
    v_mfma_f32_32x32x16_bf16 v[128:143], a[168:171], a[92:95], v[128:143]
    ds_read_b64_tr_b16 a[196:197], v23 offset:16384
    ds_read_b64_tr_b16 a[198:199], v23 offset:16896
    ds_read_b128 a[108:111], v19 offset:8192
    buffer_load_dwordx4 v112, s[4:7], s56 offen offset:2048 lds
    v_mfma_f32_32x32x16_bf16 v[144:159], a[172:175], a[92:95], v[144:159]
    ds_read_b64_tr_b16 a[160:161], v20 offset:18432
    ds_read_b64_tr_b16 a[162:163], v20 offset:18944
    buffer_load_dwordx4 v113, s[4:7], s56 offen offset:3072 lds
    s_waitcnt lgkmcnt(14)
    v_mfma_f32_32x32x16_bf16 v[160:175], a[176:179], a[92:95], v[160:175]
    ds_read_b64_tr_b16 a[164:165], v21 offset:18432
    ds_read_b64_tr_b16 a[166:167], v21 offset:18944
    s_add_u32 m0, s63, 131072
    s_nop 0
    buffer_load_dwordx4 v5, s[8:11], s89 offen offset:0 lds
    v_mfma_f32_32x32x16_bf16 v[176:191], a[180:183], a[92:95], v[176:191]
    ds_read_b64_tr_b16 a[168:169], v22 offset:18432
    ds_read_b64_tr_b16 a[170:171], v22 offset:18944
    buffer_load_dwordx4 v10, s[8:11], s89 offen offset:1024 lds
    s_waitcnt lgkmcnt(13)
    v_mfma_f32_32x32x16_bf16 v[128:143], a[184:187], a[96:99], v[128:143]
    ds_read_b64_tr_b16 a[172:173], v23 offset:18432
    ds_read_b64_tr_b16 a[174:175], v23 offset:18944
    buffer_load_dwordx4 v11, s[8:11], s89 offen offset:2048 lds
    v_mfma_f32_32x32x16_bf16 v[144:159], a[188:191], a[96:99], v[144:159]
    ds_read_b64_tr_b16 a[176:177], v20 offset:20480
    ds_read_b64_tr_b16 a[178:179], v20 offset:20992
    buffer_load_dwordx4 v12, s[8:11], s89 offen offset:3072 lds
    s_waitcnt lgkmcnt(11)
    v_mfma_f32_32x32x16_bf16 v[160:175], a[192:195], a[96:99], v[160:175]
    ds_read_b64_tr_b16 a[180:181], v21 offset:20480
    ds_read_b64_tr_b16 a[182:183], v21 offset:20992
    ds_read_b64_tr_b16 a[200:201], v109 offset:0
    ds_read_b64_tr_b16 a[202:203], v109 offset:512
    v_mfma_f32_32x32x16_bf16 v[176:191], a[196:199], a[96:99], v[176:191]
    ds_read_b64_tr_b16 a[184:185], v22 offset:20480
    ds_read_b64_tr_b16 a[186:187], v22 offset:20992
    ds_read_b64_tr_b16 a[204:205], v109 offset:32
    ds_read_b64_tr_b16 a[206:207], v109 offset:544
    s_waitcnt lgkmcnt(14)
    v_mfma_f32_32x32x16_bf16 v[128:143], a[160:163], a[100:103], v[128:143]
    ds_read_b64_tr_b16 a[188:189], v23 offset:20480
    ds_read_b64_tr_b16 a[190:191], v23 offset:20992
    ds_read_b64_tr_b16 a[208:209], v109 offset:64
    ds_read_b64_tr_b16 a[210:211], v109 offset:576
    v_mfma_f32_32x32x16_bf16 v[144:159], a[164:167], a[100:103], v[144:159]
    ds_read_b64_tr_b16 a[192:193], v20 offset:22528
    ds_read_b64_tr_b16 a[194:195], v20 offset:23040
    ds_read_b64_tr_b16 a[212:213], v109 offset:96
    ds_read_b64_tr_b16 a[214:215], v109 offset:608
    s_waitcnt lgkmcnt(15)
    v_mfma_f32_32x32x16_bf16 v[160:175], a[168:171], a[100:103], v[160:175]
    ds_read_b64_tr_b16 a[196:197], v21 offset:22528
    ds_read_b64_tr_b16 a[198:199], v21 offset:23040
    s_waitcnt lgkmcnt(14)
    buffer_store_dwordx4 a[200:203], v92, s[12:15], 0 offen sc1
    v_mfma_f32_32x32x16_bf16 v[176:191], a[172:175], a[100:103], v[176:191]
    ds_read_b64_tr_b16 a[160:161], v22 offset:22528
    ds_read_b64_tr_b16 a[162:163], v22 offset:23040
    s_waitcnt lgkmcnt(12)
    buffer_store_dwordx4 a[204:207], v93, s[12:15], 0 offen sc1
    v_mfma_f32_32x32x16_bf16 v[128:143], a[176:179], a[104:107], v[128:143]
    ds_read_b64_tr_b16 a[164:165], v23 offset:22528
    ds_read_b64_tr_b16 a[166:167], v23 offset:23040
    s_waitcnt lgkmcnt(10)
    buffer_store_dwordx4 a[208:211], v94, s[12:15], 0 offen sc1
    v_mfma_f32_32x32x16_bf16 v[144:159], a[180:183], a[104:107], v[144:159]
    s_waitcnt vmcnt(21)
    s_barrier
    ds_read_b64_tr_b16 a[168:169], v20 offset:32768
    ds_read_b64_tr_b16 a[170:171], v20 offset:33280
    s_waitcnt lgkmcnt(8)
    buffer_store_dwordx4 a[212:215], v95, s[12:15], 0 offen sc1
    ds_read_b128 a[112:115], v16 offset:12288
    v_mfma_f32_32x32x16_bf16 v[160:175], a[184:187], a[104:107], v[160:175]
    ds_read_b64_tr_b16 a[172:173], v21 offset:32768
    ds_read_b64_tr_b16 a[174:175], v21 offset:33280
    s_mov_b32 s24, s38
    s_mov_b32 s25, s39
    s_mov_b32 s26, 819200
    s_add_u32 m0, s63, 147456
    s_nop 0
    buffer_load_dwordx4 v96, s[24:27], 0 offen offset:0 lds
    ds_read_b128 a[116:119], v17 offset:12288
    v_mfma_f32_32x32x16_bf16 v[176:191], a[188:191], a[104:107], v[176:191]
    ds_read_b64_tr_b16 a[176:177], v22 offset:32768
    ds_read_b64_tr_b16 a[178:179], v22 offset:33280
    buffer_load_dwordx4 v97, s[24:27], 0 offen offset:1024 lds
    ds_read_b128 a[120:123], v18 offset:12288
    s_waitcnt lgkmcnt(13)
    v_mfma_f32_32x32x16_bf16 v[128:143], a[192:195], a[108:111], v[128:143]
    ds_read_b64_tr_b16 a[180:181], v23 offset:32768
    ds_read_b64_tr_b16 a[182:183], v23 offset:33280
    buffer_load_dwordx4 v98, s[24:27], 0 offen offset:2048 lds
    ds_read_b128 a[124:127], v19 offset:12288
    v_mfma_f32_32x32x16_bf16 v[144:159], a[196:199], a[108:111], v[144:159]
    ds_read_b64_tr_b16 a[184:185], v20 offset:34816
    ds_read_b64_tr_b16 a[186:187], v20 offset:35328
    buffer_load_dwordx4 v99, s[24:27], 0 offen offset:3072 lds
    s_mov_b32 s24, s12
    s_mov_b32 s25, s13
    s_waitcnt lgkmcnt(14)
    v_mfma_f32_32x32x16_bf16 v[160:175], a[160:163], a[108:111], v[160:175]
    ds_read_b64_tr_b16 a[188:189], v21 offset:34816
    ds_read_b64_tr_b16 a[190:191], v21 offset:35328
    s_add_u32 s8, s8, 128
    s_addc_u32 s9, s9, 0
    s_sub_u32 s10, s10, 128
    s_add_u32 m0, s63, 65536
    s_nop 0
    buffer_load_dwordx4 v5, s[8:11], s80 offen offset:0 lds
    v_mfma_f32_32x32x16_bf16 v[176:191], a[164:167], a[108:111], v[176:191]
    ds_read_b64_tr_b16 a[192:193], v22 offset:34816
    ds_read_b64_tr_b16 a[194:195], v22 offset:35328
    buffer_load_dwordx4 v10, s[8:11], s80 offen offset:1024 lds
    s_waitcnt lgkmcnt(13)
    v_mfma_f32_32x32x16_bf16 v[128:143], a[168:171], a[112:115], v[128:143]
    ds_read_b64_tr_b16 a[196:197], v23 offset:34816
    ds_read_b64_tr_b16 a[198:199], v23 offset:35328
    buffer_load_dwordx4 v11, s[8:11], s80 offen offset:2048 lds
    v_mfma_f32_32x32x16_bf16 v[144:159], a[172:175], a[112:115], v[144:159]
    ds_read_b64_tr_b16 a[160:161], v20 offset:36864
    ds_read_b64_tr_b16 a[162:163], v20 offset:37376
    buffer_load_dwordx4 v12, s[8:11], s80 offen offset:3072 lds
    s_waitcnt lgkmcnt(11)
    v_mfma_f32_32x32x16_bf16 v[160:175], a[176:179], a[112:115], v[160:175]
    ds_read_b64_tr_b16 a[164:165], v21 offset:36864
    ds_read_b64_tr_b16 a[166:167], v21 offset:37376
    v_mfma_f32_32x32x16_bf16 v[176:191], a[180:183], a[112:115], v[176:191]
    ds_read_b64_tr_b16 a[168:169], v22 offset:36864
    ds_read_b64_tr_b16 a[170:171], v22 offset:37376
    s_waitcnt lgkmcnt(10)
    v_mfma_f32_32x32x16_bf16 v[128:143], a[184:187], a[116:119], v[128:143]
    ds_read_b64_tr_b16 a[172:173], v23 offset:36864
    ds_read_b64_tr_b16 a[174:175], v23 offset:37376
    v_mfma_f32_32x32x16_bf16 v[144:159], a[188:191], a[116:119], v[144:159]
    ds_read_b64_tr_b16 a[176:177], v20 offset:38912
    ds_read_b64_tr_b16 a[178:179], v20 offset:39424
    s_waitcnt lgkmcnt(10)
    v_mfma_f32_32x32x16_bf16 v[160:175], a[192:195], a[116:119], v[160:175]
    ds_read_b64_tr_b16 a[180:181], v21 offset:38912
    ds_read_b64_tr_b16 a[182:183], v21 offset:39424
    v_mfma_f32_32x32x16_bf16 v[176:191], a[196:199], a[116:119], v[176:191]
    ds_read_b64_tr_b16 a[184:185], v22 offset:38912
    ds_read_b64_tr_b16 a[186:187], v22 offset:39424
    s_waitcnt lgkmcnt(10)
    v_mfma_f32_32x32x16_bf16 v[128:143], a[160:163], a[120:123], v[128:143]
    ds_read_b64_tr_b16 a[188:189], v23 offset:38912
    ds_read_b64_tr_b16 a[190:191], v23 offset:39424
    v_mfma_f32_32x32x16_bf16 v[144:159], a[164:167], a[120:123], v[144:159]
    s_waitcnt vmcnt(22)
    s_barrier
    ds_read_b64_tr_b16 a[192:193], v20 offset:49152
    ds_read_b64_tr_b16 a[194:195], v20 offset:49664
    ds_read_b128 a[128:131], v16 offset:0
    s_waitcnt lgkmcnt(11)
    v_mfma_f32_32x32x16_bf16 v[160:175], a[168:171], a[120:123], v[160:175]
    ds_read_b64_tr_b16 a[196:197], v21 offset:49152
    ds_read_b64_tr_b16 a[198:199], v21 offset:49664
    ds_read_b128 a[132:135], v17 offset:0
    s_add_u32 m0, s63, 81920
    s_nop 0
    buffer_load_dwordx4 v5, s[8:11], s81 offen offset:0 lds
    v_mfma_f32_32x32x16_bf16 v[176:191], a[172:175], a[120:123], v[176:191]
    ds_read_b64_tr_b16 a[160:161], v22 offset:49152
    ds_read_b64_tr_b16 a[162:163], v22 offset:49664
    ds_read_b128 a[136:139], v18 offset:0
    buffer_load_dwordx4 v10, s[8:11], s81 offen offset:1024 lds
    s_waitcnt lgkmcnt(13)
    v_mfma_f32_32x32x16_bf16 v[128:143], a[176:179], a[124:127], v[128:143]
    ds_read_b64_tr_b16 a[164:165], v23 offset:49152
    ds_read_b64_tr_b16 a[166:167], v23 offset:49664
    ds_read_b128 a[140:143], v19 offset:0
    buffer_load_dwordx4 v11, s[8:11], s81 offen offset:2048 lds
    v_mfma_f32_32x32x16_bf16 v[144:159], a[180:183], a[124:127], v[144:159]
    ds_read_b64_tr_b16 a[168:169], v20 offset:51200
    ds_read_b64_tr_b16 a[170:171], v20 offset:51712
    buffer_load_dwordx4 v12, s[8:11], s81 offen offset:3072 lds
    s_waitcnt lgkmcnt(14)
    v_mfma_f32_32x32x16_bf16 v[160:175], a[184:187], a[124:127], v[160:175]
    ds_read_b64_tr_b16 a[172:173], v21 offset:51200
    ds_read_b64_tr_b16 a[174:175], v21 offset:51712
    buffer_load_dword v75, v34, s[12:15], 0 offen offset:0 sc1
    v_mfma_f32_32x32x16_bf16 v[176:191], a[188:191], a[124:127], v[176:191]
    ds_read_b64_tr_b16 a[176:177], v22 offset:51200
    ds_read_b64_tr_b16 a[178:179], v22 offset:51712
    s_waitcnt lgkmcnt(13)
    v_mfma_f32_32x32x16_bf16 v[128:143], a[192:195], a[128:131], v[128:143]
    ds_read_b64_tr_b16 a[180:181], v23 offset:51200
    ds_read_b64_tr_b16 a[182:183], v23 offset:51712
    v_mfma_f32_32x32x16_bf16 v[144:159], a[196:199], a[128:131], v[144:159]
    ds_read_b64_tr_b16 a[184:185], v20 offset:53248
    ds_read_b64_tr_b16 a[186:187], v20 offset:53760
    s_waitcnt lgkmcnt(11)
    v_mfma_f32_32x32x16_bf16 v[160:175], a[160:163], a[128:131], v[160:175]
    ds_read_b64_tr_b16 a[188:189], v21 offset:53248
    ds_read_b64_tr_b16 a[190:191], v21 offset:53760
    v_mfma_f32_32x32x16_bf16 v[176:191], a[164:167], a[128:131], v[176:191]
    ds_read_b64_tr_b16 a[192:193], v22 offset:53248
    ds_read_b64_tr_b16 a[194:195], v22 offset:53760
    s_waitcnt lgkmcnt(10)
    v_mfma_f32_32x32x16_bf16 v[128:143], a[168:171], a[132:135], v[128:143]
    ds_read_b64_tr_b16 a[196:197], v23 offset:53248
    ds_read_b64_tr_b16 a[198:199], v23 offset:53760
    v_mfma_f32_32x32x16_bf16 v[144:159], a[172:175], a[132:135], v[144:159]
    ds_read_b64_tr_b16 a[160:161], v20 offset:55296
    ds_read_b64_tr_b16 a[162:163], v20 offset:55808
    s_waitcnt lgkmcnt(10)
    v_mfma_f32_32x32x16_bf16 v[160:175], a[176:179], a[132:135], v[160:175]
    ds_read_b64_tr_b16 a[164:165], v21 offset:55296
    ds_read_b64_tr_b16 a[166:167], v21 offset:55808
    v_mfma_f32_32x32x16_bf16 v[176:191], a[180:183], a[132:135], v[176:191]
    ds_read_b64_tr_b16 a[168:169], v22 offset:55296
    ds_read_b64_tr_b16 a[170:171], v22 offset:55808
    s_waitcnt lgkmcnt(10)
    v_mfma_f32_32x32x16_bf16 v[128:143], a[184:187], a[136:139], v[128:143]
    ds_read_b64_tr_b16 a[172:173], v23 offset:55296
    ds_read_b64_tr_b16 a[174:175], v23 offset:55808
    v_mfma_f32_32x32x16_bf16 v[144:159], a[188:191], a[136:139], v[144:159]
    s_waitcnt vmcnt(17)
    s_barrier
    ds_read_b64_tr_b16 a[176:177], v24 offset:0
    ds_read_b64_tr_b16 a[178:179], v24 offset:512
    ds_read_b128 a[144:147], v16 offset:4096
    s_waitcnt lgkmcnt(11)
    v_mfma_f32_32x32x16_bf16 v[160:175], a[192:195], a[136:139], v[160:175]
    ds_read_b64_tr_b16 a[180:181], v25 offset:0
    ds_read_b64_tr_b16 a[182:183], v25 offset:512
    ds_read_b128 a[148:151], v17 offset:4096
    s_add_u32 m0, s63, 98304
    s_nop 0
    buffer_load_dwordx4 v5, s[8:11], s82 offen offset:0 lds
    v_mfma_f32_32x32x16_bf16 v[176:191], a[196:199], a[136:139], v[176:191]
    ds_read_b64_tr_b16 a[184:185], v26 offset:0
    ds_read_b64_tr_b16 a[186:187], v26 offset:512
    ds_read_b128 a[152:155], v18 offset:4096
    buffer_load_dwordx4 v10, s[8:11], s82 offen offset:1024 lds
    s_waitcnt lgkmcnt(13)
    v_mfma_f32_32x32x16_bf16 v[128:143], a[160:163], a[140:143], v[128:143]
    ds_read_b64_tr_b16 a[188:189], v27 offset:0
    ds_read_b64_tr_b16 a[190:191], v27 offset:512
    ds_read_b128 a[156:159], v19 offset:4096
    buffer_load_dwordx4 v11, s[8:11], s82 offen offset:2048 lds
    v_mfma_f32_32x32x16_bf16 v[144:159], a[164:167], a[140:143], v[144:159]
    ds_read_b64_tr_b16 a[192:193], v24 offset:2048
    ds_read_b64_tr_b16 a[194:195], v24 offset:2560
    buffer_load_dwordx4 v12, s[8:11], s82 offen offset:3072 lds
    s_waitcnt lgkmcnt(14)
    v_mfma_f32_32x32x16_bf16 v[160:175], a[168:171], a[140:143], v[160:175]
    ds_read_b64_tr_b16 a[196:197], v25 offset:2048
    ds_read_b64_tr_b16 a[198:199], v25 offset:2560
    s_waitcnt vmcnt(13)
    ds_read_b64_tr_b16 a[200:201], v109 offset:0
    ds_read_b64_tr_b16 a[202:203], v109 offset:512
    v_mfma_f32_32x32x16_bf16 v[176:191], a[172:175], a[140:143], v[176:191]
    ds_read_b64_tr_b16 a[160:161], v26 offset:2048
    ds_read_b64_tr_b16 a[162:163], v26 offset:2560
    ds_read_b64_tr_b16 a[204:205], v109 offset:32
    ds_read_b64_tr_b16 a[206:207], v109 offset:544
    s_waitcnt lgkmcnt(15)
    v_mfma_f32_32x32x16_bf16 v[128:143], a[176:179], a[144:147], v[128:143]
    ds_read_b64_tr_b16 a[164:165], v27 offset:2048
    ds_read_b64_tr_b16 a[166:167], v27 offset:2560
    ds_read_b64_tr_b16 a[208:209], v109 offset:64
    ds_read_b64_tr_b16 a[210:211], v109 offset:576
    v_mfma_f32_32x32x16_bf16 v[144:159], a[180:183], a[144:147], v[144:159]
    ds_read_b64_tr_b16 a[168:169], v24 offset:4096
    ds_read_b64_tr_b16 a[170:171], v24 offset:4608
    ds_read_b64_tr_b16 a[212:213], v109 offset:96
    ds_read_b64_tr_b16 a[214:215], v109 offset:608
    s_waitcnt lgkmcnt(15)
    v_mfma_f32_32x32x16_bf16 v[160:175], a[184:187], a[144:147], v[160:175]
    ds_read_b64_tr_b16 a[172:173], v25 offset:4096
    ds_read_b64_tr_b16 a[174:175], v25 offset:4608
    s_waitcnt lgkmcnt(14)
    buffer_store_dwordx4 a[200:203], v100, s[12:15], 0 offen sc1
    v_mfma_f32_32x32x16_bf16 v[176:191], a[188:191], a[144:147], v[176:191]
    ds_read_b64_tr_b16 a[176:177], v26 offset:4096
    ds_read_b64_tr_b16 a[178:179], v26 offset:4608
    s_waitcnt lgkmcnt(12)
    buffer_store_dwordx4 a[204:207], v101, s[12:15], 0 offen sc1
    v_mfma_f32_32x32x16_bf16 v[128:143], a[192:195], a[148:151], v[128:143]
    ds_read_b64_tr_b16 a[180:181], v27 offset:4096
    ds_read_b64_tr_b16 a[182:183], v27 offset:4608
    s_waitcnt lgkmcnt(10)
    buffer_store_dwordx4 a[208:211], v102, s[12:15], 0 offen sc1
    v_mfma_f32_32x32x16_bf16 v[144:159], a[196:199], a[148:151], v[144:159]
    ds_read_b64_tr_b16 a[184:185], v24 offset:6144
    ds_read_b64_tr_b16 a[186:187], v24 offset:6656
    s_waitcnt lgkmcnt(8)
    buffer_store_dwordx4 a[212:215], v103, s[12:15], 0 offen sc1
    v_mfma_f32_32x32x16_bf16 v[160:175], a[160:163], a[148:151], v[160:175]
    ds_read_b64_tr_b16 a[188:189], v25 offset:6144
    ds_read_b64_tr_b16 a[190:191], v25 offset:6656
    v_mfma_f32_32x32x16_bf16 v[176:191], a[164:167], a[148:151], v[176:191]
    ds_read_b64_tr_b16 a[192:193], v26 offset:6144
    ds_read_b64_tr_b16 a[194:195], v26 offset:6656
    s_waitcnt lgkmcnt(10)
    v_mfma_f32_32x32x16_bf16 v[128:143], a[168:171], a[152:155], v[128:143]
    ds_read_b64_tr_b16 a[196:197], v27 offset:6144
    ds_read_b64_tr_b16 a[198:199], v27 offset:6656
    v_mfma_f32_32x32x16_bf16 v[144:159], a[172:175], a[152:155], v[144:159]
    s_waitcnt vmcnt(13)
    s_barrier
    ds_read_b64_tr_b16 a[160:161], v20 offset:0
    ds_read_b64_tr_b16 a[162:163], v20 offset:512
    s_add_u32 m0, s63, 16384
    s_nop 0
    buffer_load_dwordx4 v5, s[8:11], s83 offen offset:0 lds
    s_waitcnt lgkmcnt(10)
    v_mfma_f32_32x32x16_bf16 v[160:175], a[176:179], a[152:155], v[160:175]
    ds_read_b64_tr_b16 a[164:165], v21 offset:0
    ds_read_b64_tr_b16 a[166:167], v21 offset:512
    buffer_load_dwordx4 v10, s[8:11], s83 offen offset:1024 lds
    v_mfma_f32_32x32x16_bf16 v[176:191], a[180:183], a[152:155], v[176:191]
    ds_read_b64_tr_b16 a[168:169], v22 offset:0
    ds_read_b64_tr_b16 a[170:171], v22 offset:512
    buffer_load_dwordx4 v11, s[8:11], s83 offen offset:2048 lds
    s_waitcnt lgkmcnt(10)
    v_mfma_f32_32x32x16_bf16 v[128:143], a[184:187], a[156:159], v[128:143]
    ds_read_b64_tr_b16 a[172:173], v23 offset:0
    ds_read_b64_tr_b16 a[174:175], v23 offset:512
    buffer_load_dwordx4 v12, s[8:11], s83 offen offset:3072 lds
    v_mfma_f32_32x32x16_bf16 v[144:159], a[188:191], a[156:159], v[144:159]
    ds_read_b64_tr_b16 a[176:177], v20 offset:2048
    ds_read_b64_tr_b16 a[178:179], v20 offset:2560
    s_waitcnt lgkmcnt(10)
    v_mfma_f32_32x32x16_bf16 v[160:175], a[192:195], a[156:159], v[160:175]
    ds_read_b64_tr_b16 a[180:181], v21 offset:2048
    ds_read_b64_tr_b16 a[182:183], v21 offset:2560
    s_add_u32 m0, s63, 32768
    s_nop 0
    buffer_load_dwordx4 v5, s[8:11], s84 offen offset:0 lds
    v_mfma_f32_32x32x16_bf16 v[176:191], a[196:199], a[156:159], v[176:191]
    ds_read_b64_tr_b16 a[184:185], v22 offset:2048
    ds_read_b64_tr_b16 a[186:187], v22 offset:2560
    buffer_load_dwordx4 v10, s[8:11], s84 offen offset:1024 lds
    s_waitcnt lgkmcnt(10)
    v_mfma_f32_32x32x16_bf16 v[192:207], a[160:163], a[0:3], 0
    ds_read_b64_tr_b16 a[188:189], v23 offset:2048
    ds_read_b64_tr_b16 a[190:191], v23 offset:2560
    buffer_load_dwordx4 v11, s[8:11], s84 offen offset:2048 lds
    v_mfma_f32_16x16x32_bf16 v[48:51], v[36:39], a[160:163], 0
    v_mfma_f32_32x32x16_bf16 v[208:223], a[164:167], a[0:3], 0
    ds_read_b64_tr_b16 a[192:193], v20 offset:4096
    ds_read_b64_tr_b16 a[194:195], v20 offset:4608
    s_waitcnt lgkmcnt(10)
    v_mfma_f32_32x32x16_bf16 v[224:239], a[168:171], a[0:3], 0
    ds_read_b64_tr_b16 a[196:197], v21 offset:4096
    ds_read_b64_tr_b16 a[198:199], v21 offset:4608
    buffer_load_dwordx4 v12, s[8:11], s84 offen offset:3072 lds
    v_mfma_f32_32x32x16_bf16 v[240:255], a[172:175], a[0:3], 0
    ds_read_b64_tr_b16 a[160:161], v22 offset:4096
    ds_read_b64_tr_b16 a[162:163], v22 offset:4608
    s_waitcnt vmcnt(16)
    v_cmp_ne_u32 vcc, 1, v75
    s_nop 0
    s_and_b32 s58, vcc_lo, 0x1f03ff
    s_cbranch_scc1 L_slow_cs0g
L_back_cs0g:
    buffer_load_dword v68, v35, s[12:15], s48 offen offset:0 sc1
    s_waitcnt lgkmcnt(10)
    v_mfma_f32_32x32x16_bf16 v[192:207], a[176:179], a[4:7], v[192:207]
    ds_read_b64_tr_b16 a[164:165], v23 offset:4096
    ds_read_b64_tr_b16 a[166:167], v23 offset:4608
    buffer_load_dword v69, v35, s[12:15], s49 offen offset:0 sc1
    v_mfma_f32_16x16x32_bf16 v[48:51], v[36:39], a[176:179], v[48:51]
    v_mfma_f32_32x32x16_bf16 v[208:223], a[180:183], a[4:7], v[208:223]
    ds_read_b64_tr_b16 a[168:169], v20 offset:6144
    ds_read_b64_tr_b16 a[170:171], v20 offset:6656
    s_waitcnt lgkmcnt(10)
    v_mfma_f32_32x32x16_bf16 v[224:239], a[184:187], a[4:7], v[224:239]
    ds_read_b64_tr_b16 a[172:173], v21 offset:6144
    ds_read_b64_tr_b16 a[174:175], v21 offset:6656
    buffer_load_dword v70, v35, s[12:15], s50 offen offset:0 sc1
    v_mfma_f32_32x32x16_bf16 v[240:255], a[188:191], a[4:7], v[240:255]
    ds_read_b64_tr_b16 a[176:177], v22 offset:6144
    ds_read_b64_tr_b16 a[178:179], v22 offset:6656
    buffer_load_dword v71, v35, s[12:15], s51 offen offset:0 sc1
    s_waitcnt lgkmcnt(10)
    v_mfma_f32_32x32x16_bf16 v[192:207], a[192:195], a[8:11], v[192:207]
    ds_read_b64_tr_b16 a[180:181], v23 offset:6144
    ds_read_b64_tr_b16 a[182:183], v23 offset:6656
    buffer_load_dword v116, v35, s[12:15], s37 offen sc1
    v_mfma_f32_16x16x32_bf16 v[48:51], v[36:39], a[192:195], v[48:51]
    v_mfma_f32_32x32x16_bf16 v[208:223], a[196:199], a[8:11], v[208:223]
    s_waitcnt vmcnt(13)
    s_barrier
    ds_read_b64_tr_b16 a[184:185], v20 offset:16384
    ds_read_b64_tr_b16 a[186:187], v20 offset:16896
    s_waitcnt lgkmcnt(10)
    v_mfma_f32_32x32x16_bf16 v[224:239], a[160:163], a[8:11], v[224:239]
    ds_read_b64_tr_b16 a[188:189], v21 offset:16384
    ds_read_b64_tr_b16 a[190:191], v21 offset:16896
    s_add_u32 s37, s37, 8192
    buffer_load_dword v117, v35, s[12:15], s37 offen sc1
    v_mfma_f32_32x32x16_bf16 v[240:255], a[164:167], a[8:11], v[240:255]
    ds_read_b64_tr_b16 a[192:193], v22 offset:16384
    ds_read_b64_tr_b16 a[194:195], v22 offset:16896
    s_add_u32 m0, s63, 49152
    s_nop 0
    buffer_load_dwordx4 v5, s[8:11], s85 offen offset:0 lds
    s_waitcnt lgkmcnt(10)
    v_mfma_f32_32x32x16_bf16 v[192:207], a[168:171], a[12:15], v[192:207]
    ds_read_b64_tr_b16 a[196:197], v23 offset:16384
    ds_read_b64_tr_b16 a[198:199], v23 offset:16896
    buffer_load_dwordx4 v10, s[8:11], s85 offen offset:1024 lds
    v_mfma_f32_16x16x32_bf16 v[48:51], v[36:39], a[168:171], v[48:51]
    v_mfma_f32_32x32x16_bf16 v[208:223], a[172:175], a[12:15], v[208:223]
    ds_read_b64_tr_b16 a[160:161], v20 offset:18432
    ds_read_b64_tr_b16 a[162:163], v20 offset:18944
    s_waitcnt lgkmcnt(10)
    v_mfma_f32_32x32x16_bf16 v[224:239], a[176:179], a[12:15], v[224:239]
    ds_read_b64_tr_b16 a[164:165], v21 offset:18432
    ds_read_b64_tr_b16 a[166:167], v21 offset:18944
    buffer_load_dwordx4 v11, s[8:11], s85 offen offset:2048 lds
    v_mfma_f32_32x32x16_bf16 v[240:255], a[180:183], a[12:15], v[240:255]
    ds_read_b64_tr_b16 a[168:169], v22 offset:18432
    ds_read_b64_tr_b16 a[170:171], v22 offset:18944
    buffer_load_dwordx4 v12, s[8:11], s85 offen offset:3072 lds
    s_waitcnt lgkmcnt(10)
    v_mfma_f32_32x32x16_bf16 v[192:207], a[184:187], a[16:19], v[192:207]
    ds_read_b64_tr_b16 a[172:173], v23 offset:18432
    ds_read_b64_tr_b16 a[174:175], v23 offset:18944
    s_add_u32 m0, s63, 114688
    s_nop 0
    buffer_load_dwordx4 v5, s[8:11], s86 offen offset:0 lds
    v_mfma_f32_32x32x16_bf16 v[208:223], a[188:191], a[16:19], v[208:223]
    ds_read_b64_tr_b16 a[176:177], v20 offset:20480
    ds_read_b64_tr_b16 a[178:179], v20 offset:20992
    s_waitcnt lgkmcnt(10)
    v_mfma_f32_32x32x16_bf16 v[224:239], a[192:195], a[16:19], v[224:239]
    ds_read_b64_tr_b16 a[180:181], v21 offset:20480
    ds_read_b64_tr_b16 a[182:183], v21 offset:20992
    buffer_load_dwordx4 v10, s[8:11], s86 offen offset:1024 lds
    v_mfma_f32_32x32x16_bf16 v[240:255], a[196:199], a[16:19], v[240:255]
    ds_read_b64_tr_b16 a[184:185], v22 offset:20480
    ds_read_b64_tr_b16 a[186:187], v22 offset:20992
    buffer_load_dwordx4 v11, s[8:11], s86 offen offset:2048 lds
    s_waitcnt lgkmcnt(10)
    v_mfma_f32_32x32x16_bf16 v[192:207], a[160:163], a[20:23], v[192:207]
    ds_read_b64_tr_b16 a[188:189], v23 offset:20480
    ds_read_b64_tr_b16 a[190:191], v23 offset:20992
    buffer_load_dwordx4 v12, s[8:11], s86 offen offset:3072 lds
    v_mfma_f32_32x32x16_bf16 v[208:223], a[164:167], a[20:23], v[208:223]
    ds_read_b64_tr_b16 a[192:193], v20 offset:22528
    ds_read_b64_tr_b16 a[194:195], v20 offset:23040
    s_waitcnt lgkmcnt(10)
    v_mfma_f32_32x32x16_bf16 v[224:239], a[168:171], a[20:23], v[224:239]
    ds_read_b64_tr_b16 a[196:197], v21 offset:22528
    ds_read_b64_tr_b16 a[198:199], v21 offset:23040
    buffer_store_dword a255, v15, s[12:15], s34 offen offset:0 sc1
    v_mfma_f32_32x32x16_bf16 v[240:255], a[172:175], a[20:23], v[240:255]
    ds_read_b64_tr_b16 a[160:161], v22 offset:22528
    ds_read_b64_tr_b16 a[162:163], v22 offset:23040
    s_waitcnt lgkmcnt(10)
    v_mfma_f32_32x32x16_bf16 v[192:207], a[176:179], a[24:27], v[192:207]
    ds_read_b64_tr_b16 a[164:165], v23 offset:22528
    ds_read_b64_tr_b16 a[166:167], v23 offset:23040
    v_mfma_f32_32x32x16_bf16 v[208:223], a[180:183], a[24:27], v[208:223]
    s_barrier
    ds_read_b64_tr_b16 a[168:169], v20 offset:32768
    ds_read_b64_tr_b16 a[170:171], v20 offset:33280
    s_add_u32 m0, s63, 131072
    s_nop 0
    buffer_load_dwordx4 v5, s[8:11], s87 offen offset:0 lds
    s_waitcnt lgkmcnt(10)
    v_mfma_f32_32x32x16_bf16 v[224:239], a[184:187], a[24:27], v[224:239]
    ds_read_b64_tr_b16 a[172:173], v21 offset:32768
    ds_read_b64_tr_b16 a[174:175], v21 offset:33280
    buffer_load_dwordx4 v10, s[8:11], s87 offen offset:1024 lds
    v_mfma_f32_32x32x16_bf16 v[240:255], a[188:191], a[24:27], v[240:255]
    ds_read_b64_tr_b16 a[176:177], v22 offset:32768
    ds_read_b64_tr_b16 a[178:179], v22 offset:33280
    buffer_load_dwordx4 v11, s[8:11], s87 offen offset:2048 lds
    s_waitcnt lgkmcnt(10)
    v_mfma_f32_32x32x16_bf16 v[192:207], a[192:195], a[28:31], v[192:207]
    ds_read_b64_tr_b16 a[180:181], v23 offset:32768
    ds_read_b64_tr_b16 a[182:183], v23 offset:33280
    buffer_load_dwordx4 v12, s[8:11], s87 offen offset:3072 lds
    v_mfma_f32_32x32x16_bf16 v[208:223], a[196:199], a[28:31], v[208:223]
    ds_read_b64_tr_b16 a[184:185], v20 offset:34816
    ds_read_b64_tr_b16 a[186:187], v20 offset:35328
    s_waitcnt lgkmcnt(10)
    v_mfma_f32_32x32x16_bf16 v[224:239], a[160:163], a[28:31], v[224:239]
    ds_read_b64_tr_b16 a[188:189], v21 offset:34816
    ds_read_b64_tr_b16 a[190:191], v21 offset:35328
    s_add_u32 m0, s63, 147456
    s_nop 0
    buffer_load_dwordx4 v5, s[8:11], s88 offen offset:0 lds
    v_mfma_f32_32x32x16_bf16 v[240:255], a[164:167], a[28:31], v[240:255]
    ds_read_b64_tr_b16 a[192:193], v22 offset:34816
    ds_read_b64_tr_b16 a[194:195], v22 offset:35328
    buffer_load_dwordx4 v10, s[8:11], s88 offen offset:1024 lds
    s_waitcnt lgkmcnt(10)
    v_mfma_f32_32x32x16_bf16 v[192:207], a[168:171], a[32:35], v[192:207]
    ds_read_b64_tr_b16 a[196:197], v23 offset:34816
    ds_read_b64_tr_b16 a[198:199], v23 offset:35328
    buffer_load_dwordx4 v11, s[8:11], s88 offen offset:2048 lds
    v_mfma_f32_32x32x16_bf16 v[208:223], a[172:175], a[32:35], v[208:223]
    ds_read_b64_tr_b16 a[160:161], v20 offset:36864
    ds_read_b64_tr_b16 a[162:163], v20 offset:37376
    s_waitcnt lgkmcnt(10)
    v_mfma_f32_32x32x16_bf16 v[224:239], a[176:179], a[32:35], v[224:239]
    ds_read_b64_tr_b16 a[164:165], v21 offset:36864
    ds_read_b64_tr_b16 a[166:167], v21 offset:37376
    buffer_load_dwordx4 v12, s[8:11], s88 offen offset:3072 lds
    v_mfma_f32_32x32x16_bf16 v[240:255], a[180:183], a[32:35], v[240:255]
    ds_read_b64_tr_b16 a[168:169], v22 offset:36864
    ds_read_b64_tr_b16 a[170:171], v22 offset:37376
    v_cndmask_b32 v48, v49, v48, s[96:97]
    buffer_atomic_add_f32 v48, v28, s[12:15], s48 offen offset:512
    s_waitcnt lgkmcnt(10)
    v_mfma_f32_32x32x16_bf16 v[192:207], a[184:187], a[36:39], v[192:207]
    ds_read_b64_tr_b16 a[172:173], v23 offset:36864
    ds_read_b64_tr_b16 a[174:175], v23 offset:37376
    v_mfma_f32_32x32x16_bf16 v[208:223], a[188:191], a[36:39], v[208:223]
    ds_read_b64_tr_b16 a[176:177], v20 offset:38912
    ds_read_b64_tr_b16 a[178:179], v20 offset:39424
    s_waitcnt lgkmcnt(10)
    v_mfma_f32_32x32x16_bf16 v[224:239], a[192:195], a[36:39], v[224:239]
    ds_read_b64_tr_b16 a[180:181], v21 offset:38912
    ds_read_b64_tr_b16 a[182:183], v21 offset:39424
    v_mfma_f32_32x32x16_bf16 v[240:255], a[196:199], a[36:39], v[240:255]
    ds_read_b64_tr_b16 a[184:185], v22 offset:38912
    ds_read_b64_tr_b16 a[186:187], v22 offset:39424
    s_waitcnt lgkmcnt(10)
    v_mfma_f32_32x32x16_bf16 v[192:207], a[160:163], a[40:43], v[192:207]
    ds_read_b64_tr_b16 a[188:189], v23 offset:38912
    ds_read_b64_tr_b16 a[190:191], v23 offset:39424
    v_mfma_f32_32x32x16_bf16 v[208:223], a[164:167], a[40:43], v[208:223]
    s_waitcnt vmcnt(28)
    s_barrier
    ds_read_b64_tr_b16 a[192:193], v104 offset:16384
    ds_read_b64_tr_b16 a[194:195], v104 offset:16896
    s_add_u32 m0, s63, 65536
    s_nop 0
    buffer_load_dwordx4 v5, s[8:11], s89 offen offset:0 lds
    s_waitcnt lgkmcnt(10)
    v_mfma_f32_32x32x16_bf16 v[224:239], a[168:171], a[40:43], v[224:239]
    ds_read_b64_tr_b16 a[196:197], v105 offset:16384
    ds_read_b64_tr_b16 a[198:199], v105 offset:16896
    buffer_load_dwordx4 v10, s[8:11], s89 offen offset:1024 lds
    v_mfma_f32_32x32x16_bf16 v[240:255], a[172:175], a[40:43], v[240:255]
    ds_read_b64_tr_b16 a[160:161], v106 offset:16384
    ds_read_b64_tr_b16 a[162:163], v106 offset:16896
    buffer_load_dwordx4 v11, s[8:11], s89 offen offset:2048 lds
    s_waitcnt lgkmcnt(10)
    v_mfma_f32_32x32x16_bf16 v[192:207], a[176:179], a[44:47], v[192:207]
    ds_read_b64_tr_b16 a[164:165], v107 offset:16384
    ds_read_b64_tr_b16 a[166:167], v107 offset:16896
    buffer_load_dwordx4 v12, s[8:11], s89 offen offset:3072 lds
    s_waitcnt vmcnt(23)
    v_mul_f32 v46, 0x3acccccd, v116
    s_waitcnt vmcnt(22)
    v_mul_f32 v117, 0x3acccccd, v117
    v_mfma_f32_32x32x16_bf16 v[208:223], a[180:183], a[44:47], v[208:223]
    ds_read_b64_tr_b16 a[168:169], v104 offset:18432
    ds_read_b64_tr_b16 a[170:171], v104 offset:18944
    v_fma_f32 v117, -v46, v46, v117
    v_max_f32 v117, 0, v117
    v_cvt_pk_bf16_f32 v117, v117, v117
    s_waitcnt lgkmcnt(10)
    v_mfma_f32_32x32x16_bf16 v[224:239], a[184:187], a[44:47], v[224:239]
    ds_read_b64_tr_b16 a[172:173], v105 offset:18432
    ds_read_b64_tr_b16 a[174:175], v105 offset:18944
    s_add_u32 s8, s8, 128
    s_addc_u32 s9, s9, 0
    s_sub_u32 s10, s10, 128
    s_add_u32 m0, s63, 81920
    s_nop 0
    buffer_load_dwordx4 v5, s[8:11], s80 offen offset:0 lds
    v_lshlrev_b32 v117, 16, v117
    v_add_f32 v117, 0x3727c5ac, v117
    v_cvt_pk_bf16_f32 v117, v117, v117
    v_mfma_f32_32x32x16_bf16 v[240:255], a[188:191], a[44:47], v[240:255]
    ds_read_b64_tr_b16 a[176:177], v106 offset:18432
    ds_read_b64_tr_b16 a[178:179], v106 offset:18944
    buffer_load_dwordx4 v10, s[8:11], s80 offen offset:1024 lds
    v_lshlrev_b32 v117, 16, v117
    v_sqrt_f32 v45, v117
    s_mov_b32 s98, -1
    s_mov_b32 s99, 0
    s_waitcnt lgkmcnt(10)
    v_mfma_f32_32x32x16_bf16 v[192:207], a[192:195], a[48:51], v[192:207]
    ds_read_b64_tr_b16 a[180:181], v107 offset:18432
    ds_read_b64_tr_b16 a[182:183], v107 offset:18944
    buffer_load_dwordx4 v11, s[8:11], s80 offen offset:2048 lds
    v_sub_f32 v80, 0, v46
    v_cndmask_b32 v80, 0, v80, s[98:99]
    v_mfma_f32_32x32x16_bf16 v[208:223], a[196:199], a[48:51], v[208:223]
    ds_read_b64_tr_b16 a[184:185], v104 offset:20480
    ds_read_b64_tr_b16 a[186:187], v104 offset:20992
    v_cvt_pk_bf16_f32 v45, v45, v45
    v_lshlrev_b32 v45, 16, v45
    s_waitcnt lgkmcnt(10)
    v_mfma_f32_32x32x16_bf16 v[224:239], a[160:163], a[48:51], v[224:239]
    ds_read_b64_tr_b16 a[188:189], v105 offset:20480
    ds_read_b64_tr_b16 a[190:191], v105 offset:20992
    buffer_load_dwordx4 v12, s[8:11], s80 offen offset:3072 lds
    v_rcp_f32 v47, v45
    v_cvt_pk_bf16_f32 v40, v80, 0
    v_cvt_pk_bf16_f32 v41, 0, v80
    v_mfma_f32_32x32x16_bf16 v[240:255], a[164:167], a[48:51], v[240:255]
    ds_read_b64_tr_b16 a[192:193], v106 offset:20480
    ds_read_b64_tr_b16 a[194:195], v106 offset:20992
    v_mov_b32 v42, v41
    v_mov_b32 v43, 0
    v_mul_f32 v44, 0xbfb8aa3b, v47
    s_waitcnt lgkmcnt(10)
    v_mfma_f32_32x32x16_bf16 v[192:207], a[168:171], a[52:55], v[192:207]
    ds_read_b64_tr_b16 a[196:197], v107 offset:20480
    ds_read_b64_tr_b16 a[198:199], v107 offset:20992
    v_cvt_pk_bf16_f32 v72, v68, v68
    v_lshlrev_b32 v74, 16, v72
    v_mfma_f32_32x32x16_bf16 v[208:223], a[172:175], a[52:55], v[208:223]
    ds_read_b64_tr_b16 a[160:161], v104 offset:22528
    ds_read_b64_tr_b16 a[162:163], v104 offset:23040
    v_sub_f32 v73, v68, v74
    v_mov_b32 v52, v72
    v_cvt_pk_bf16_f32 v53, v68, v73
    s_waitcnt lgkmcnt(10)
    v_mfma_f32_32x32x16_bf16 v[224:239], a[176:179], a[52:55], v[224:239]
    ds_read_b64_tr_b16 a[164:165], v105 offset:22528
    ds_read_b64_tr_b16 a[166:167], v105 offset:23040
    v_and_b32 v74, 0xffff0000, v53
    v_sub_f32 v74, v73, v74
    v_cvt_pk_bf16_f32 v54, v73, v74
    v_mfma_f32_32x32x16_bf16 v[240:255], a[180:183], a[52:55], v[240:255]
    ds_read_b64_tr_b16 a[168:169], v106 offset:22528
    ds_read_b64_tr_b16 a[170:171], v106 offset:23040
    v_mov_b32 v55, 0
    v_cvt_pk_bf16_f32 v72, v69, v69
    v_lshlrev_b32 v74, 16, v72
    s_waitcnt lgkmcnt(10)
    v_mfma_f32_32x32x16_bf16 v[192:207], a[184:187], a[56:59], v[192:207]
    ds_read_b64_tr_b16 a[172:173], v107 offset:22528
    ds_read_b64_tr_b16 a[174:175], v107 offset:23040
    v_sub_f32 v73, v69, v74
    v_mov_b32 v56, v72
    v_mfma_f32_32x32x16_bf16 v[208:223], a[188:191], a[56:59], v[208:223]
    s_barrier
    ds_read_b64_tr_b16 a[176:177], v104 offset:32768
    ds_read_b64_tr_b16 a[178:179], v104 offset:33280
    s_add_u32 m0, s63, 98304
    s_nop 0
    buffer_load_dwordx4 v5, s[8:11], s81 offen offset:0 lds
    v_cvt_pk_bf16_f32 v57, v69, v73
    v_and_b32 v74, 0xffff0000, v57
    v_sub_f32 v74, v73, v74
    s_waitcnt lgkmcnt(10)
    v_mfma_f32_32x32x16_bf16 v[224:239], a[192:195], a[56:59], v[224:239]
    ds_read_b64_tr_b16 a[180:181], v105 offset:32768
    ds_read_b64_tr_b16 a[182:183], v105 offset:33280
    buffer_load_dwordx4 v10, s[8:11], s81 offen offset:1024 lds
    v_cvt_pk_bf16_f32 v58, v73, v74
    v_mov_b32 v59, 0
    v_cvt_pk_bf16_f32 v72, v70, v70
    v_mfma_f32_32x32x16_bf16 v[240:255], a[196:199], a[56:59], v[240:255]
    ds_read_b64_tr_b16 a[184:185], v106 offset:32768
    ds_read_b64_tr_b16 a[186:187], v106 offset:33280
    buffer_load_dwordx4 v11, s[8:11], s81 offen offset:2048 lds
    v_lshlrev_b32 v74, 16, v72
    v_sub_f32 v73, v70, v74
    v_mov_b32 v60, v72
    s_waitcnt lgkmcnt(10)
    v_mfma_f32_32x32x16_bf16 v[192:207], a[160:163], a[60:63], v[192:207]
    ds_read_b64_tr_b16 a[188:189], v107 offset:32768
    ds_read_b64_tr_b16 a[190:191], v107 offset:33280
    buffer_load_dwordx4 v12, s[8:11], s81 offen offset:3072 lds
    v_cvt_pk_bf16_f32 v61, v70, v73
    v_and_b32 v74, 0xffff0000, v61
    v_mfma_f32_32x32x16_bf16 v[208:223], a[164:167], a[60:63], v[208:223]
    ds_read_b64_tr_b16 a[192:193], v104 offset:34816
    ds_read_b64_tr_b16 a[194:195], v104 offset:35328
    v_sub_f32 v74, v73, v74
    v_cvt_pk_bf16_f32 v62, v73, v74
    v_mov_b32 v63, 0
    s_waitcnt lgkmcnt(10)
    v_mfma_f32_32x32x16_bf16 v[224:239], a[168:171], a[60:63], v[224:239]
    ds_read_b64_tr_b16 a[196:197], v105 offset:34816
    ds_read_b64_tr_b16 a[198:199], v105 offset:35328
    v_cvt_pk_bf16_f32 v72, v71, v71
    v_lshlrev_b32 v74, 16, v72
    v_sub_f32 v73, v71, v74
    v_mfma_f32_32x32x16_bf16 v[240:255], a[172:175], a[60:63], v[240:255]
    ds_read_b64_tr_b16 a[160:161], v106 offset:34816
    ds_read_b64_tr_b16 a[162:163], v106 offset:35328
    v_mov_b32 v64, v72
    v_cvt_pk_bf16_f32 v65, v71, v73
    v_and_b32 v74, 0xffff0000, v65
    s_waitcnt lgkmcnt(10)
    v_mfma_f32_32x32x16_bf16 v[192:207], a[176:179], a[64:67], v[192:207]
    ds_read_b64_tr_b16 a[164:165], v107 offset:34816
    ds_read_b64_tr_b16 a[166:167], v107 offset:35328
    v_sub_f32 v74, v73, v74
    v_cvt_pk_bf16_f32 v66, v73, v74
    v_mfma_f32_32x32x16_bf16 v[208:223], a[180:183], a[64:67], v[208:223]
    ds_read_b64_tr_b16 a[168:169], v104 offset:36864
    ds_read_b64_tr_b16 a[170:171], v104 offset:37376
    v_mov_b32 v67, 0
    v_mfma_f32_32x32x16_bf16 v[128:143], v[52:55], v[40:43], v[128:143]
    v_mfma_f32_32x32x16_bf16 v[144:159], v[56:59], v[40:43], v[144:159]
    s_waitcnt lgkmcnt(10)
    v_mfma_f32_32x32x16_bf16 v[224:239], a[184:187], a[64:67], v[224:239]
    ds_read_b64_tr_b16 a[172:173], v105 offset:36864
    ds_read_b64_tr_b16 a[174:175], v105 offset:37376
    v_mfma_f32_32x32x16_bf16 v[160:175], v[60:63], v[40:43], v[160:175]
    v_mfma_f32_32x32x16_bf16 v[176:191], v[64:67], v[40:43], v[176:191]
    s_nop 4
    v_mul_f32 v128, v128, v44
    v_mfma_f32_32x32x16_bf16 v[240:255], a[188:191], a[64:67], v[240:255]
    ds_read_b64_tr_b16 a[176:177], v106 offset:36864
    ds_read_b64_tr_b16 a[178:179], v106 offset:37376
    v_mul_f32 v129, v129, v44
    v_exp_f32 v128, v128
    s_waitcnt lgkmcnt(10)
    v_mfma_f32_32x32x16_bf16 v[192:207], a[192:195], a[68:71], v[192:207]
    ds_read_b64_tr_b16 a[180:181], v107 offset:36864
    ds_read_b64_tr_b16 a[182:183], v107 offset:37376
    v_mul_f32 v130, v130, v44
    v_mfma_f32_32x32x16_bf16 v[208:223], a[196:199], a[68:71], v[208:223]
    ds_read_b64_tr_b16 a[184:185], v104 offset:38912
    ds_read_b64_tr_b16 a[186:187], v104 offset:39424
    v_exp_f32 v129, v129
    v_fma_f32 v128, v128, v45, v45
    v_mul_f32 v131, v131, v44
    s_waitcnt lgkmcnt(10)
    v_mfma_f32_32x32x16_bf16 v[224:239], a[160:163], a[68:71], v[224:239]
    ds_read_b64_tr_b16 a[188:189], v105 offset:38912
    ds_read_b64_tr_b16 a[190:191], v105 offset:39424
    v_exp_f32 v130, v130
    v_fma_f32 v129, v129, v45, v45
    v_mfma_f32_32x32x16_bf16 v[240:255], a[164:167], a[68:71], v[240:255]
    ds_read_b64_tr_b16 a[192:193], v106 offset:38912
    ds_read_b64_tr_b16 a[194:195], v106 offset:39424
    v_rcp_f32 v128, v128
    v_mul_f32 v132, v132, v44
    s_waitcnt lgkmcnt(10)
    v_mfma_f32_32x32x16_bf16 v[192:207], a[168:171], a[72:75], v[192:207]
    ds_read_b64_tr_b16 a[196:197], v107 offset:38912
    ds_read_b64_tr_b16 a[198:199], v107 offset:39424
    v_exp_f32 v131, v131
    v_mfma_f32_32x32x16_bf16 v[208:223], a[172:175], a[72:75], v[208:223]
    s_waitcnt vmcnt(12)
    s_barrier
    ds_read_b64_tr_b16 a[160:161], v104 offset:49152
    ds_read_b64_tr_b16 a[162:163], v104 offset:49664
    s_add_u32 m0, s63, 16384
    s_nop 0
    buffer_load_dwordx4 v5, s[8:11], s82 offen offset:0 lds
    v_fma_f32 v130, v130, v45, v45
    v_rcp_f32 v129, v129
    s_waitcnt lgkmcnt(10)
    v_mfma_f32_32x32x16_bf16 v[224:239], a[176:179], a[72:75], v[224:239]
    ds_read_b64_tr_b16 a[164:165], v105 offset:49152
    ds_read_b64_tr_b16 a[166:167], v105 offset:49664
    buffer_load_dwordx4 v10, s[8:11], s82 offen offset:1024 lds
    v_mul_f32 v136, v136, v128
    v_mul_f32 v133, v133, v44
    v_mfma_f32_32x32x16_bf16 v[240:255], a[180:183], a[72:75], v[240:255]
    ds_read_b64_tr_b16 a[168:169], v106 offset:49152
    ds_read_b64_tr_b16 a[170:171], v106 offset:49664
    buffer_load_dwordx4 v11, s[8:11], s82 offen offset:2048 lds
    v_exp_f32 v132, v132
    v_fma_f32 v131, v131, v45, v45
    s_waitcnt lgkmcnt(10)
    v_mfma_f32_32x32x16_bf16 v[192:207], a[184:187], a[76:79], v[192:207]
    ds_read_b64_tr_b16 a[172:173], v107 offset:49152
    ds_read_b64_tr_b16 a[174:175], v107 offset:49664
    buffer_load_dwordx4 v12, s[8:11], s82 offen offset:3072 lds
    v_rcp_f32 v130, v130
    v_mul_f32 v137, v137, v129
    v_mfma_f32_32x32x16_bf16 v[208:223], a[188:191], a[76:79], v[208:223]
    ds_read_b64_tr_b16 a[176:177], v104 offset:51200
    ds_read_b64_tr_b16 a[178:179], v104 offset:51712
    v_mul_f32 v134, v134, v44
    v_exp_f32 v133, v133
    s_waitcnt lgkmcnt(10)
    v_mfma_f32_32x32x16_bf16 v[224:239], a[192:195], a[76:79], v[224:239]
    ds_read_b64_tr_b16 a[180:181], v105 offset:51200
    ds_read_b64_tr_b16 a[182:183], v105 offset:51712
    buffer_store_dword a255, v33, s[12:15], s43 offen offset:128 sc1
    v_fma_f32 v132, v132, v45, v45
    v_rcp_f32 v131, v131
    v_mfma_f32_32x32x16_bf16 v[240:255], a[196:199], a[76:79], v[240:255]
    ds_read_b64_tr_b16 a[184:185], v106 offset:51200
    ds_read_b64_tr_b16 a[186:187], v106 offset:51712
    v_mul_f32 v138, v138, v130
    v_mul_f32 v135, v135, v44
    s_waitcnt lgkmcnt(10)
    v_mfma_f32_32x32x16_bf16 v[192:207], a[160:163], a[80:83], v[192:207]
    ds_read_b64_tr_b16 a[188:189], v107 offset:51200
    ds_read_b64_tr_b16 a[190:191], v107 offset:51712
    v_exp_f32 v134, v134
    v_fma_f32 v133, v133, v45, v45
    v_mfma_f32_32x32x16_bf16 v[208:223], a[164:167], a[80:83], v[208:223]
    ds_read_b64_tr_b16 a[192:193], v104 offset:53248
    ds_read_b64_tr_b16 a[194:195], v104 offset:53760
    v_rcp_f32 v132, v132
    v_mul_f32 v139, v139, v131
    s_waitcnt lgkmcnt(10)
    v_mfma_f32_32x32x16_bf16 v[224:239], a[168:171], a[80:83], v[224:239]
    ds_read_b64_tr_b16 a[196:197], v105 offset:53248
    ds_read_b64_tr_b16 a[198:199], v105 offset:53760
    v_mul_f32 v144, v144, v44
    v_exp_f32 v135, v135
    v_mfma_f32_32x32x16_bf16 v[240:255], a[172:175], a[80:83], v[240:255]
    ds_read_b64_tr_b16 a[160:161], v106 offset:53248
    ds_read_b64_tr_b16 a[162:163], v106 offset:53760
    v_fma_f32 v134, v134, v45, v45
    v_rcp_f32 v133, v133
    s_waitcnt lgkmcnt(10)
    v_mfma_f32_32x32x16_bf16 v[192:207], a[176:179], a[84:87], v[192:207]
    ds_read_b64_tr_b16 a[164:165], v107 offset:53248
    ds_read_b64_tr_b16 a[166:167], v107 offset:53760
    v_mul_f32 v140, v140, v132
    v_mul_f32 v145, v145, v44
    v_mfma_f32_32x32x16_bf16 v[208:223], a[180:183], a[84:87], v[208:223]
    ds_read_b64_tr_b16 a[168:169], v104 offset:55296
    ds_read_b64_tr_b16 a[170:171], v104 offset:55808
    v_exp_f32 v144, v144
    v_fma_f32 v135, v135, v45, v45
    s_waitcnt lgkmcnt(10)
    v_mfma_f32_32x32x16_bf16 v[224:239], a[184:187], a[84:87], v[224:239]
    ds_read_b64_tr_b16 a[172:173], v105 offset:55296
    ds_read_b64_tr_b16 a[174:175], v105 offset:55808
    v_rcp_f32 v134, v134
    v_mul_f32 v141, v141, v133
    v_mfma_f32_32x32x16_bf16 v[240:255], a[188:191], a[84:87], v[240:255]
    ds_read_b64_tr_b16 a[176:177], v106 offset:55296
    ds_read_b64_tr_b16 a[178:179], v106 offset:55808
    v_mul_f32 v146, v146, v44
    v_exp_f32 v145, v145
    s_waitcnt lgkmcnt(10)
    v_mfma_f32_32x32x16_bf16 v[192:207], a[192:195], a[88:91], v[192:207]
    ds_read_b64_tr_b16 a[180:181], v107 offset:55296
    ds_read_b64_tr_b16 a[182:183], v107 offset:55808
    v_fma_f32 v144, v144, v45, v45
    v_mfma_f32_32x32x16_bf16 v[208:223], a[196:199], a[88:91], v[208:223]
    s_barrier
    ds_read_b64_tr_b16 a[184:185], v20 offset:49152
    ds_read_b64_tr_b16 a[186:187], v20 offset:49664
    s_add_u32 m0, s63, 32768
    s_nop 0
    buffer_load_dwordx4 v5, s[8:11], s83 offen offset:0 lds
    v_rcp_f32 v135, v135
    v_mul_f32 v142, v142, v134
    v_mul_f32 v147, v147, v44
    s_waitcnt lgkmcnt(10)
    v_mfma_f32_32x32x16_bf16 v[224:239], a[160:163], a[88:91], v[224:239]
    ds_read_b64_tr_b16 a[188:189], v21 offset:49152
    ds_read_b64_tr_b16 a[190:191], v21 offset:49664
    buffer_load_dwordx4 v10, s[8:11], s83 offen offset:1024 lds
    v_exp_f32 v146, v146
    v_fma_f32 v145, v145, v45, v45
    v_mfma_f32_32x32x16_bf16 v[240:255], a[164:167], a[88:91], v[240:255]
    ds_read_b64_tr_b16 a[192:193], v22 offset:49152
    ds_read_b64_tr_b16 a[194:195], v22 offset:49664
    buffer_load_dwordx4 v11, s[8:11], s83 offen offset:2048 lds
    v_rcp_f32 v144, v144
    v_mul_f32 v143, v143, v135
    s_waitcnt lgkmcnt(10)
    v_mfma_f32_32x32x16_bf16 v[192:207], a[168:171], a[92:95], v[192:207]
    ds_read_b64_tr_b16 a[196:197], v23 offset:49152
    ds_read_b64_tr_b16 a[198:199], v23 offset:49664
    buffer_load_dwordx4 v12, s[8:11], s83 offen offset:3072 lds
    v_mul_f32 v148, v148, v44
    v_mfma_f32_32x32x16_bf16 v[208:223], a[172:175], a[92:95], v[208:223]
    ds_read_b64_tr_b16 a[160:161], v20 offset:51200
    ds_read_b64_tr_b16 a[162:163], v20 offset:51712
    v_exp_f32 v147, v147
    v_fma_f32 v146, v146, v45, v45
    s_waitcnt lgkmcnt(10)
    v_mfma_f32_32x32x16_bf16 v[224:239], a[176:179], a[92:95], v[224:239]
    ds_read_b64_tr_b16 a[164:165], v21 offset:51200
    ds_read_b64_tr_b16 a[166:167], v21 offset:51712
    v_add_u32 v16, 4096, v2
    v_add_u32 v17, 8192, v2
    v_add_u32 v18, 12288, v2
    v_add_u32 v19, 16384, v2
    v_add_u32 v13, 20480, v2
    v_add_u32 v14, 24576, v2
    v_lshrrev_b32 v86, 2, v1
    v_lshlrev_b32 v86, 7, v86
    v_and_b32 v84, 3, v1
    v_lshl_add_u32 v86, v84, 3, v86
    s_mov_b32 s101, 9216
    buffer_load_dwordx2 v[84:85], v86, s[12:15], s101 offen sc1
    v_rcp_f32 v145, v145
    v_mul_f32 v152, v152, v144
    v_cvt_pk_bf16_f32 v128, v136, v137
    v_mfma_f32_32x32x16_bf16 v[240:255], a[180:183], a[92:95], v[240:255]
    ds_read_b64_tr_b16 a[168:169], v22 offset:51200
    ds_read_b64_tr_b16 a[170:171], v22 offset:51712
    buffer_load_dwordx2 a[240:241], v9, s[4:7], s76 offen offset:0
    v_cvt_pk_bf16_f32 v129, v138, v139
    v_cvt_pk_bf16_f32 v130, v140, v141
    v_cvt_pk_bf16_f32 v131, v142, v143
    s_waitcnt lgkmcnt(10)
    v_mfma_f32_32x32x16_bf16 v[192:207], a[184:187], a[96:99], v[192:207]
    ds_read_b64_tr_b16 a[172:173], v23 offset:51200
    ds_read_b64_tr_b16 a[174:175], v23 offset:51712
    buffer_load_dwordx2 a[242:243], v9, s[4:7], s76 offen offset:32
    v_mul_f32 v149, v149, v44
    v_mfma_f32_32x32x16_bf16 v[208:223], a[188:191], a[96:99], v[208:223]
    ds_read_b64_tr_b16 a[176:177], v20 offset:53248
    ds_read_b64_tr_b16 a[178:179], v20 offset:53760
    v_exp_f32 v148, v148
    v_fma_f32 v147, v147, v45, v45
    s_waitcnt lgkmcnt(10)
    v_mfma_f32_32x32x16_bf16 v[224:239], a[192:195], a[96:99], v[224:239]
    ds_read_b64_tr_b16 a[180:181], v21 offset:53248
    ds_read_b64_tr_b16 a[182:183], v21 offset:53760
    buffer_load_dwordx2 a[244:245], v9, s[4:7], s76 offen offset:64
    v_rcp_f32 v146, v146
    v_mul_f32 v153, v153, v145
    s_add_u32 s36, s70, 0
    buffer_store_dwordx4 v[128:131], v2, s[12:15], s36 offen sc1
    v_mfma_f32_32x32x16_bf16 v[240:255], a[196:199], a[96:99], v[240:255]
    ds_read_b64_tr_b16 a[184:185], v22 offset:53248
    ds_read_b64_tr_b16 a[186:187], v22 offset:53760
    buffer_load_dwordx2 a[246:247], v9, s[4:7], s76 offen offset:96
    v_mul_f32 v150, v150, v44
    v_exp_f32 v149, v149
    s_waitcnt lgkmcnt(10)
    v_mfma_f32_32x32x16_bf16 v[192:207], a[160:163], a[100:103], v[192:207]
    ds_read_b64_tr_b16 a[188:189], v23 offset:53248
    ds_read_b64_tr_b16 a[190:191], v23 offset:53760
    buffer_load_dwordx2 a[248:249], v9, s[4:7], s76 offen offset:128
    v_fma_f32 v148, v148, v45, v45
    v_mfma_f32_32x32x16_bf16 v[208:223], a[164:167], a[100:103], v[208:223]
    ds_read_b64_tr_b16 a[192:193], v20 offset:55296
    ds_read_b64_tr_b16 a[194:195], v20 offset:55808
    v_rcp_f32 v147, v147
    v_mul_f32 v154, v154, v146
    v_mul_f32 v151, v151, v44
    s_waitcnt lgkmcnt(10)
    v_mfma_f32_32x32x16_bf16 v[224:239], a[168:171], a[100:103], v[224:239]
    ds_read_b64_tr_b16 a[196:197], v21 offset:55296
    ds_read_b64_tr_b16 a[198:199], v21 offset:55808
    v_exp_f32 v150, v150
    v_fma_f32 v149, v149, v45, v45
    v_mfma_f32_32x32x16_bf16 v[240:255], a[172:175], a[100:103], v[240:255]
    ds_read_b64_tr_b16 a[160:161], v22 offset:55296
    ds_read_b64_tr_b16 a[162:163], v22 offset:55808
    v_rcp_f32 v148, v148
    v_mul_f32 v155, v155, v147
    s_waitcnt lgkmcnt(10)
    v_mfma_f32_32x32x16_bf16 v[192:207], a[176:179], a[104:107], v[192:207]
    ds_read_b64_tr_b16 a[164:165], v23 offset:55296
    ds_read_b64_tr_b16 a[166:167], v23 offset:55808
    v_mul_f32 v160, v160, v44
    v_mfma_f32_32x32x16_bf16 v[208:223], a[180:183], a[104:107], v[208:223]
    s_barrier
    ds_read_b64_tr_b16 a[168:169], v24 offset:0
    ds_read_b64_tr_b16 a[170:171], v24 offset:512
    s_add_u32 m0, s63, 49152
    s_nop 0
    buffer_load_dwordx4 v5, s[8:11], s84 offen offset:0 lds
    v_exp_f32 v151, v151
    v_fma_f32 v150, v150, v45, v45
    s_waitcnt lgkmcnt(10)
    v_mfma_f32_32x32x16_bf16 v[224:239], a[184:187], a[104:107], v[224:239]
    ds_read_b64_tr_b16 a[172:173], v25 offset:0
    ds_read_b64_tr_b16 a[174:175], v25 offset:512
    buffer_load_dwordx4 v10, s[8:11], s84 offen offset:1024 lds
    v_rcp_f32 v149, v149
    v_mul_f32 v156, v156, v148
    v_mul_f32 v161, v161, v44
    v_mfma_f32_32x32x16_bf16 v[240:255], a[188:191], a[104:107], v[240:255]
    ds_read_b64_tr_b16 a[176:177], v26 offset:0
    ds_read_b64_tr_b16 a[178:179], v26 offset:512
    buffer_load_dwordx4 v11, s[8:11], s84 offen offset:2048 lds
    v_exp_f32 v160, v160
    v_fma_f32 v151, v151, v45, v45
    s_waitcnt lgkmcnt(10)
    v_mfma_f32_32x32x16_bf16 v[192:207], a[192:195], a[108:111], v[192:207]
    ds_read_b64_tr_b16 a[180:181], v27 offset:0
    ds_read_b64_tr_b16 a[182:183], v27 offset:512
    buffer_load_dwordx4 v12, s[8:11], s84 offen offset:3072 lds
    v_rcp_f32 v150, v150
    v_mfma_f32_32x32x16_bf16 v[208:223], a[196:199], a[108:111], v[208:223]
    ds_read_b64_tr_b16 a[184:185], v24 offset:2048
    ds_read_b64_tr_b16 a[186:187], v24 offset:2560
    v_mul_f32 v157, v157, v149
    v_mul_f32 v162, v162, v44
    s_waitcnt lgkmcnt(10)
    v_mfma_f32_32x32x16_bf16 v[224:239], a[160:163], a[108:111], v[224:239]
    ds_read_b64_tr_b16 a[188:189], v25 offset:2048
    ds_read_b64_tr_b16 a[190:191], v25 offset:2560
    buffer_load_dword v75, v34, s[12:15], 0 offen offset:128 sc1
    v_exp_f32 v161, v161
    v_fma_f32 v160, v160, v45, v45
    v_mfma_f32_32x32x16_bf16 v[240:255], a[164:167], a[108:111], v[240:255]
    ds_read_b64_tr_b16 a[192:193], v26 offset:2048
    ds_read_b64_tr_b16 a[194:195], v26 offset:2560
    v_rcp_f32 v151, v151
    v_mul_f32 v158, v158, v150
    v_mul_f32 v163, v163, v44
    s_waitcnt lgkmcnt(10)
    v_mfma_f32_32x32x16_bf16 v[192:207], a[168:171], a[112:115], v[192:207]
    ds_read_b64_tr_b16 a[196:197], v27 offset:2048
    ds_read_b64_tr_b16 a[198:199], v27 offset:2560
    v_exp_f32 v162, v162
    v_mfma_f32_32x32x16_bf16 v[208:223], a[172:175], a[112:115], v[208:223]
    ds_read_b64_tr_b16 a[160:161], v24 offset:4096
    ds_read_b64_tr_b16 a[162:163], v24 offset:4608
    v_fma_f32 v161, v161, v45, v45
    v_rcp_f32 v160, v160
    s_waitcnt lgkmcnt(10)
    v_mfma_f32_32x32x16_bf16 v[224:239], a[176:179], a[112:115], v[224:239]
    ds_read_b64_tr_b16 a[164:165], v25 offset:4096
    ds_read_b64_tr_b16 a[166:167], v25 offset:4608
    v_mul_f32 v159, v159, v151
    v_mul_f32 v164, v164, v44
    v_mfma_f32_32x32x16_bf16 v[240:255], a[180:183], a[112:115], v[240:255]
    ds_read_b64_tr_b16 a[168:169], v26 offset:4096
    ds_read_b64_tr_b16 a[170:171], v26 offset:4608
    v_exp_f32 v163, v163
    v_fma_f32 v162, v162, v45, v45
    s_waitcnt lgkmcnt(10)
    v_mfma_f32_32x32x16_bf16 v[192:207], a[184:187], a[116:119], v[192:207]
    ds_read_b64_tr_b16 a[172:173], v27 offset:4096
    ds_read_b64_tr_b16 a[174:175], v27 offset:4608
    v_rcp_f32 v161, v161
    v_mul_f32 v168, v168, v160
    v_mfma_f32_32x32x16_bf16 v[208:223], a[188:191], a[116:119], v[208:223]
    ds_read_b64_tr_b16 a[176:177], v24 offset:6144
    ds_read_b64_tr_b16 a[178:179], v24 offset:6656
    v_cvt_pk_bf16_f32 v144, v152, v153
    v_cvt_pk_bf16_f32 v145, v154, v155
    v_cvt_pk_bf16_f32 v146, v156, v157
    s_waitcnt lgkmcnt(10)
    v_mfma_f32_32x32x16_bf16 v[224:239], a[192:195], a[116:119], v[224:239]
    ds_read_b64_tr_b16 a[180:181], v25 offset:6144
    ds_read_b64_tr_b16 a[182:183], v25 offset:6656
    v_cvt_pk_bf16_f32 v147, v158, v159
    v_mul_f32 v165, v165, v44
    v_mfma_f32_32x32x16_bf16 v[240:255], a[196:199], a[116:119], v[240:255]
    ds_read_b64_tr_b16 a[184:185], v26 offset:6144
    ds_read_b64_tr_b16 a[186:187], v26 offset:6656
    v_exp_f32 v164, v164
    v_fma_f32 v163, v163, v45, v45
    s_waitcnt lgkmcnt(10)
    v_mfma_f32_32x32x16_bf16 v[192:207], a[160:163], a[120:123], v[192:207]
    ds_read_b64_tr_b16 a[188:189], v27 offset:6144
    ds_read_b64_tr_b16 a[190:191], v27 offset:6656
    v_rcp_f32 v162, v162
    v_mul_f32 v169, v169, v161
    s_add_u32 s36, s71, 0
    v_mfma_f32_32x32x16_bf16 v[208:223], a[164:167], a[120:123], v[208:223]
    s_barrier
    ds_read_b64_tr_b16 a[192:193], v24 offset:16384
    ds_read_b64_tr_b16 a[194:195], v24 offset:16896
    s_add_u32 m0, s63, 114688
    s_nop 0
    buffer_load_dwordx4 v5, s[8:11], s85 offen offset:0 lds
    buffer_store_dwordx4 v[144:147], v2, s[12:15], s36 offen sc1
    v_mul_f32 v166, v166, v44
    s_waitcnt lgkmcnt(10)
    v_mfma_f32_32x32x16_bf16 v[224:239], a[168:171], a[120:123], v[224:239]
    ds_read_b64_tr_b16 a[196:197], v25 offset:16384
    ds_read_b64_tr_b16 a[198:199], v25 offset:16896
    buffer_load_dwordx4 v10, s[8:11], s85 offen offset:1024 lds
    v_exp_f32 v165, v165
    v_fma_f32 v164, v164, v45, v45
    v_mfma_f32_32x32x16_bf16 v[240:255], a[172:175], a[120:123], v[240:255]
    ds_read_b64_tr_b16 a[160:161], v26 offset:16384
    ds_read_b64_tr_b16 a[162:163], v26 offset:16896
    buffer_load_dwordx4 v11, s[8:11], s85 offen offset:2048 lds
    v_rcp_f32 v163, v163
    v_mul_f32 v170, v170, v162
    v_mul_f32 v167, v167, v44
    s_waitcnt lgkmcnt(10)
    v_mfma_f32_32x32x16_bf16 v[192:207], a[176:179], a[124:127], v[192:207]
    ds_read_b64_tr_b16 a[164:165], v27 offset:16384
    ds_read_b64_tr_b16 a[166:167], v27 offset:16896
    buffer_load_dwordx4 v12, s[8:11], s85 offen offset:3072 lds
    v_exp_f32 v166, v166
    v_mfma_f32_32x32x16_bf16 v[208:223], a[180:183], a[124:127], v[208:223]
    ds_read_b64_tr_b16 a[168:169], v24 offset:18432
    ds_read_b64_tr_b16 a[170:171], v24 offset:18944
    v_fma_f32 v165, v165, v45, v45
    v_rcp_f32 v164, v164
    s_waitcnt lgkmcnt(10)
    v_mfma_f32_32x32x16_bf16 v[224:239], a[184:187], a[124:127], v[224:239]
    ds_read_b64_tr_b16 a[172:173], v25 offset:18432
    ds_read_b64_tr_b16 a[174:175], v25 offset:18944
    s_waitcnt vmcnt(16)
    v_and_b32 v84, v84, v85
    v_cmp_ne_u32 vcc, 1, v84
    s_nop 0
    s_and_b32 s58, vcc_lo, 0xffffffff
    s_and_b32 s59, vcc_hi, 0xffffffff
    s_or_b32 s58, s58, s59
    s_cbranch_scc1 L_slow_kg
L_back_kg:
    buffer_load_dwordx4 a[200:203], v16, s[12:15], s67 offen offset:1024 sc1
    v_mul_f32 v171, v171, v163
    v_mul_f32 v176, v176, v44
    v_mfma_f32_32x32x16_bf16 v[240:255], a[188:191], a[124:127], v[240:255]
    ds_read_b64_tr_b16 a[176:177], v26 offset:18432
    ds_read_b64_tr_b16 a[178:179], v26 offset:18944
    buffer_load_dwordx4 a[204:207], v16, s[12:15], s67 offen offset:2048 sc1
    v_exp_f32 v167, v167
    v_fma_f32 v166, v166, v45, v45
    s_waitcnt lgkmcnt(10)
    v_mfma_f32_32x32x16_bf16 v[192:207], a[192:195], a[128:131], v[192:207]
    ds_read_b64_tr_b16 a[180:181], v27 offset:18432
    ds_read_b64_tr_b16 a[182:183], v27 offset:18944
    buffer_load_dwordx4 a[208:211], v16, s[12:15], s67 offen offset:3072 sc1
    v_rcp_f32 v165, v165
    v_mul_f32 v172, v172, v164
    v_mfma_f32_32x32x16_bf16 v[208:223], a[196:199], a[128:131], v[208:223]
    ds_read_b64_tr_b16 a[184:185], v24 offset:20480
    ds_read_b64_tr_b16 a[186:187], v24 offset:20992
    v_mul_f32 v177, v177, v44
    v_exp_f32 v176, v176
    s_waitcnt lgkmcnt(10)
    v_mfma_f32_32x32x16_bf16 v[224:239], a[160:163], a[128:131], v[224:239]
    ds_read_b64_tr_b16 a[188:189], v25 offset:20480
    ds_read_b64_tr_b16 a[190:191], v25 offset:20992
    buffer_load_dwordx4 a[212:215], v17, s[12:15], s67 offen offset:0 sc1
    v_fma_f32 v167, v167, v45, v45
    v_rcp_f32 v166, v166
    v_mfma_f32_32x32x16_bf16 v[240:255], a[164:167], a[128:131], v[240:255]
    ds_read_b64_tr_b16 a[192:193], v26 offset:20480
    ds_read_b64_tr_b16 a[194:195], v26 offset:20992
    buffer_load_dwordx4 a[216:219], v17, s[12:15], s67 offen offset:1024 sc1
    v_mul_f32 v173, v173, v165
    v_mul_f32 v178, v178, v44
    s_waitcnt lgkmcnt(10)
    v_mfma_f32_32x32x16_bf16 v[192:207], a[168:171], a[132:135], v[192:207]
    ds_read_b64_tr_b16 a[196:197], v27 offset:20480
    ds_read_b64_tr_b16 a[198:199], v27 offset:20992
    s_add_u32 m0, s63, 0
    s_nop 0
    buffer_load_dwordx4 v18, s[12:15], s67 offen offset:3072 sc1 lds
    v_exp_f32 v177, v177
    v_fma_f32 v176, v176, v45, v45
    v_mfma_f32_32x32x16_bf16 v[208:223], a[172:175], a[132:135], v[208:223]
    ds_read_b64_tr_b16 a[160:161], v24 offset:22528
    ds_read_b64_tr_b16 a[162:163], v24 offset:23040
    v_rcp_f32 v167, v167
    v_mul_f32 v174, v174, v166
    s_waitcnt lgkmcnt(10)
    v_mfma_f32_32x32x16_bf16 v[224:239], a[176:179], a[132:135], v[224:239]
    ds_read_b64_tr_b16 a[164:165], v25 offset:22528
    ds_read_b64_tr_b16 a[166:167], v25 offset:23040
    v_mul_f32 v179, v179, v44
    v_exp_f32 v178, v178
    v_mfma_f32_32x32x16_bf16 v[240:255], a[180:183], a[132:135], v[240:255]
    ds_read_b64_tr_b16 a[168:169], v26 offset:22528
    ds_read_b64_tr_b16 a[170:171], v26 offset:23040
    v_fma_f32 v177, v177, v45, v45
    v_rcp_f32 v176, v176
    s_waitcnt lgkmcnt(10)
    v_mfma_f32_32x32x16_bf16 v[192:207], a[184:187], a[136:139], v[192:207]
    ds_read_b64_tr_b16 a[172:173], v27 offset:22528
    ds_read_b64_tr_b16 a[174:175], v27 offset:23040
    v_mul_f32 v175, v175, v167
    v_mul_f32 v180, v180, v44
    v_mfma_f32_32x32x16_bf16 v[208:223], a[188:191], a[136:139], v[208:223]
    s_barrier
    ds_read_b64_tr_b16 a[176:177], v20 offset:0
    ds_read_b64_tr_b16 a[178:179], v20 offset:512
    s_add_u32 m0, s63, 131072
    s_nop 0
    buffer_load_dwordx4 v5, s[8:11], s86 offen offset:0 lds
    v_exp_f32 v179, v179
    v_fma_f32 v178, v178, v45, v45
    s_waitcnt lgkmcnt(10)
    v_mfma_f32_32x32x16_bf16 v[224:239], a[192:195], a[136:139], v[224:239]
    ds_read_b64_tr_b16 a[180:181], v21 offset:0
    ds_read_b64_tr_b16 a[182:183], v21 offset:512
    buffer_load_dwordx4 v10, s[8:11], s86 offen offset:1024 lds
    v_rcp_f32 v177, v177
    v_mul_f32 v184, v184, v176
    v_mfma_f32_32x32x16_bf16 v[240:255], a[196:199], a[136:139], v[240:255]
    ds_read_b64_tr_b16 a[184:185], v22 offset:0
    ds_read_b64_tr_b16 a[186:187], v22 offset:512
    buffer_load_dwordx4 v11, s[8:11], s86 offen offset:2048 lds
    v_cvt_pk_bf16_f32 v160, v168, v169
    v_cvt_pk_bf16_f32 v161, v170, v171
    v_cvt_pk_bf16_f32 v162, v172, v173
    s_waitcnt lgkmcnt(10)
    v_mfma_f32_32x32x16_bf16 v[192:207], a[160:163], a[140:143], v[192:207]
    ds_read_b64_tr_b16 a[188:189], v23 offset:0
    ds_read_b64_tr_b16 a[190:191], v23 offset:512
    buffer_load_dwordx4 v12, s[8:11], s86 offen offset:3072 lds
    v_cvt_pk_bf16_f32 v163, v174, v175
    v_mul_f32 v181, v181, v44
    v_mfma_f32_32x32x16_bf16 v[208:223], a[164:167], a[140:143], v[208:223]
    ds_read_b64_tr_b16 a[192:193], v20 offset:2048
    ds_read_b64_tr_b16 a[194:195], v20 offset:2560
    v_exp_f32 v180, v180
    v_fma_f32 v179, v179, v45, v45
    s_waitcnt lgkmcnt(10)
    v_mfma_f32_32x32x16_bf16 v[224:239], a[168:171], a[140:143], v[224:239]
    ds_read_b64_tr_b16 a[196:197], v21 offset:2048
    ds_read_b64_tr_b16 a[198:199], v21 offset:2560
    s_waitcnt vmcnt(15)
    v_cmp_ne_u32 vcc, 1, v75
    s_nop 0
    s_and_b32 s58, vcc_lo, 0x3ff
    s_cbranch_scc1 L_slow_cs1g
L_back_cs1g:
    buffer_load_dword v68, v35, s[12:15], s48 offen offset:512 sc1
    v_rcp_f32 v178, v178
    v_mul_f32 v185, v185, v177
    s_add_u32 s36, s72, 0
    v_mfma_f32_32x32x16_bf16 v[240:255], a[172:175], a[140:143], v[240:255]
    ds_read_b64_tr_b16 a[160:161], v22 offset:2048
    ds_read_b64_tr_b16 a[162:163], v22 offset:2560
    buffer_load_dword v69, v35, s[12:15], s49 offen offset:512 sc1
    buffer_store_dwordx4 v[160:163], v2, s[12:15], s36 offen sc1
    v_mul_f32 v182, v182, v44
    s_waitcnt lgkmcnt(10)
    v_mfma_f32_32x32x16_bf16 v[192:207], a[176:179], a[144:147], v[192:207]
    ds_read_b64_tr_b16 a[164:165], v23 offset:2048
    ds_read_b64_tr_b16 a[166:167], v23 offset:2560
    buffer_load_dword v70, v35, s[12:15], s50 offen offset:512 sc1
    v_exp_f32 v181, v181
    v_fma_f32 v180, v180, v45, v45
    v_mfma_f32_32x32x16_bf16 v[208:223], a[180:183], a[144:147], v[208:223]
    ds_read_b64_tr_b16 a[168:169], v20 offset:4096
    ds_read_b64_tr_b16 a[170:171], v20 offset:4608
    v_rcp_f32 v179, v179
    v_mul_f32 v186, v186, v178
    s_waitcnt lgkmcnt(10)
    v_mfma_f32_32x32x16_bf16 v[224:239], a[184:187], a[144:147], v[224:239]
    ds_read_b64_tr_b16 a[172:173], v21 offset:4096
    ds_read_b64_tr_b16 a[174:175], v21 offset:4608
    buffer_load_dword v71, v35, s[12:15], s51 offen offset:512 sc1
    v_mul_f32 v183, v183, v44
    v_exp_f32 v182, v182
    v_mfma_f32_32x32x16_bf16 v[240:255], a[188:191], a[144:147], v[240:255]
    ds_read_b64_tr_b16 a[176:177], v22 offset:4096
    ds_read_b64_tr_b16 a[178:179], v22 offset:4608
    buffer_load_dwordx4 a[220:223], v17, s[12:15], s67 offen offset:2048 sc1
    v_fma_f32 v181, v181, v45, v45
    v_rcp_f32 v180, v180
    s_waitcnt lgkmcnt(10)
    v_mfma_f32_32x32x16_bf16 v[192:207], a[192:195], a[148:151], v[192:207]
    ds_read_b64_tr_b16 a[180:181], v23 offset:4096
    ds_read_b64_tr_b16 a[182:183], v23 offset:4608
    buffer_load_dwordx4 a[224:227], v17, s[12:15], s67 offen offset:3072 sc1
    v_mul_f32 v187, v187, v179
    v_mfma_f32_32x32x16_bf16 v[208:223], a[196:199], a[148:151], v[208:223]
    ds_read_b64_tr_b16 a[184:185], v20 offset:6144
    ds_read_b64_tr_b16 a[186:187], v20 offset:6656
    v_exp_f32 v183, v183
    v_fma_f32 v182, v182, v45, v45
    s_waitcnt lgkmcnt(10)
    v_mfma_f32_32x32x16_bf16 v[224:239], a[160:163], a[148:151], v[224:239]
    ds_read_b64_tr_b16 a[188:189], v21 offset:6144
    ds_read_b64_tr_b16 a[190:191], v21 offset:6656
    buffer_load_dwordx4 a[228:231], v18, s[12:15], s67 offen offset:0 sc1
    v_rcp_f32 v181, v181
    v_mul_f32 v188, v188, v180
    v_fma_f32 v183, v183, v45, v45
    v_mfma_f32_32x32x16_bf16 v[240:255], a[164:167], a[148:151], v[240:255]
    ds_read_b64_tr_b16 a[192:193], v22 offset:6144
    ds_read_b64_tr_b16 a[194:195], v22 offset:6656
    buffer_load_dwordx4 a[232:235], v18, s[12:15], s67 offen offset:1024 sc1
    v_rcp_f32 v182, v182
    v_mul_f32 v189, v189, v181
    s_waitcnt lgkmcnt(10)
    v_mfma_f32_32x32x16_bf16 v[192:207], a[168:171], a[152:155], v[192:207]
    ds_read_b64_tr_b16 a[196:197], v23 offset:6144
    ds_read_b64_tr_b16 a[198:199], v23 offset:6656
    buffer_load_dwordx4 a[236:239], v18, s[12:15], s67 offen offset:2048 sc1
    v_rcp_f32 v183, v183
    v_mfma_f32_32x32x16_bf16 v[208:223], a[172:175], a[152:155], v[208:223]
    s_barrier
    ds_read_b64_tr_b16 a[160:161], v20 offset:16384
    ds_read_b64_tr_b16 a[162:163], v20 offset:16896
    v_mul_f32 v190, v190, v182
    v_mul_f32 v191, v191, v183
    v_cvt_pk_bf16_f32 v176, v184, v185
    s_waitcnt lgkmcnt(10)
    v_mfma_f32_32x32x16_bf16 v[224:239], a[176:179], a[152:155], v[224:239]
    ds_read_b64_tr_b16 a[164:165], v21 offset:16384
    ds_read_b64_tr_b16 a[166:167], v21 offset:16896
    s_add_u32 m0, s63, 147456
    s_nop 0
    buffer_load_dwordx4 v5, s[8:11], s87 offen offset:0 lds
    v_cvt_pk_bf16_f32 v177, v186, v187
    v_cvt_pk_bf16_f32 v178, v188, v189
    v_cvt_pk_bf16_f32 v179, v190, v191
    s_add_u32 s36, s73, 0
    v_mfma_f32_32x32x16_bf16 v[240:255], a[180:183], a[152:155], v[240:255]
    ds_read_b64_tr_b16 a[168:169], v22 offset:16384
    ds_read_b64_tr_b16 a[170:171], v22 offset:16896
    buffer_load_dwordx4 v10, s[8:11], s87 offen offset:1024 lds
    buffer_store_dwordx4 v[176:179], v2, s[12:15], s36 offen sc1
    s_waitcnt lgkmcnt(10)
    v_mfma_f32_32x32x16_bf16 v[192:207], a[184:187], a[156:159], v[192:207]
    ds_read_b64_tr_b16 a[172:173], v23 offset:16384
    ds_read_b64_tr_b16 a[174:175], v23 offset:16896
    buffer_load_dwordx4 v11, s[8:11], s87 offen offset:2048 lds
    v_mfma_f32_32x32x16_bf16 v[208:223], a[188:191], a[156:159], v[208:223]
    ds_read_b64_tr_b16 a[176:177], v20 offset:18432
    ds_read_b64_tr_b16 a[178:179], v20 offset:18944
    s_waitcnt lgkmcnt(10)
    v_mfma_f32_32x32x16_bf16 v[224:239], a[192:195], a[156:159], v[224:239]
    ds_read_b64_tr_b16 a[180:181], v21 offset:18432
    ds_read_b64_tr_b16 a[182:183], v21 offset:18944
    buffer_load_dwordx4 v12, s[8:11], s87 offen offset:3072 lds
    v_mfma_f32_32x32x16_bf16 v[240:255], a[196:199], a[156:159], v[240:255]
    ds_read_b64_tr_b16 a[184:185], v22 offset:18432
    ds_read_b64_tr_b16 a[186:187], v22 offset:18944
    s_waitcnt lgkmcnt(10)
    v_mfma_f32_32x32x16_bf16 v[128:143], a[160:163], a[0:3], 0
    ds_read_b64_tr_b16 a[188:189], v23 offset:18432
    ds_read_b64_tr_b16 a[190:191], v23 offset:18944
    v_mfma_f32_16x16x32_bf16 v[48:51], v[36:39], a[160:163], 0
    v_mfma_f32_32x32x16_bf16 v[144:159], a[164:167], a[0:3], 0
    ds_read_b64_tr_b16 a[192:193], v20 offset:20480
    ds_read_b64_tr_b16 a[194:195], v20 offset:20992
    s_waitcnt lgkmcnt(10)
    v_mfma_f32_32x32x16_bf16 v[160:175], a[168:171], a[0:3], 0
    ds_read_b64_tr_b16 a[196:197], v21 offset:20480
    ds_read_b64_tr_b16 a[198:199], v21 offset:20992
    v_mfma_f32_32x32x16_bf16 v[176:191], a[172:175], a[0:3], 0
    ds_read_b64_tr_b16 a[160:161], v22 offset:20480
    ds_read_b64_tr_b16 a[162:163], v22 offset:20992
    s_waitcnt lgkmcnt(10)
    v_mfma_f32_32x32x16_bf16 v[128:143], a[176:179], a[4:7], v[128:143]
    ds_read_b64_tr_b16 a[164:165], v23 offset:20480
    ds_read_b64_tr_b16 a[166:167], v23 offset:20992
    s_waitcnt vmcnt(14)
    v_cvt_pk_bf16_f32 v72, v68, v68
    v_lshlrev_b32 v74, 16, v72
    v_sub_f32 v73, v68, v74
    v_mfma_f32_16x16x32_bf16 v[48:51], v[36:39], a[176:179], v[48:51]
    v_mfma_f32_32x32x16_bf16 v[144:159], a[180:183], a[4:7], v[144:159]
    ds_read_b64_tr_b16 a[168:169], v20 offset:22528
    ds_read_b64_tr_b16 a[170:171], v20 offset:23040
    v_mov_b32 v52, v72
    v_cvt_pk_bf16_f32 v53, v68, v73
    v_and_b32 v74, 0xffff0000, v53
    s_waitcnt lgkmcnt(10)
    v_mfma_f32_32x32x16_bf16 v[160:175], a[184:187], a[4:7], v[160:175]
    ds_read_b64_tr_b16 a[172:173], v21 offset:22528
    ds_read_b64_tr_b16 a[174:175], v21 offset:23040
    v_sub_f32 v74, v73, v74
    v_cvt_pk_bf16_f32 v54, v73, v74
    v_mov_b32 v55, 0
    v_mfma_f32_32x32x16_bf16 v[176:191], a[188:191], a[4:7], v[176:191]
    ds_read_b64_tr_b16 a[176:177], v22 offset:22528
    ds_read_b64_tr_b16 a[178:179], v22 offset:23040
    s_waitcnt vmcnt(13)
    v_cvt_pk_bf16_f32 v72, v69, v69
    v_lshlrev_b32 v74, 16, v72
    v_sub_f32 v73, v69, v74
    v_mov_b32 v56, v72
    s_waitcnt lgkmcnt(10)
    v_mfma_f32_32x32x16_bf16 v[128:143], a[192:195], a[8:11], v[128:143]
    ds_read_b64_tr_b16 a[180:181], v23 offset:22528
    ds_read_b64_tr_b16 a[182:183], v23 offset:23040
    v_cvt_pk_bf16_f32 v57, v69, v73
    v_and_b32 v74, 0xffff0000, v57
    v_sub_f32 v74, v73, v74
    v_mfma_f32_16x16x32_bf16 v[48:51], v[36:39], a[192:195], v[48:51]
    v_mfma_f32_32x32x16_bf16 v[144:159], a[196:199], a[8:11], v[144:159]
    s_barrier
    ds_read_b64_tr_b16 a[184:185], v20 offset:32768
    ds_read_b64_tr_b16 a[186:187], v20 offset:33280
    s_add_u32 m0, s63, 65536
    s_nop 0
    buffer_load_dwordx4 v5, s[8:11], s88 offen offset:0 lds
    v_cvt_pk_bf16_f32 v58, v73, v74
    v_mov_b32 v59, 0
    s_waitcnt vmcnt(12)
    v_cvt_pk_bf16_f32 v72, v70, v70
    s_waitcnt lgkmcnt(10)
    v_mfma_f32_32x32x16_bf16 v[160:175], a[160:163], a[8:11], v[160:175]
    ds_read_b64_tr_b16 a[188:189], v21 offset:32768
    ds_read_b64_tr_b16 a[190:191], v21 offset:33280
    buffer_load_dwordx4 v10, s[8:11], s88 offen offset:1024 lds
    v_lshlrev_b32 v74, 16, v72
    v_sub_f32 v73, v70, v74
    v_mov_b32 v60, v72
    v_cvt_pk_bf16_f32 v61, v70, v73
    v_mfma_f32_32x32x16_bf16 v[176:191], a[164:167], a[8:11], v[176:191]
    ds_read_b64_tr_b16 a[192:193], v22 offset:32768
    ds_read_b64_tr_b16 a[194:195], v22 offset:33280
    buffer_load_dwordx4 v11, s[8:11], s88 offen offset:2048 lds
    v_and_b32 v74, 0xffff0000, v61
    v_sub_f32 v74, v73, v74
    v_cvt_pk_bf16_f32 v62, v73, v74
    s_waitcnt lgkmcnt(10)
    v_mfma_f32_32x32x16_bf16 v[128:143], a[168:171], a[12:15], v[128:143]
    ds_read_b64_tr_b16 a[196:197], v23 offset:32768
    ds_read_b64_tr_b16 a[198:199], v23 offset:33280
    buffer_load_dwordx4 v12, s[8:11], s88 offen offset:3072 lds
    v_mov_b32 v63, 0
    s_waitcnt vmcnt(14)
    v_cvt_pk_bf16_f32 v72, v71, v71
    v_lshlrev_b32 v74, 16, v72
    v_mfma_f32_16x16x32_bf16 v[48:51], v[36:39], a[168:171], v[48:51]
    v_mfma_f32_32x32x16_bf16 v[144:159], a[172:175], a[12:15], v[144:159]
    ds_read_b64_tr_b16 a[160:161], v20 offset:34816
    ds_read_b64_tr_b16 a[162:163], v20 offset:35328
    v_sub_f32 v73, v71, v74
    v_mov_b32 v64, v72
    v_cvt_pk_bf16_f32 v65, v71, v73
    s_waitcnt lgkmcnt(10)
    v_mfma_f32_32x32x16_bf16 v[160:175], a[176:179], a[12:15], v[160:175]
    ds_read_b64_tr_b16 a[164:165], v21 offset:34816
    ds_read_b64_tr_b16 a[166:167], v21 offset:35328
    v_and_b32 v74, 0xffff0000, v65
    v_sub_f32 v74, v73, v74
    v_cvt_pk_bf16_f32 v66, v73, v74
    v_mov_b32 v67, 0
    v_mfma_f32_32x32x16_bf16 v[176:191], a[180:183], a[12:15], v[176:191]
    ds_read_b64_tr_b16 a[168:169], v22 offset:34816
    ds_read_b64_tr_b16 a[170:171], v22 offset:35328
    v_mfma_f32_32x32x16_bf16 v[192:207], v[52:55], v[40:43], v[192:207]
    v_mfma_f32_32x32x16_bf16 v[208:223], v[56:59], v[40:43], v[208:223]
    v_mfma_f32_32x32x16_bf16 v[224:239], v[60:63], v[40:43], v[224:239]
    s_waitcnt lgkmcnt(10)
    v_mfma_f32_32x32x16_bf16 v[128:143], a[184:187], a[16:19], v[128:143]
    ds_read_b64_tr_b16 a[172:173], v23 offset:34816
    ds_read_b64_tr_b16 a[174:175], v23 offset:35328
    v_mfma_f32_32x32x16_bf16 v[240:255], v[64:67], v[40:43], v[240:255]
    s_nop 4
    v_mul_f32 v192, v192, v44
    v_mul_f32 v193, v193, v44
    v_mfma_f32_32x32x16_bf16 v[144:159], a[188:191], a[16:19], v[144:159]
    ds_read_b64_tr_b16 a[176:177], v20 offset:36864
    ds_read_b64_tr_b16 a[178:179], v20 offset:37376
    v_exp_f32 v192, v192
    v_mul_f32 v194, v194, v44
    s_waitcnt lgkmcnt(10)
    v_mfma_f32_32x32x16_bf16 v[160:175], a[192:195], a[16:19], v[160:175]
    ds_read_b64_tr_b16 a[180:181], v21 offset:36864
    ds_read_b64_tr_b16 a[182:183], v21 offset:37376
    v_exp_f32 v193, v193
    v_fma_f32 v192, v192, v45, v45
    v_mul_f32 v195, v195, v44
    v_mfma_f32_32x32x16_bf16 v[176:191], a[196:199], a[16:19], v[176:191]
    ds_read_b64_tr_b16 a[184:185], v22 offset:36864
    ds_read_b64_tr_b16 a[186:187], v22 offset:37376
    v_exp_f32 v194, v194
    v_fma_f32 v193, v193, v45, v45
    s_waitcnt lgkmcnt(10)
    v_mfma_f32_32x32x16_bf16 v[128:143], a[160:163], a[20:23], v[128:143]
    ds_read_b64_tr_b16 a[188:189], v23 offset:36864
    ds_read_b64_tr_b16 a[190:191], v23 offset:37376
    v_rcp_f32 v192, v192
    v_mul_f32 v196, v196, v44
    v_mfma_f32_32x32x16_bf16 v[144:159], a[164:167], a[20:23], v[144:159]
    ds_read_b64_tr_b16 a[192:193], v20 offset:38912
    ds_read_b64_tr_b16 a[194:195], v20 offset:39424
    v_exp_f32 v195, v195
    v_fma_f32 v194, v194, v45, v45
    s_waitcnt lgkmcnt(10)
    v_mfma_f32_32x32x16_bf16 v[160:175], a[168:171], a[20:23], v[160:175]
    ds_read_b64_tr_b16 a[196:197], v21 offset:38912
    ds_read_b64_tr_b16 a[198:199], v21 offset:39424
    v_rcp_f32 v193, v193
    v_mul_f32 v200, v200, v192
    v_mul_f32 v197, v197, v44
    v_mfma_f32_32x32x16_bf16 v[176:191], a[172:175], a[20:23], v[176:191]
    ds_read_b64_tr_b16 a[160:161], v22 offset:38912
    ds_read_b64_tr_b16 a[162:163], v22 offset:39424
    v_exp_f32 v196, v196
    v_fma_f32 v195, v195, v45, v45
    s_waitcnt lgkmcnt(10)
    v_mfma_f32_32x32x16_bf16 v[128:143], a[176:179], a[24:27], v[128:143]
    ds_read_b64_tr_b16 a[164:165], v23 offset:38912
    ds_read_b64_tr_b16 a[166:167], v23 offset:39424
    v_rcp_f32 v194, v194
    v_mul_f32 v201, v201, v193
    v_mul_f32 v198, v198, v44
    v_mfma_f32_32x32x16_bf16 v[144:159], a[180:183], a[24:27], v[144:159]
    s_waitcnt vmcnt(6)
    s_barrier
    ds_read_b64_tr_b16 a[168:169], v104 offset:16384
    ds_read_b64_tr_b16 a[170:171], v104 offset:16896
    s_add_u32 m0, s63, 81920
    s_nop 0
    buffer_load_dwordx4 v5, s[8:11], s89 offen offset:0 lds
    v_exp_f32 v197, v197
    v_fma_f32 v196, v196, v45, v45
    s_waitcnt lgkmcnt(10)
    v_mfma_f32_32x32x16_bf16 v[160:175], a[184:187], a[24:27], v[160:175]
    ds_read_b64_tr_b16 a[172:173], v105 offset:16384
    ds_read_b64_tr_b16 a[174:175], v105 offset:16896
    buffer_load_dwordx4 v10, s[8:11], s89 offen offset:1024 lds
    v_rcp_f32 v195, v195
    v_mul_f32 v202, v202, v194
    v_mfma_f32_32x32x16_bf16 v[176:191], a[188:191], a[24:27], v[176:191]
    ds_read_b64_tr_b16 a[176:177], v106 offset:16384
    ds_read_b64_tr_b16 a[178:179], v106 offset:16896
    buffer_load_dwordx4 v11, s[8:11], s89 offen offset:2048 lds
    v_mul_f32 v199, v199, v44
    v_exp_f32 v198, v198
    v_fma_f32 v197, v197, v45, v45
    s_waitcnt lgkmcnt(10)
    v_mfma_f32_32x32x16_bf16 v[128:143], a[192:195], a[28:31], v[128:143]
    ds_read_b64_tr_b16 a[180:181], v107 offset:16384
    ds_read_b64_tr_b16 a[182:183], v107 offset:16896
    buffer_load_dwordx4 v12, s[8:11], s89 offen offset:3072 lds
    v_rcp_f32 v196, v196
    v_mul_f32 v203, v203, v195
    v_mfma_f32_32x32x16_bf16 v[144:159], a[196:199], a[28:31], v[144:159]
    ds_read_b64_tr_b16 a[184:185], v104 offset:18432
    ds_read_b64_tr_b16 a[186:187], v104 offset:18944
    v_mul_f32 v208, v208, v44
    v_exp_f32 v199, v199
    s_waitcnt lgkmcnt(10)
    v_mfma_f32_32x32x16_bf16 v[160:175], a[160:163], a[28:31], v[160:175]
    ds_read_b64_tr_b16 a[188:189], v105 offset:18432
    ds_read_b64_tr_b16 a[190:191], v105 offset:18944
    v_cndmask_b32 v48, v49, v48, s[96:97]
    buffer_atomic_add_f32 v48, v28, s[12:15], s48 offen offset:1024
    v_fma_f32 v198, v198, v45, v45
    v_rcp_f32 v197, v197
    v_mul_f32 v204, v204, v196
    v_mfma_f32_32x32x16_bf16 v[176:191], a[164:167], a[28:31], v[176:191]
    ds_read_b64_tr_b16 a[192:193], v106 offset:18432
    ds_read_b64_tr_b16 a[194:195], v106 offset:18944
    buffer_store_dword a255, v15, s[12:15], s77 offen offset:0 sc1
    v_mul_f32 v209, v209, v44
    v_exp_f32 v208, v208
    s_waitcnt lgkmcnt(10)
    v_mfma_f32_32x32x16_bf16 v[128:143], a[168:171], a[32:35], v[128:143]
    ds_read_b64_tr_b16 a[196:197], v107 offset:18432
    ds_read_b64_tr_b16 a[198:199], v107 offset:18944
    v_fma_f32 v199, v199, v45, v45
    v_rcp_f32 v198, v198
    v_mfma_f32_32x32x16_bf16 v[144:159], a[172:175], a[32:35], v[144:159]
    ds_read_b64_tr_b16 a[160:161], v104 offset:20480
    ds_read_b64_tr_b16 a[162:163], v104 offset:20992
    v_mul_f32 v205, v205, v197
    v_mul_f32 v210, v210, v44
    s_waitcnt lgkmcnt(10)
    v_mfma_f32_32x32x16_bf16 v[160:175], a[176:179], a[32:35], v[160:175]
    ds_read_b64_tr_b16 a[164:165], v105 offset:20480
    ds_read_b64_tr_b16 a[166:167], v105 offset:20992
    v_exp_f32 v209, v209
    v_fma_f32 v208, v208, v45, v45
    v_rcp_f32 v199, v199
    v_mfma_f32_32x32x16_bf16 v[176:191], a[180:183], a[32:35], v[176:191]
    ds_read_b64_tr_b16 a[168:169], v106 offset:20480
    ds_read_b64_tr_b16 a[170:171], v106 offset:20992
    v_mul_f32 v206, v206, v198
    v_mul_f32 v211, v211, v44
    s_waitcnt lgkmcnt(10)
    v_mfma_f32_32x32x16_bf16 v[128:143], a[184:187], a[36:39], v[128:143]
    ds_read_b64_tr_b16 a[172:173], v107 offset:20480
    ds_read_b64_tr_b16 a[174:175], v107 offset:20992
    v_exp_f32 v210, v210
    v_fma_f32 v209, v209, v45, v45
    v_mfma_f32_32x32x16_bf16 v[144:159], a[188:191], a[36:39], v[144:159]
    ds_read_b64_tr_b16 a[176:177], v104 offset:22528
    ds_read_b64_tr_b16 a[178:179], v104 offset:23040
    v_rcp_f32 v208, v208
    v_mul_f32 v207, v207, v199
    v_mul_f32 v212, v212, v44
    s_waitcnt lgkmcnt(10)
    v_mfma_f32_32x32x16_bf16 v[160:175], a[192:195], a[36:39], v[160:175]
    ds_read_b64_tr_b16 a[180:181], v105 offset:22528
    ds_read_b64_tr_b16 a[182:183], v105 offset:23040
    v_exp_f32 v211, v211
    v_fma_f32 v210, v210, v45, v45
    v_mfma_f32_32x32x16_bf16 v[176:191], a[196:199], a[36:39], v[176:191]
    ds_read_b64_tr_b16 a[184:185], v106 offset:22528
    ds_read_b64_tr_b16 a[186:187], v106 offset:23040
    v_rcp_f32 v209, v209
    v_mul_f32 v216, v216, v208
    v_cvt_pk_bf16_f32 v192, v200, v201
    s_waitcnt lgkmcnt(10)
    v_mfma_f32_32x32x16_bf16 v[128:143], a[160:163], a[40:43], v[128:143]
    ds_read_b64_tr_b16 a[188:189], v107 offset:22528
    ds_read_b64_tr_b16 a[190:191], v107 offset:23040
    v_cvt_pk_bf16_f32 v193, v202, v203
    v_cvt_pk_bf16_f32 v194, v204, v205
    v_cvt_pk_bf16_f32 v195, v206, v207
    v_mul_f32 v213, v213, v44
    v_mfma_f32_32x32x16_bf16 v[144:159], a[164:167], a[40:43], v[144:159]
    s_barrier
    ds_read_b64_tr_b16 a[192:193], v104 offset:32768
    ds_read_b64_tr_b16 a[194:195], v104 offset:33280
    buffer_load_dwordx4 a[0:3], v2, s[12:15], s66 offen offset:0 sc1
    v_exp_f32 v212, v212
    v_fma_f32 v211, v211, v45, v45
    s_waitcnt lgkmcnt(10)
    v_mfma_f32_32x32x16_bf16 v[160:175], a[168:171], a[40:43], v[160:175]
    ds_read_b64_tr_b16 a[196:197], v105 offset:32768
    ds_read_b64_tr_b16 a[198:199], v105 offset:33280
    buffer_load_dwordx4 a[4:7], v2, s[12:15], s66 offen offset:1024 sc1
    v_rcp_f32 v210, v210
    v_mul_f32 v217, v217, v209
    s_add_u32 s36, s70, 32768
    v_mfma_f32_32x32x16_bf16 v[176:191], a[172:175], a[40:43], v[176:191]
    ds_read_b64_tr_b16 a[160:161], v106 offset:32768
    ds_read_b64_tr_b16 a[162:163], v106 offset:33280
    buffer_load_dwordx4 a[8:11], v2, s[12:15], s66 offen offset:2048 sc1
    buffer_store_dwordx4 v[192:195], v2, s[12:15], s36 offen sc1
    v_mul_f32 v214, v214, v44
    s_waitcnt lgkmcnt(10)
    v_mfma_f32_32x32x16_bf16 v[128:143], a[176:179], a[44:47], v[128:143]
    ds_read_b64_tr_b16 a[164:165], v107 offset:32768
    ds_read_b64_tr_b16 a[166:167], v107 offset:33280
    buffer_load_dwordx4 a[12:15], v2, s[12:15], s66 offen offset:3072 sc1
    v_exp_f32 v213, v213
    v_fma_f32 v212, v212, v45, v45
    v_rcp_f32 v211, v211
    v_mfma_f32_32x32x16_bf16 v[144:159], a[180:183], a[44:47], v[144:159]
    ds_read_b64_tr_b16 a[168:169], v104 offset:34816
    ds_read_b64_tr_b16 a[170:171], v104 offset:35328
    v_mul_f32 v218, v218, v210
    v_mul_f32 v215, v215, v44
    s_waitcnt lgkmcnt(10)
    v_mfma_f32_32x32x16_bf16 v[160:175], a[184:187], a[44:47], v[160:175]
    ds_read_b64_tr_b16 a[172:173], v105 offset:34816
    ds_read_b64_tr_b16 a[174:175], v105 offset:35328
    buffer_load_dwordx4 a[16:19], v16, s[12:15], s66 offen offset:0 sc1
    v_exp_f32 v214, v214
    v_fma_f32 v213, v213, v45, v45
    v_mfma_f32_32x32x16_bf16 v[176:191], a[188:191], a[44:47], v[176:191]
    ds_read_b64_tr_b16 a[176:177], v106 offset:34816
    ds_read_b64_tr_b16 a[178:179], v106 offset:35328
    s_add_u32 m0, s63, 98304
    s_nop 0
    buffer_load_dwordx4 v19, s[12:15], s67 offen offset:0 sc1 lds
    v_rcp_f32 v212, v212
    v_mul_f32 v219, v219, v211
    v_mul_f32 v224, v224, v44
    s_waitcnt lgkmcnt(10)
    v_mfma_f32_32x32x16_bf16 v[128:143], a[192:195], a[48:51], v[128:143]
    ds_read_b64_tr_b16 a[180:181], v107 offset:34816
    ds_read_b64_tr_b16 a[182:183], v107 offset:35328
    buffer_load_dwordx4 v19, s[12:15], s67 offen offset:1024 sc1 lds
    v_exp_f32 v215, v215
    v_fma_f32 v214, v214, v45, v45
    v_mfma_f32_32x32x16_bf16 v[144:159], a[196:199], a[48:51], v[144:159]
    ds_read_b64_tr_b16 a[184:185], v104 offset:36864
    ds_read_b64_tr_b16 a[186:187], v104 offset:37376
    v_rcp_f32 v213, v213
    v_mul_f32 v220, v220, v212
    v_mul_f32 v225, v225, v44
    s_waitcnt lgkmcnt(10)
    v_mfma_f32_32x32x16_bf16 v[160:175], a[160:163], a[48:51], v[160:175]
    ds_read_b64_tr_b16 a[188:189], v105 offset:36864
    ds_read_b64_tr_b16 a[190:191], v105 offset:37376
    buffer_load_dwordx4 v19, s[12:15], s67 offen offset:2048 sc1 lds
    v_exp_f32 v224, v224
    v_fma_f32 v215, v215, v45, v45
    v_mfma_f32_32x32x16_bf16 v[176:191], a[164:167], a[48:51], v[176:191]
    ds_read_b64_tr_b16 a[192:193], v106 offset:36864
    ds_read_b64_tr_b16 a[194:195], v106 offset:37376
    buffer_load_dwordx4 v19, s[12:15], s67 offen offset:3072 sc1 lds
    v_rcp_f32 v214, v214
    v_mul_f32 v221, v221, v213
    v_mul_f32 v226, v226, v44
    s_waitcnt lgkmcnt(10)
    v_mfma_f32_32x32x16_bf16 v[128:143], a[168:171], a[52:55], v[128:143]
    ds_read_b64_tr_b16 a[196:197], v107 offset:36864
    ds_read_b64_tr_b16 a[198:199], v107 offset:37376
    v_exp_f32 v225, v225
    v_fma_f32 v224, v224, v45, v45
    v_mfma_f32_32x32x16_bf16 v[144:159], a[172:175], a[52:55], v[144:159]
    ds_read_b64_tr_b16 a[160:161], v104 offset:38912
    ds_read_b64_tr_b16 a[162:163], v104 offset:39424
    v_rcp_f32 v215, v215
    v_mul_f32 v222, v222, v214
    s_waitcnt lgkmcnt(10)
    v_mfma_f32_32x32x16_bf16 v[160:175], a[176:179], a[52:55], v[160:175]
    ds_read_b64_tr_b16 a[164:165], v105 offset:38912
    ds_read_b64_tr_b16 a[166:167], v105 offset:39424
    v_mul_f32 v227, v227, v44
    v_exp_f32 v226, v226
    v_fma_f32 v225, v225, v45, v45
    v_mfma_f32_32x32x16_bf16 v[176:191], a[180:183], a[52:55], v[176:191]
    ds_read_b64_tr_b16 a[168:169], v106 offset:38912
    ds_read_b64_tr_b16 a[170:171], v106 offset:39424
    v_rcp_f32 v224, v224
    v_mul_f32 v223, v223, v215
    s_waitcnt lgkmcnt(10)
    v_mfma_f32_32x32x16_bf16 v[128:143], a[184:187], a[56:59], v[128:143]
    ds_read_b64_tr_b16 a[172:173], v107 offset:38912
    ds_read_b64_tr_b16 a[174:175], v107 offset:39424
    v_mul_f32 v228, v228, v44
    v_exp_f32 v227, v227
    v_mfma_f32_32x32x16_bf16 v[144:159], a[188:191], a[56:59], v[144:159]
    s_waitcnt vmcnt(11)
    s_barrier
    ds_read_b64_tr_b16 a[176:177], v104 offset:49152
    ds_read_b64_tr_b16 a[178:179], v104 offset:49664
    buffer_store_dword a255, v33, s[12:15], s43 offen offset:256 sc1
    v_fma_f32 v226, v226, v45, v45
    v_rcp_f32 v225, v225
    v_mul_f32 v232, v232, v224
    s_waitcnt lgkmcnt(10)
    v_mfma_f32_32x32x16_bf16 v[160:175], a[192:195], a[56:59], v[160:175]
    ds_read_b64_tr_b16 a[180:181], v105 offset:49152
    ds_read_b64_tr_b16 a[182:183], v105 offset:49664
    buffer_load_dwordx4 a[20:23], v16, s[12:15], s66 offen offset:1024 sc1
    v_cvt_pk_bf16_f32 v208, v216, v217
    v_cvt_pk_bf16_f32 v209, v218, v219
    v_cvt_pk_bf16_f32 v210, v220, v221
    v_mfma_f32_32x32x16_bf16 v[176:191], a[196:199], a[56:59], v[176:191]
    ds_read_b64_tr_b16 a[184:185], v106 offset:49152
    ds_read_b64_tr_b16 a[186:187], v106 offset:49664
    buffer_load_dwordx4 a[24:27], v16, s[12:15], s66 offen offset:2048 sc1
    v_cvt_pk_bf16_f32 v211, v222, v223
    v_mul_f32 v229, v229, v44
    s_waitcnt lgkmcnt(10)
    v_mfma_f32_32x32x16_bf16 v[128:143], a[160:163], a[60:63], v[128:143]
    ds_read_b64_tr_b16 a[188:189], v107 offset:49152
    ds_read_b64_tr_b16 a[190:191], v107 offset:49664
    buffer_load_dwordx4 a[28:31], v16, s[12:15], s66 offen offset:3072 sc1
    v_exp_f32 v228, v228
    v_fma_f32 v227, v227, v45, v45
    v_rcp_f32 v226, v226
    v_mfma_f32_32x32x16_bf16 v[144:159], a[164:167], a[60:63], v[144:159]
    ds_read_b64_tr_b16 a[192:193], v104 offset:51200
    ds_read_b64_tr_b16 a[194:195], v104 offset:51712
    v_mul_f32 v233, v233, v225
    s_add_u32 s36, s71, 32768
    buffer_store_dwordx4 v[208:211], v2, s[12:15], s36 offen sc1
    v_mul_f32 v230, v230, v44
    s_waitcnt lgkmcnt(10)
    v_mfma_f32_32x32x16_bf16 v[160:175], a[168:171], a[60:63], v[160:175]
    ds_read_b64_tr_b16 a[196:197], v105 offset:51200
    ds_read_b64_tr_b16 a[198:199], v105 offset:51712
    buffer_load_dwordx4 a[32:35], v17, s[12:15], s66 offen offset:0 sc1
    v_exp_f32 v229, v229
    v_fma_f32 v228, v228, v45, v45
    v_mfma_f32_32x32x16_bf16 v[176:191], a[172:175], a[60:63], v[176:191]
    ds_read_b64_tr_b16 a[160:161], v106 offset:51200
    ds_read_b64_tr_b16 a[162:163], v106 offset:51712
    buffer_load_dwordx4 a[36:39], v17, s[12:15], s66 offen offset:1024 sc1
    v_rcp_f32 v227, v227
    v_mul_f32 v234, v234, v226
    s_waitcnt lgkmcnt(10)
    v_mfma_f32_32x32x16_bf16 v[128:143], a[176:179], a[64:67], v[128:143]
    ds_read_b64_tr_b16 a[164:165], v107 offset:51200
    ds_read_b64_tr_b16 a[166:167], v107 offset:51712
    s_add_u32 m0, s63, 16384
    s_nop 0
    buffer_load_dwordx4 v2, s[12:15], s68 offen offset:0 sc1 lds
    v_mul_f32 v231, v231, v44
    v_exp_f32 v230, v230
    v_fma_f32 v229, v229, v45, v45
    v_mfma_f32_32x32x16_bf16 v[144:159], a[180:183], a[64:67], v[144:159]
    ds_read_b64_tr_b16 a[168:169], v104 offset:53248
    ds_read_b64_tr_b16 a[170:171], v104 offset:53760
    v_rcp_f32 v228, v228
    v_mul_f32 v235, v235, v227
    s_waitcnt lgkmcnt(10)
    v_mfma_f32_32x32x16_bf16 v[160:175], a[184:187], a[64:67], v[160:175]
    ds_read_b64_tr_b16 a[172:173], v105 offset:53248
    ds_read_b64_tr_b16 a[174:175], v105 offset:53760
    buffer_load_dwordx4 v2, s[12:15], s68 offen offset:1024 sc1 lds
    v_mul_f32 v240, v240, v44
    v_exp_f32 v231, v231
    v_mfma_f32_32x32x16_bf16 v[176:191], a[188:191], a[64:67], v[176:191]
    ds_read_b64_tr_b16 a[176:177], v106 offset:53248
    ds_read_b64_tr_b16 a[178:179], v106 offset:53760
    buffer_load_dwordx4 v2, s[12:15], s68 offen offset:2048 sc1 lds
    v_fma_f32 v230, v230, v45, v45
    v_rcp_f32 v229, v229
    v_mul_f32 v236, v236, v228
    s_waitcnt lgkmcnt(10)
    v_mfma_f32_32x32x16_bf16 v[128:143], a[192:195], a[68:71], v[128:143]
    ds_read_b64_tr_b16 a[180:181], v107 offset:53248
    ds_read_b64_tr_b16 a[182:183], v107 offset:53760
    buffer_load_dwordx4 v2, s[12:15], s68 offen offset:3072 sc1 lds
    v_mul_f32 v241, v241, v44
    v_exp_f32 v240, v240
    v_mfma_f32_32x32x16_bf16 v[144:159], a[196:199], a[68:71], v[144:159]
    ds_read_b64_tr_b16 a[184:185], v104 offset:55296
    ds_read_b64_tr_b16 a[186:187], v104 offset:55808
    v_fma_f32 v231, v231, v45, v45
    v_rcp_f32 v230, v230
    s_waitcnt lgkmcnt(10)
    v_mfma_f32_32x32x16_bf16 v[160:175], a[160:163], a[68:71], v[160:175]
    ds_read_b64_tr_b16 a[188:189], v105 offset:55296
    ds_read_b64_tr_b16 a[190:191], v105 offset:55808
    v_mul_f32 v237, v237, v229
    v_mul_f32 v242, v242, v44
    v_exp_f32 v241, v241
    v_mfma_f32_32x32x16_bf16 v[176:191], a[164:167], a[68:71], v[176:191]
    ds_read_b64_tr_b16 a[192:193], v106 offset:55296
    ds_read_b64_tr_b16 a[194:195], v106 offset:55808
    v_fma_f32 v240, v240, v45, v45
    v_rcp_f32 v231, v231
    s_waitcnt lgkmcnt(10)
    v_mfma_f32_32x32x16_bf16 v[128:143], a[168:171], a[72:75], v[128:143]
    ds_read_b64_tr_b16 a[196:197], v107 offset:55296
    ds_read_b64_tr_b16 a[198:199], v107 offset:55808
    v_mul_f32 v238, v238, v230
    v_mul_f32 v243, v243, v44
    v_mfma_f32_32x32x16_bf16 v[144:159], a[172:175], a[72:75], v[144:159]
    s_barrier
    ds_read_b64_tr_b16 a[160:161], v20 offset:49152
    ds_read_b64_tr_b16 a[162:163], v20 offset:49664
    buffer_load_dword v7, v6, s[12:15], s57 offen offset:0 sc1
    v_exp_f32 v242, v242
    v_fma_f32 v241, v241, v45, v45
    s_waitcnt lgkmcnt(10)
    v_mfma_f32_32x32x16_bf16 v[160:175], a[176:179], a[72:75], v[160:175]
    ds_read_b64_tr_b16 a[164:165], v21 offset:49152
    ds_read_b64_tr_b16 a[166:167], v21 offset:49664
    buffer_load_dwordx4 a[40:43], v17, s[12:15], s66 offen offset:2048 sc1
    v_rcp_f32 v240, v240
    v_mul_f32 v239, v239, v231
    v_mul_f32 v244, v244, v44
    v_mfma_f32_32x32x16_bf16 v[176:191], a[180:183], a[72:75], v[176:191]
    ds_read_b64_tr_b16 a[168:169], v22 offset:49152
    ds_read_b64_tr_b16 a[170:171], v22 offset:49664
    buffer_load_dwordx4 a[44:47], v17, s[12:15], s66 offen offset:3072 sc1
    v_exp_f32 v243, v243
    v_fma_f32 v242, v242, v45, v45
    s_waitcnt lgkmcnt(10)
    v_mfma_f32_32x32x16_bf16 v[128:143], a[184:187], a[76:79], v[128:143]
    ds_read_b64_tr_b16 a[172:173], v23 offset:49152
    ds_read_b64_tr_b16 a[174:175], v23 offset:49664
    buffer_load_dwordx4 a[48:51], v18, s[12:15], s66 offen offset:0 sc1
    v_rcp_f32 v241, v241
    v_mul_f32 v248, v248, v240
    v_cvt_pk_bf16_f32 v224, v232, v233
    v_mfma_f32_32x32x16_bf16 v[144:159], a[188:191], a[76:79], v[144:159]
    ds_read_b64_tr_b16 a[176:177], v20 offset:51200
    ds_read_b64_tr_b16 a[178:179], v20 offset:51712
    v_cvt_pk_bf16_f32 v225, v234, v235
    v_cvt_pk_bf16_f32 v226, v236, v237
    v_cvt_pk_bf16_f32 v227, v238, v239
    v_mul_f32 v245, v245, v44
    s_waitcnt lgkmcnt(10)
    v_mfma_f32_32x32x16_bf16 v[160:175], a[192:195], a[76:79], v[160:175]
    ds_read_b64_tr_b16 a[180:181], v21 offset:51200
    ds_read_b64_tr_b16 a[182:183], v21 offset:51712
    buffer_load_dwordx4 a[52:55], v18, s[12:15], s66 offen offset:1024 sc1
    v_exp_f32 v244, v244
    v_fma_f32 v243, v243, v45, v45
    v_mfma_f32_32x32x16_bf16 v[176:191], a[196:199], a[76:79], v[176:191]
    ds_read_b64_tr_b16 a[184:185], v22 offset:51200
    ds_read_b64_tr_b16 a[186:187], v22 offset:51712
    buffer_load_dwordx4 a[56:59], v18, s[12:15], s66 offen offset:2048 sc1
    v_rcp_f32 v242, v242
    v_mul_f32 v249, v249, v241
    s_add_u32 s36, s72, 32768
    s_waitcnt lgkmcnt(10)
    v_mfma_f32_32x32x16_bf16 v[128:143], a[160:163], a[80:83], v[128:143]
    ds_read_b64_tr_b16 a[188:189], v23 offset:51200
    ds_read_b64_tr_b16 a[190:191], v23 offset:51712
    s_add_u32 m0, s63, 32768
    s_nop 0
    buffer_load_dwordx4 v16, s[12:15], s68 offen offset:0 sc1 lds
    buffer_store_dwordx4 v[224:227], v2, s[12:15], s36 offen sc1
    v_mul_f32 v246, v246, v44
    v_exp_f32 v245, v245
    v_mfma_f32_32x32x16_bf16 v[144:159], a[164:167], a[80:83], v[144:159]
    ds_read_b64_tr_b16 a[192:193], v20 offset:53248
    ds_read_b64_tr_b16 a[194:195], v20 offset:53760
    v_fma_f32 v244, v244, v45, v45
    v_rcp_f32 v243, v243
    s_waitcnt lgkmcnt(10)
    v_mfma_f32_32x32x16_bf16 v[160:175], a[168:171], a[80:83], v[160:175]
    ds_read_b64_tr_b16 a[196:197], v21 offset:53248
    ds_read_b64_tr_b16 a[198:199], v21 offset:53760
    buffer_load_dwordx4 v16, s[12:15], s68 offen offset:1024 sc1 lds
    v_mul_f32 v250, v250, v242
    v_mul_f32 v247, v247, v44
    v_mfma_f32_32x32x16_bf16 v[176:191], a[172:175], a[80:83], v[176:191]
    ds_read_b64_tr_b16 a[160:161], v22 offset:53248
    ds_read_b64_tr_b16 a[162:163], v22 offset:53760
    buffer_load_dwordx4 v16, s[12:15], s68 offen offset:2048 sc1 lds
    v_exp_f32 v246, v246
    v_fma_f32 v245, v245, v45, v45
    s_waitcnt lgkmcnt(10)
    v_mfma_f32_32x32x16_bf16 v[128:143], a[176:179], a[84:87], v[128:143]
    ds_read_b64_tr_b16 a[164:165], v23 offset:53248
    ds_read_b64_tr_b16 a[166:167], v23 offset:53760
    buffer_load_dwordx4 v16, s[12:15], s68 offen offset:3072 sc1 lds
    v_rcp_f32 v244, v244
    v_mul_f32 v251, v251, v243
    v_exp_f32 v247, v247
    v_mfma_f32_32x32x16_bf16 v[144:159], a[180:183], a[84:87], v[144:159]
    ds_read_b64_tr_b16 a[168:169], v20 offset:55296
    ds_read_b64_tr_b16 a[170:171], v20 offset:55808
    v_fma_f32 v246, v246, v45, v45
    v_rcp_f32 v245, v245
    s_waitcnt lgkmcnt(10)
    v_mfma_f32_32x32x16_bf16 v[160:175], a[184:187], a[84:87], v[160:175]
    ds_read_b64_tr_b16 a[172:173], v21 offset:55296
    ds_read_b64_tr_b16 a[174:175], v21 offset:55808
    v_mul_f32 v252, v252, v244
    v_fma_f32 v247, v247, v45, v45
    v_mfma_f32_32x32x16_bf16 v[176:191], a[188:191], a[84:87], v[176:191]
    ds_read_b64_tr_b16 a[176:177], v22 offset:55296
    ds_read_b64_tr_b16 a[178:179], v22 offset:55808
    v_rcp_f32 v246, v246
    v_mul_f32 v253, v253, v245
    v_rcp_f32 v247, v247
    s_waitcnt lgkmcnt(10)
    v_mfma_f32_32x32x16_bf16 v[128:143], a[192:195], a[88:91], v[128:143]
    ds_read_b64_tr_b16 a[180:181], v23 offset:55296
    ds_read_b64_tr_b16 a[182:183], v23 offset:55808
    v_mul_f32 v254, v254, v246
    v_mul_f32 v255, v255, v247
    v_cvt_pk_bf16_f32 v240, v248, v249
    v_mfma_f32_32x32x16_bf16 v[144:159], a[196:199], a[88:91], v[144:159]
    s_barrier
    ds_read_b64_tr_b16 a[184:185], v24 offset:0
    ds_read_b64_tr_b16 a[186:187], v24 offset:512
    buffer_load_dword v75, v34, s[12:15], 0 offen offset:256 sc1
    v_cvt_pk_bf16_f32 v241, v250, v251
    v_cvt_pk_bf16_f32 v242, v252, v253
    v_cvt_pk_bf16_f32 v243, v254, v255
    s_add_u32 s36, s73, 32768
    s_waitcnt lgkmcnt(10)
    v_mfma_f32_32x32x16_bf16 v[160:175], a[160:163], a[88:91], v[160:175]
    ds_read_b64_tr_b16 a[188:189], v25 offset:0
    ds_read_b64_tr_b16 a[190:191], v25 offset:512
    buffer_load_dwordx4 a[60:63], v18, s[12:15], s66 offen offset:3072 sc1
    buffer_store_dwordx4 v[240:243], v2, s[12:15], s36 offen sc1
    v_mfma_f32_32x32x16_bf16 v[176:191], a[164:167], a[88:91], v[176:191]
    ds_read_b64_tr_b16 a[192:193], v26 offset:0
    ds_read_b64_tr_b16 a[194:195], v26 offset:512
    buffer_load_dwordx4 a[64:67], v19, s[12:15], s66 offen offset:0 sc1
    s_waitcnt lgkmcnt(10)
    v_mfma_f32_32x32x16_bf16 v[128:143], a[168:171], a[92:95], v[128:143]
    ds_read_b64_tr_b16 a[196:197], v27 offset:0
    ds_read_b64_tr_b16 a[198:199], v27 offset:512
    buffer_load_dwordx4 a[68:71], v19, s[12:15], s66 offen offset:1024 sc1
    v_mfma_f32_32x32x16_bf16 v[144:159], a[172:175], a[92:95], v[144:159]
    ds_read_b64_tr_b16 a[160:161], v24 offset:2048
    ds_read_b64_tr_b16 a[162:163], v24 offset:2560
    s_waitcnt lgkmcnt(10)
    v_mfma_f32_32x32x16_bf16 v[160:175], a[176:179], a[92:95], v[160:175]
    ds_read_b64_tr_b16 a[164:165], v25 offset:2048
    ds_read_b64_tr_b16 a[166:167], v25 offset:2560
    buffer_load_dwordx4 a[72:75], v19, s[12:15], s66 offen offset:2048 sc1
    v_mfma_f32_32x32x16_bf16 v[176:191], a[180:183], a[92:95], v[176:191]
    ds_read_b64_tr_b16 a[168:169], v26 offset:2048
    ds_read_b64_tr_b16 a[170:171], v26 offset:2560
    buffer_load_dwordx4 a[76:79], v19, s[12:15], s66 offen offset:3072 sc1
    s_waitcnt lgkmcnt(10)
    v_mfma_f32_32x32x16_bf16 v[128:143], a[184:187], a[96:99], v[128:143]
    ds_read_b64_tr_b16 a[172:173], v27 offset:2048
    ds_read_b64_tr_b16 a[174:175], v27 offset:2560
    s_add_u32 m0, s63, 49152
    s_nop 0
    buffer_load_dwordx4 v17, s[12:15], s68 offen offset:0 sc1 lds
    v_mfma_f32_32x32x16_bf16 v[144:159], a[188:191], a[96:99], v[144:159]
    ds_read_b64_tr_b16 a[176:177], v24 offset:4096
    ds_read_b64_tr_b16 a[178:179], v24 offset:4608
    s_waitcnt lgkmcnt(10)
    v_mfma_f32_32x32x16_bf16 v[160:175], a[192:195], a[96:99], v[160:175]
    ds_read_b64_tr_b16 a[180:181], v25 offset:4096
    ds_read_b64_tr_b16 a[182:183], v25 offset:4608
    buffer_load_dwordx4 v17, s[12:15], s68 offen offset:1024 sc1 lds
    v_mfma_f32_32x32x16_bf16 v[176:191], a[196:199], a[96:99], v[176:191]
    ds_read_b64_tr_b16 a[184:185], v26 offset:4096
    ds_read_b64_tr_b16 a[186:187], v26 offset:4608
    buffer_load_dwordx4 v17, s[12:15], s68 offen offset:2048 sc1 lds
    s_waitcnt lgkmcnt(10)
    v_mfma_f32_32x32x16_bf16 v[128:143], a[160:163], a[100:103], v[128:143]
    ds_read_b64_tr_b16 a[188:189], v27 offset:4096
    ds_read_b64_tr_b16 a[190:191], v27 offset:4608
    buffer_load_dwordx4 v17, s[12:15], s68 offen offset:3072 sc1 lds
    v_mfma_f32_32x32x16_bf16 v[144:159], a[164:167], a[100:103], v[144:159]
    ds_read_b64_tr_b16 a[192:193], v24 offset:6144
    ds_read_b64_tr_b16 a[194:195], v24 offset:6656
    s_waitcnt lgkmcnt(10)
    v_mfma_f32_32x32x16_bf16 v[160:175], a[168:171], a[100:103], v[160:175]
    ds_read_b64_tr_b16 a[196:197], v25 offset:6144
    ds_read_b64_tr_b16 a[198:199], v25 offset:6656
    v_mfma_f32_32x32x16_bf16 v[176:191], a[172:175], a[100:103], v[176:191]
    ds_read_b64_tr_b16 a[160:161], v26 offset:6144
    ds_read_b64_tr_b16 a[162:163], v26 offset:6656
    s_waitcnt lgkmcnt(10)
    v_mfma_f32_32x32x16_bf16 v[128:143], a[176:179], a[104:107], v[128:143]
    ds_read_b64_tr_b16 a[164:165], v27 offset:6144
    ds_read_b64_tr_b16 a[166:167], v27 offset:6656
    v_mfma_f32_32x32x16_bf16 v[144:159], a[180:183], a[104:107], v[144:159]
    s_waitcnt vmcnt(8)
    s_barrier
    ds_read_b64_tr_b16 a[168:169], v24 offset:16384
    ds_read_b64_tr_b16 a[170:171], v24 offset:16896
    buffer_store_dword a255, v15, s[12:15], s77 offen offset:128 sc1
    s_waitcnt lgkmcnt(10)
    v_mfma_f32_32x32x16_bf16 v[160:175], a[184:187], a[104:107], v[160:175]
    ds_read_b64_tr_b16 a[172:173], v25 offset:16384
    ds_read_b64_tr_b16 a[174:175], v25 offset:16896
    v_cmp_ne_u32 vcc, 1, v7
    s_nop 0
    s_and_b32 s58, vcc_lo, 0xff
    s_cbranch_scc1 L_slow_p0g
L_back_p0g:
    s_add_u32 s46, s44, 0
    buffer_load_dwordx4 v[192:195], v29, s[12:15], s46 offen offset:0 sc1
    v_mfma_f32_32x32x16_bf16 v[176:191], a[188:191], a[104:107], v[176:191]
    ds_read_b64_tr_b16 a[176:177], v26 offset:16384
    ds_read_b64_tr_b16 a[178:179], v26 offset:16896
    buffer_load_dwordx4 v[196:199], v30, s[12:15], s46 offen offset:0 sc1
    s_waitcnt lgkmcnt(10)
    v_mfma_f32_32x32x16_bf16 v[128:143], a[192:195], a[108:111], v[128:143]
    ds_read_b64_tr_b16 a[180:181], v27 offset:16384
    ds_read_b64_tr_b16 a[182:183], v27 offset:16896
    buffer_load_dwordx4 v[200:203], v31, s[12:15], s46 offen offset:0 sc1
    v_mfma_f32_32x32x16_bf16 v[144:159], a[196:199], a[108:111], v[144:159]
    ds_read_b64_tr_b16 a[184:185], v24 offset:18432
    ds_read_b64_tr_b16 a[186:187], v24 offset:18944
    s_waitcnt lgkmcnt(10)
    v_mfma_f32_32x32x16_bf16 v[160:175], a[160:163], a[108:111], v[160:175]
    ds_read_b64_tr_b16 a[188:189], v25 offset:18432
    ds_read_b64_tr_b16 a[190:191], v25 offset:18944
    buffer_load_dwordx4 v[204:207], v32, s[12:15], s46 offen offset:0 sc1
    v_mfma_f32_32x32x16_bf16 v[176:191], a[164:167], a[108:111], v[176:191]
    ds_read_b64_tr_b16 a[192:193], v26 offset:18432
    ds_read_b64_tr_b16 a[194:195], v26 offset:18944
    buffer_load_dwordx4 v[208:211], v29, s[12:15], s46 offen offset:2048 sc1
    s_waitcnt lgkmcnt(10)
    v_mfma_f32_32x32x16_bf16 v[128:143], a[168:171], a[112:115], v[128:143]
    ds_read_b64_tr_b16 a[196:197], v27 offset:18432
    ds_read_b64_tr_b16 a[198:199], v27 offset:18944
    buffer_load_dwordx4 v[212:215], v30, s[12:15], s46 offen offset:2048 sc1
    v_mfma_f32_32x32x16_bf16 v[144:159], a[172:175], a[112:115], v[144:159]
    ds_read_b64_tr_b16 a[160:161], v24 offset:20480
    ds_read_b64_tr_b16 a[162:163], v24 offset:20992
    s_waitcnt lgkmcnt(10)
    v_mfma_f32_32x32x16_bf16 v[160:175], a[176:179], a[112:115], v[160:175]
    ds_read_b64_tr_b16 a[164:165], v25 offset:20480
    ds_read_b64_tr_b16 a[166:167], v25 offset:20992
    buffer_load_dwordx4 v[216:219], v31, s[12:15], s46 offen offset:2048 sc1
    v_mfma_f32_32x32x16_bf16 v[176:191], a[180:183], a[112:115], v[176:191]
    ds_read_b64_tr_b16 a[168:169], v26 offset:20480
    ds_read_b64_tr_b16 a[170:171], v26 offset:20992
    buffer_load_dwordx4 v[220:223], v32, s[12:15], s46 offen offset:2048 sc1
    s_waitcnt lgkmcnt(10)
    v_mfma_f32_32x32x16_bf16 v[128:143], a[184:187], a[116:119], v[128:143]
    ds_read_b64_tr_b16 a[172:173], v27 offset:20480
    ds_read_b64_tr_b16 a[174:175], v27 offset:20992
    v_mfma_f32_32x32x16_bf16 v[144:159], a[188:191], a[116:119], v[144:159]
    ds_read_b64_tr_b16 a[176:177], v24 offset:22528
    ds_read_b64_tr_b16 a[178:179], v24 offset:23040
    s_waitcnt lgkmcnt(10)
    v_mfma_f32_32x32x16_bf16 v[160:175], a[192:195], a[116:119], v[160:175]
    ds_read_b64_tr_b16 a[180:181], v25 offset:22528
    ds_read_b64_tr_b16 a[182:183], v25 offset:23040
    v_mfma_f32_32x32x16_bf16 v[176:191], a[196:199], a[116:119], v[176:191]
    ds_read_b64_tr_b16 a[184:185], v26 offset:22528
    ds_read_b64_tr_b16 a[186:187], v26 offset:23040
    s_waitcnt lgkmcnt(10)
    v_mfma_f32_32x32x16_bf16 v[128:143], a[160:163], a[120:123], v[128:143]
    ds_read_b64_tr_b16 a[188:189], v27 offset:22528
    ds_read_b64_tr_b16 a[190:191], v27 offset:23040
    v_mfma_f32_32x32x16_bf16 v[144:159], a[164:167], a[120:123], v[144:159]
    s_barrier
    ds_read_b64_tr_b16 a[192:193], v20 offset:0
    ds_read_b64_tr_b16 a[194:195], v20 offset:512
    v_cmp_ne_u32 vcc, 1, v75
    s_nop 0
    s_and_b32 s58, vcc_lo, 0x3ff
    s_cbranch_scc1 L_slow_cs2g
L_back_cs2g:
    buffer_load_dword v68, v35, s[12:15], s48 offen offset:1024 sc1
    s_waitcnt lgkmcnt(10)
    v_mfma_f32_32x32x16_bf16 v[160:175], a[168:171], a[120:123], v[160:175]
    ds_read_b64_tr_b16 a[196:197], v21 offset:0
    ds_read_b64_tr_b16 a[198:199], v21 offset:512
    buffer_load_dword v69, v35, s[12:15], s49 offen offset:1024 sc1
    v_mfma_f32_32x32x16_bf16 v[176:191], a[172:175], a[120:123], v[176:191]
    ds_read_b64_tr_b16 a[160:161], v22 offset:0
    ds_read_b64_tr_b16 a[162:163], v22 offset:512
    buffer_load_dword v70, v35, s[12:15], s50 offen offset:1024 sc1
    s_waitcnt lgkmcnt(10)
    v_mfma_f32_32x32x16_bf16 v[128:143], a[176:179], a[124:127], v[128:143]
    ds_read_b64_tr_b16 a[164:165], v23 offset:0
    ds_read_b64_tr_b16 a[166:167], v23 offset:512
    buffer_load_dword v71, v35, s[12:15], s51 offen offset:1024 sc1
    v_mfma_f32_32x32x16_bf16 v[144:159], a[180:183], a[124:127], v[144:159]
    ds_read_b64_tr_b16 a[168:169], v20 offset:2048
    ds_read_b64_tr_b16 a[170:171], v20 offset:2560
    s_waitcnt lgkmcnt(10)
    v_mfma_f32_32x32x16_bf16 v[160:175], a[184:187], a[124:127], v[160:175]
    ds_read_b64_tr_b16 a[172:173], v21 offset:2048
    ds_read_b64_tr_b16 a[174:175], v21 offset:2560
    s_add_u32 s46, s46, 4096
    buffer_load_dwordx4 v[224:227], v29, s[12:15], s46 offen offset:0 sc1
    v_mfma_f32_32x32x16_bf16 v[176:191], a[188:191], a[124:127], v[176:191]
    ds_read_b64_tr_b16 a[176:177], v22 offset:2048
    ds_read_b64_tr_b16 a[178:179], v22 offset:2560
    buffer_load_dwordx4 v[228:231], v30, s[12:15], s46 offen offset:0 sc1
    s_waitcnt lgkmcnt(10)
    v_mfma_f32_32x32x16_bf16 v[128:143], a[192:195], a[128:131], v[128:143]
    ds_read_b64_tr_b16 a[180:181], v23 offset:2048
    ds_read_b64_tr_b16 a[182:183], v23 offset:2560
    buffer_load_dwordx4 v[232:235], v31, s[12:15], s46 offen offset:0 sc1
    v_mfma_f32_32x32x16_bf16 v[144:159], a[196:199], a[128:131], v[144:159]
    ds_read_b64_tr_b16 a[184:185], v20 offset:4096
    ds_read_b64_tr_b16 a[186:187], v20 offset:4608
    s_waitcnt lgkmcnt(10)
    v_mfma_f32_32x32x16_bf16 v[160:175], a[160:163], a[128:131], v[160:175]
    ds_read_b64_tr_b16 a[188:189], v21 offset:4096
    ds_read_b64_tr_b16 a[190:191], v21 offset:4608
    buffer_load_dwordx4 v[236:239], v32, s[12:15], s46 offen offset:0 sc1
    v_mfma_f32_32x32x16_bf16 v[176:191], a[164:167], a[128:131], v[176:191]
    ds_read_b64_tr_b16 a[192:193], v22 offset:4096
    ds_read_b64_tr_b16 a[194:195], v22 offset:4608
    buffer_load_dwordx4 v[240:243], v29, s[12:15], s46 offen offset:2048 sc1
    s_waitcnt lgkmcnt(10)
    v_mfma_f32_32x32x16_bf16 v[128:143], a[168:171], a[132:135], v[128:143]
    ds_read_b64_tr_b16 a[196:197], v23 offset:4096
    ds_read_b64_tr_b16 a[198:199], v23 offset:4608
    buffer_load_dwordx4 v[244:247], v30, s[12:15], s46 offen offset:2048 sc1
    v_mfma_f32_32x32x16_bf16 v[144:159], a[172:175], a[132:135], v[144:159]
    ds_read_b64_tr_b16 a[160:161], v20 offset:6144
    ds_read_b64_tr_b16 a[162:163], v20 offset:6656
    s_waitcnt lgkmcnt(10)
    v_mfma_f32_32x32x16_bf16 v[160:175], a[176:179], a[132:135], v[160:175]
    ds_read_b64_tr_b16 a[164:165], v21 offset:6144
    ds_read_b64_tr_b16 a[166:167], v21 offset:6656
    buffer_load_dwordx4 v[248:251], v31, s[12:15], s46 offen offset:2048 sc1
    v_mfma_f32_32x32x16_bf16 v[176:191], a[180:183], a[132:135], v[176:191]
    ds_read_b64_tr_b16 a[168:169], v22 offset:6144
    ds_read_b64_tr_b16 a[170:171], v22 offset:6656
    buffer_load_dwordx4 v[252:255], v32, s[12:15], s46 offen offset:2048 sc1
    s_waitcnt lgkmcnt(10)
    v_mfma_f32_32x32x16_bf16 v[128:143], a[184:187], a[136:139], v[128:143]
    ds_read_b64_tr_b16 a[172:173], v23 offset:6144
    ds_read_b64_tr_b16 a[174:175], v23 offset:6656
    v_mfma_f32_32x32x16_bf16 v[144:159], a[188:191], a[136:139], v[144:159]
    s_barrier
    ds_read_b64_tr_b16 a[176:177], v20 offset:16384
    ds_read_b64_tr_b16 a[178:179], v20 offset:16896
    buffer_load_dwordx4 a[80:83], v2, s[12:15], s67 offen offset:0 sc1
    s_waitcnt lgkmcnt(10)
    v_mfma_f32_32x32x16_bf16 v[160:175], a[192:195], a[136:139], v[160:175]
    ds_read_b64_tr_b16 a[180:181], v20 offset:18432
    ds_read_b64_tr_b16 a[182:183], v20 offset:18944
    buffer_load_dwordx4 a[84:87], v2, s[12:15], s67 offen offset:1024 sc1
    v_mfma_f32_32x32x16_bf16 v[176:191], a[196:199], a[136:139], v[176:191]
    ds_read_b64_tr_b16 a[184:185], v20 offset:20480
    ds_read_b64_tr_b16 a[186:187], v20 offset:20992
    buffer_load_dwordx4 a[88:91], v2, s[12:15], s67 offen offset:2048 sc1
    s_waitcnt lgkmcnt(10)
    v_mfma_f32_32x32x16_bf16 v[128:143], a[160:163], a[140:143], v[128:143]
    ds_read_b64_tr_b16 a[188:189], v20 offset:22528
    ds_read_b64_tr_b16 a[190:191], v20 offset:23040
    buffer_load_dwordx4 a[92:95], v2, s[12:15], s67 offen offset:3072 sc1
    v_mfma_f32_32x32x16_bf16 v[144:159], a[164:167], a[140:143], v[144:159]
    ds_read_b64_tr_b16 a[192:193], v21 offset:16384
    ds_read_b64_tr_b16 a[194:195], v21 offset:16896
    s_waitcnt lgkmcnt(10)
    v_mfma_f32_32x32x16_bf16 v[160:175], a[168:171], a[140:143], v[160:175]
    ds_read_b64_tr_b16 a[196:197], v21 offset:18432
    ds_read_b64_tr_b16 a[198:199], v21 offset:18944
    buffer_load_dwordx4 a[96:99], v16, s[12:15], s67 offen offset:0 sc1
    v_mfma_f32_32x32x16_bf16 v[176:191], a[172:175], a[140:143], v[176:191]
    ds_read_b64_tr_b16 a[160:161], v21 offset:20480
    ds_read_b64_tr_b16 a[162:163], v21 offset:20992
    s_add_u32 m0, s63, 114688
    s_nop 0
    buffer_load_dwordx4 v18, s[12:15], s68 offen offset:0 sc1 lds
    s_waitcnt lgkmcnt(10)
    v_mfma_f32_32x32x16_bf16 v[128:143], a[176:179], a[144:147], v[128:143]
    ds_read_b64_tr_b16 a[164:165], v21 offset:22528
    ds_read_b64_tr_b16 a[166:167], v21 offset:23040
    buffer_load_dwordx4 v18, s[12:15], s68 offen offset:1024 sc1 lds
    s_waitcnt vmcnt(18)
    v_cvt_pk_bf16_f32 v72, v68, v68
    v_lshlrev_b32 v74, 16, v72
    v_sub_f32 v73, v68, v74
    v_mfma_f32_32x32x16_bf16 v[128:143], a[180:183], a[148:151], v[128:143]
    ds_read_b64_tr_b16 a[168:169], v22 offset:16384
    ds_read_b64_tr_b16 a[170:171], v22 offset:16896
    v_mov_b32 v52, v72
    v_cvt_pk_bf16_f32 v53, v68, v73
    v_and_b32 v74, 0xffff0000, v53
    s_waitcnt lgkmcnt(10)
    v_mfma_f32_32x32x16_bf16 v[128:143], a[184:187], a[152:155], v[128:143]
    ds_read_b64_tr_b16 a[172:173], v22 offset:18432
    ds_read_b64_tr_b16 a[174:175], v22 offset:18944
    buffer_load_dwordx4 v18, s[12:15], s68 offen offset:2048 sc1 lds
    v_sub_f32 v74, v73, v74
    v_cvt_pk_bf16_f32 v54, v73, v74
    v_mov_b32 v55, 0
    v_mfma_f32_32x32x16_bf16 v[128:143], a[188:191], a[156:159], v[128:143]
    ds_read_b64_tr_b16 a[176:177], v22 offset:20480
    ds_read_b64_tr_b16 a[178:179], v22 offset:20992
    buffer_load_dwordx4 v18, s[12:15], s68 offen offset:3072 sc1 lds
    s_waitcnt vmcnt(19)
    v_cvt_pk_bf16_f32 v72, v69, v69
    v_lshlrev_b32 v74, 16, v72
    v_sub_f32 v73, v69, v74
    s_waitcnt lgkmcnt(10)
    v_mfma_f32_32x32x16_bf16 v[144:159], a[192:195], a[144:147], v[144:159]
    ds_read_b64_tr_b16 a[180:181], v22 offset:22528
    ds_read_b64_tr_b16 a[182:183], v22 offset:23040
    v_mov_b32 v56, v72
    v_cvt_pk_bf16_f32 v57, v69, v73
    v_and_b32 v74, 0xffff0000, v57
    v_mfma_f32_32x32x16_bf16 v[144:159], a[196:199], a[148:151], v[144:159]
    ds_read_b64_tr_b16 a[184:185], v23 offset:16384
    ds_read_b64_tr_b16 a[186:187], v23 offset:16896
    v_sub_f32 v74, v73, v74
    v_cvt_pk_bf16_f32 v58, v73, v74
    v_mov_b32 v59, 0
    s_waitcnt lgkmcnt(10)
    v_mfma_f32_32x32x16_bf16 v[144:159], a[160:163], a[152:155], v[144:159]
    ds_read_b64_tr_b16 a[188:189], v23 offset:18432
    ds_read_b64_tr_b16 a[190:191], v23 offset:18944
    s_waitcnt vmcnt(18)
    v_cvt_pk_bf16_f32 v72, v70, v70
    v_lshlrev_b32 v74, 16, v72
    v_sub_f32 v73, v70, v74
    v_mfma_f32_32x32x16_bf16 v[144:159], a[164:167], a[156:159], v[144:159]
    ds_read_b64_tr_b16 a[192:193], v23 offset:20480
    ds_read_b64_tr_b16 a[194:195], v23 offset:20992
    v_mov_b32 v60, v72
    v_cvt_pk_bf16_f32 v61, v70, v73
    v_and_b32 v74, 0xffff0000, v61
    s_waitcnt lgkmcnt(10)
    v_mfma_f32_32x32x16_bf16 v[160:175], a[168:171], a[144:147], v[160:175]
    ds_read_b64_tr_b16 a[196:197], v23 offset:22528
    ds_read_b64_tr_b16 a[198:199], v23 offset:23040
    v_sub_f32 v74, v73, v74
    v_cvt_pk_bf16_f32 v62, v73, v74
    v_mov_b32 v63, 0
    v_mfma_f32_32x32x16_bf16 v[160:175], a[172:175], a[148:151], v[160:175]
    s_waitcnt vmcnt(17)
    v_cvt_pk_bf16_f32 v72, v71, v71
    v_lshlrev_b32 v74, 16, v72
    v_sub_f32 v73, v71, v74
    s_waitcnt lgkmcnt(8)
    v_mfma_f32_32x32x16_bf16 v[160:175], a[176:179], a[152:155], v[160:175]
    v_mov_b32 v64, v72
    v_cvt_pk_bf16_f32 v65, v71, v73
    v_and_b32 v74, 0xffff0000, v65
    v_mfma_f32_32x32x16_bf16 v[160:175], a[180:183], a[156:159], v[160:175]
    v_sub_f32 v74, v73, v74
    v_cvt_pk_bf16_f32 v66, v73, v74
    v_mov_b32 v67, 0
    s_waitcnt lgkmcnt(4)
    v_mfma_f32_32x32x16_bf16 v[176:191], a[184:187], a[144:147], v[176:191]
    buffer_load_dword v8, v6, s[12:15], s57 offen offset:128 sc1
    v_mfma_f32_32x32x16_bf16 v[128:143], v[52:55], v[40:43], v[128:143]
    v_mfma_f32_32x32x16_bf16 v[144:159], v[56:59], v[40:43], v[144:159]
    v_mfma_f32_32x32x16_bf16 v[176:191], a[188:191], a[148:151], v[176:191]
    v_mfma_f32_32x32x16_bf16 v[160:175], v[60:63], v[40:43], v[160:175]
    s_waitcnt lgkmcnt(0)
    v_mfma_f32_32x32x16_bf16 v[176:191], a[192:195], a[152:155], v[176:191]
    v_mfma_f32_32x32x16_bf16 v[176:191], a[196:199], a[156:159], v[176:191]
    v_mfma_f32_32x32x16_bf16 v[176:191], v[64:67], v[40:43], v[176:191]
    s_nop 4
    v_pk_mul_f32 v[128:129], v[128:129], v[44:45] op_sel_hi:[1,0]
    v_pk_mul_f32 v[130:131], v[130:131], v[44:45] op_sel_hi:[1,0]
    v_pk_mul_f32 v[132:133], v[132:133], v[44:45] op_sel_hi:[1,0]
    v_pk_mul_f32 v[134:135], v[134:135], v[44:45] op_sel_hi:[1,0]
    v_exp_f32 v128, v128
    v_exp_f32 v129, v129
    v_exp_f32 v130, v130
    v_exp_f32 v131, v131
    v_exp_f32 v132, v132
    v_exp_f32 v133, v133
    v_exp_f32 v134, v134
    v_exp_f32 v135, v135
    v_pk_fma_f32 v[128:129], v[128:129], v[44:45], v[44:45] op_sel:[0,1,1] op_sel_hi:[1,1,1]
    v_pk_fma_f32 v[130:131], v[130:131], v[44:45], v[44:45] op_sel:[0,1,1] op_sel_hi:[1,1,1]
    v_pk_fma_f32 v[132:133], v[132:133], v[44:45], v[44:45] op_sel:[0,1,1] op_sel_hi:[1,1,1]
    v_pk_fma_f32 v[134:135], v[134:135], v[44:45], v[44:45] op_sel:[0,1,1] op_sel_hi:[1,1,1]
    v_rcp_f32 v128, v128
    v_rcp_f32 v129, v129
    v_rcp_f32 v130, v130
    v_rcp_f32 v131, v131
    v_rcp_f32 v132, v132
    v_rcp_f32 v133, v133
    v_rcp_f32 v134, v134
    v_rcp_f32 v135, v135
    v_pk_mul_f32 v[136:137], v[136:137], v[128:129]
    v_pk_mul_f32 v[138:139], v[138:139], v[130:131]
    v_pk_mul_f32 v[140:141], v[140:141], v[132:133]
    v_pk_mul_f32 v[142:143], v[142:143], v[134:135]
    v_cvt_pk_bf16_f32 v128, v136, v137
    v_cvt_pk_bf16_f32 v129, v138, v139
    v_cvt_pk_bf16_f32 v130, v140, v141
    v_cvt_pk_bf16_f32 v131, v142, v143
    s_add_u32 s36, s70, 65536
    buffer_store_dwordx4 v[128:131], v2, s[12:15], s36 offen sc1
    s_waitcnt vmcnt(1)
    v_cmp_ne_u32 vcc, 1, v8
    s_nop 0
    s_and_b32 s58, vcc_lo, 0xff
    s_cselect_b32 s26, 0, 16777216
    v_pk_mul_f32 v[144:145], v[144:145], v[44:45] op_sel_hi:[1,0]
    s_add_u32 s46, s44, 32768
    buffer_load_dwordx4 v[64:67], v29, s[24:27], s46 offen offset:0 sc1
    v_pk_mul_f32 v[146:147], v[146:147], v[44:45] op_sel_hi:[1,0]
    v_pk_mul_f32 v[148:149], v[148:149], v[44:45] op_sel_hi:[1,0]
    v_pk_mul_f32 v[150:151], v[150:151], v[44:45] op_sel_hi:[1,0]
    v_exp_f32 v144, v144
    v_exp_f32 v145, v145
    v_exp_f32 v146, v146
    v_exp_f32 v147, v147
    buffer_load_dwordx4 v[68:71], v30, s[24:27], s46 offen offset:0 sc1
    v_exp_f32 v148, v148
    v_exp_f32 v149, v149
    v_exp_f32 v150, v150
    v_exp_f32 v151, v151
    v_pk_fma_f32 v[144:145], v[144:145], v[44:45], v[44:45] op_sel:[0,1,1] op_sel_hi:[1,1,1]
    v_pk_fma_f32 v[146:147], v[146:147], v[44:45], v[44:45] op_sel:[0,1,1] op_sel_hi:[1,1,1]
    buffer_load_dwordx4 v[72:75], v31, s[24:27], s46 offen offset:0 sc1
    v_pk_fma_f32 v[148:149], v[148:149], v[44:45], v[44:45] op_sel:[0,1,1] op_sel_hi:[1,1,1]
    v_pk_fma_f32 v[150:151], v[150:151], v[44:45], v[44:45] op_sel:[0,1,1] op_sel_hi:[1,1,1]
    v_rcp_f32 v144, v144
    v_rcp_f32 v145, v145
    v_rcp_f32 v146, v146
    v_rcp_f32 v147, v147
    buffer_load_dwordx4 v[76:79], v32, s[24:27], s46 offen offset:0 sc1
    v_rcp_f32 v148, v148
    v_rcp_f32 v149, v149
    v_rcp_f32 v150, v150
    v_rcp_f32 v151, v151
    v_pk_mul_f32 v[152:153], v[152:153], v[144:145]
    v_pk_mul_f32 v[154:155], v[154:155], v[146:147]
    buffer_load_dwordx4 v[80:83], v29, s[24:27], s46 offen offset:2048 sc1
    v_pk_mul_f32 v[156:157], v[156:157], v[148:149]
    v_pk_mul_f32 v[158:159], v[158:159], v[150:151]
    v_cvt_pk_bf16_f32 v144, v152, v153
    v_cvt_pk_bf16_f32 v145, v154, v155
    v_cvt_pk_bf16_f32 v146, v156, v157
    v_cvt_pk_bf16_f32 v147, v158, v159
    s_add_u32 s36, s71, 65536
    buffer_store_dwordx4 v[144:147], v2, s[12:15], s36 offen sc1
    v_pk_mul_f32 v[160:161], v[160:161], v[44:45] op_sel_hi:[1,0]
    buffer_load_dwordx4 v[84:87], v30, s[24:27], s46 offen offset:2048 sc1
    v_pk_mul_f32 v[162:163], v[162:163], v[44:45] op_sel_hi:[1,0]
    v_pk_mul_f32 v[164:165], v[164:165], v[44:45] op_sel_hi:[1,0]
    v_pk_mul_f32 v[166:167], v[166:167], v[44:45] op_sel_hi:[1,0]
    v_exp_f32 v160, v160
    v_exp_f32 v161, v161
    v_exp_f32 v162, v162
    v_exp_f32 v163, v163
    buffer_load_dwordx4 v[88:91], v31, s[24:27], s46 offen offset:2048 sc1
    v_exp_f32 v164, v164
    v_exp_f32 v165, v165
    v_exp_f32 v166, v166
    v_exp_f32 v167, v167
    v_pk_fma_f32 v[160:161], v[160:161], v[44:45], v[44:45] op_sel:[0,1,1] op_sel_hi:[1,1,1]
    v_pk_fma_f32 v[162:163], v[162:163], v[44:45], v[44:45] op_sel:[0,1,1] op_sel_hi:[1,1,1]
    buffer_load_dwordx4 v[92:95], v32, s[24:27], s46 offen offset:2048 sc1
    v_pk_fma_f32 v[164:165], v[164:165], v[44:45], v[44:45] op_sel:[0,1,1] op_sel_hi:[1,1,1]
    v_pk_fma_f32 v[166:167], v[166:167], v[44:45], v[44:45] op_sel:[0,1,1] op_sel_hi:[1,1,1]
    v_rcp_f32 v160, v160
    v_rcp_f32 v161, v161
    v_rcp_f32 v162, v162
    v_rcp_f32 v163, v163
    s_add_u32 s46, s46, 4096
    buffer_load_dwordx4 v[96:99], v29, s[24:27], s46 offen offset:0 sc1
    v_rcp_f32 v164, v164
    v_rcp_f32 v165, v165
    v_rcp_f32 v166, v166
    v_rcp_f32 v167, v167
    v_pk_mul_f32 v[168:169], v[168:169], v[160:161]
    v_pk_mul_f32 v[170:171], v[170:171], v[162:163]
    buffer_load_dwordx4 v[100:103], v30, s[24:27], s46 offen offset:0 sc1
    v_pk_mul_f32 v[172:173], v[172:173], v[164:165]
    v_pk_mul_f32 v[174:175], v[174:175], v[166:167]
    v_cvt_pk_bf16_f32 v160, v168, v169
    v_cvt_pk_bf16_f32 v161, v170, v171
    v_cvt_pk_bf16_f32 v162, v172, v173
    v_cvt_pk_bf16_f32 v163, v174, v175
    s_add_u32 s36, s72, 65536
    buffer_store_dwordx4 v[160:163], v2, s[12:15], s36 offen sc1
    v_pk_mul_f32 v[176:177], v[176:177], v[44:45] op_sel_hi:[1,0]
    buffer_load_dwordx4 v[104:107], v31, s[24:27], s46 offen offset:0 sc1
    v_pk_mul_f32 v[178:179], v[178:179], v[44:45] op_sel_hi:[1,0]
    v_pk_mul_f32 v[180:181], v[180:181], v[44:45] op_sel_hi:[1,0]
    v_pk_mul_f32 v[182:183], v[182:183], v[44:45] op_sel_hi:[1,0]
    v_exp_f32 v176, v176
    v_exp_f32 v177, v177
    v_exp_f32 v178, v178
    v_exp_f32 v179, v179
    buffer_load_dwordx4 v[108:111], v32, s[24:27], s46 offen offset:0 sc1
    v_exp_f32 v180, v180
    v_exp_f32 v181, v181
    v_exp_f32 v182, v182
    v_exp_f32 v183, v183
    v_pk_fma_f32 v[176:177], v[176:177], v[44:45], v[44:45] op_sel:[0,1,1] op_sel_hi:[1,1,1]
    v_pk_fma_f32 v[178:179], v[178:179], v[44:45], v[44:45] op_sel:[0,1,1] op_sel_hi:[1,1,1]
    buffer_load_dwordx4 v[112:115], v29, s[24:27], s46 offen offset:2048 sc1
    v_pk_fma_f32 v[180:181], v[180:181], v[44:45], v[44:45] op_sel:[0,1,1] op_sel_hi:[1,1,1]
    v_pk_fma_f32 v[182:183], v[182:183], v[44:45], v[44:45] op_sel:[0,1,1] op_sel_hi:[1,1,1]
    v_rcp_f32 v176, v176
    v_rcp_f32 v177, v177
    v_rcp_f32 v178, v178
    v_rcp_f32 v179, v179
    buffer_load_dwordx4 v[116:119], v30, s[24:27], s46 offen offset:2048 sc1
    v_rcp_f32 v180, v180
    v_rcp_f32 v181, v181
    v_rcp_f32 v182, v182
    v_rcp_f32 v183, v183
    v_pk_mul_f32 v[184:185], v[184:185], v[176:177]
    v_pk_mul_f32 v[186:187], v[186:187], v[178:179]
    buffer_load_dwordx4 v[120:123], v31, s[24:27], s46 offen offset:2048 sc1
    v_pk_mul_f32 v[188:189], v[188:189], v[180:181]
    v_pk_mul_f32 v[190:191], v[190:191], v[182:183]
    v_cvt_pk_bf16_f32 v176, v184, v185
    v_cvt_pk_bf16_f32 v177, v186, v187
    v_cvt_pk_bf16_f32 v178, v188, v189
    v_cvt_pk_bf16_f32 v179, v190, v191
    s_add_u32 s36, s73, 65536
    buffer_store_dwordx4 v[176:179], v2, s[12:15], s36 offen sc1
    buffer_load_dwordx4 v[124:127], v32, s[24:27], s46 offen offset:2048 sc1
    s_add_u32 s47, s63, 0
    v_add_u32 v43, s47, v2
    s_add_u32 s47, s63, 65536
    v_add_u32 v44, s47, v2
    s_add_u32 s47, s63, 131072
    v_add_u32 v45, s47, v2
    s_waitcnt vmcnt(1)
    s_barrier
    buffer_store_dword a255, v15, s[12:15], s77 offen offset:256 sc1
    v_mfma_f32_16x16x32_bf16 v[128:131], a[0:3], v[192:195], 0
    s_add_u32 m0, s63, 131072
    s_nop 0
    buffer_load_dwordx4 v19, s[12:15], s68 offen offset:0 sc1 lds
    v_mfma_f32_16x16x32_bf16 v[132:135], a[4:7], v[192:195], 0
    v_mfma_f32_16x16x32_bf16 v[136:139], a[8:11], v[192:195], 0
    v_mfma_f32_16x16x32_bf16 v[140:143], a[12:15], v[192:195], 0
    v_mfma_f32_16x16x32_bf16 v[144:147], a[16:19], v[192:195], 0
    buffer_load_dwordx4 v19, s[12:15], s68 offen offset:1024 sc1 lds
    v_mfma_f32_16x16x32_bf16 v[148:151], a[0:3], v[196:199], 0
    v_mfma_f32_16x16x32_bf16 v[152:155], a[4:7], v[196:199], 0
    v_mfma_f32_16x16x32_bf16 v[156:159], a[8:11], v[196:199], 0
    v_mfma_f32_16x16x32_bf16 v[160:163], a[12:15], v[196:199], 0
    buffer_load_dwordx4 v19, s[12:15], s68 offen offset:2048 sc1 lds
    v_mfma_f32_16x16x32_bf16 v[164:167], a[16:19], v[196:199], 0
    v_mfma_f32_16x16x32_bf16 a[160:163], a[0:3], v[200:203], 0
    v_mfma_f32_16x16x32_bf16 a[164:167], a[4:7], v[200:203], 0
    v_mfma_f32_16x16x32_bf16 a[168:171], a[8:11], v[200:203], 0
    buffer_load_dwordx4 v19, s[12:15], s68 offen offset:3072 sc1 lds
    v_mfma_f32_16x16x32_bf16 a[172:175], a[12:15], v[200:203], 0
    v_mfma_f32_16x16x32_bf16 a[176:179], a[16:19], v[200:203], 0
    v_mfma_f32_16x16x32_bf16 a[180:183], a[0:3], v[204:207], 0
    v_mfma_f32_16x16x32_bf16 a[184:187], a[4:7], v[204:207], 0
    s_add_u32 m0, s63, 147456
    s_nop 0
    buffer_load_dwordx4 v2, s[12:15], s69 offen offset:0 sc1 lds
    v_mfma_f32_16x16x32_bf16 a[188:191], a[8:11], v[204:207], 0
    v_mfma_f32_16x16x32_bf16 a[192:195], a[12:15], v[204:207], 0
    v_mfma_f32_16x16x32_bf16 a[196:199], a[16:19], v[204:207], 0
    v_mfma_f32_16x16x32_bf16 v[128:131], a[20:23], v[208:211], v[128:131]
    buffer_load_dwordx4 v2, s[12:15], s69 offen offset:1024 sc1 lds
    v_mfma_f32_16x16x32_bf16 v[132:135], a[24:27], v[208:211], v[132:135]
    v_mfma_f32_16x16x32_bf16 v[136:139], a[28:31], v[208:211], v[136:139]
    v_mfma_f32_16x16x32_bf16 v[140:143], a[32:35], v[208:211], v[140:143]
    v_mfma_f32_16x16x32_bf16 v[144:147], a[36:39], v[208:211], v[144:147]
    buffer_load_dwordx4 v2, s[12:15], s69 offen offset:2048 sc1 lds
    v_mfma_f32_16x16x32_bf16 v[148:151], a[20:23], v[212:215], v[148:151]
    v_mfma_f32_16x16x32_bf16 v[152:155], a[24:27], v[212:215], v[152:155]
    v_mfma_f32_16x16x32_bf16 v[156:159], a[28:31], v[212:215], v[156:159]
    v_mfma_f32_16x16x32_bf16 v[160:163], a[32:35], v[212:215], v[160:163]
    buffer_load_dwordx4 v2, s[12:15], s69 offen offset:3072 sc1 lds
    v_mfma_f32_16x16x32_bf16 v[164:167], a[36:39], v[212:215], v[164:167]
    v_mfma_f32_16x16x32_bf16 a[160:163], a[20:23], v[216:219], a[160:163]
    v_mfma_f32_16x16x32_bf16 a[164:167], a[24:27], v[216:219], a[164:167]
    v_mfma_f32_16x16x32_bf16 a[168:171], a[28:31], v[216:219], a[168:171]
    s_add_u32 m0, s63, 65536
    s_nop 0
    buffer_load_dwordx4 v16, s[12:15], s69 offen offset:0 sc1 lds
    v_mfma_f32_16x16x32_bf16 a[172:175], a[32:35], v[216:219], a[172:175]
    v_mfma_f32_16x16x32_bf16 a[176:179], a[36:39], v[216:219], a[176:179]
    v_mfma_f32_16x16x32_bf16 a[180:183], a[20:23], v[220:223], a[180:183]
    v_mfma_f32_16x16x32_bf16 a[184:187], a[24:27], v[220:223], a[184:187]
    buffer_load_dwordx4 v16, s[12:15], s69 offen offset:1024 sc1 lds
    v_mfma_f32_16x16x32_bf16 a[188:191], a[28:31], v[220:223], a[188:191]
    v_mfma_f32_16x16x32_bf16 a[192:195], a[32:35], v[220:223], a[192:195]
    v_mfma_f32_16x16x32_bf16 a[196:199], a[36:39], v[220:223], a[196:199]
    v_mfma_f32_16x16x32_bf16 v[128:131], a[40:43], v[224:227], v[128:131]
    buffer_load_dwordx4 v16, s[12:15], s69 offen offset:2048 sc1 lds
    v_mfma_f32_16x16x32_bf16 v[132:135], a[44:47], v[224:227], v[132:135]
    v_mfma_f32_16x16x32_bf16 v[136:139], a[48:51], v[224:227], v[136:139]
    v_mfma_f32_16x16x32_bf16 v[140:143], a[52:55], v[224:227], v[140:143]
    v_mfma_f32_16x16x32_bf16 v[144:147], a[56:59], v[224:227], v[144:147]
    buffer_load_dwordx4 v16, s[12:15], s69 offen offset:3072 sc1 lds
    v_mfma_f32_16x16x32_bf16 v[148:151], a[40:43], v[228:231], v[148:151]
    v_mfma_f32_16x16x32_bf16 v[152:155], a[44:47], v[228:231], v[152:155]
    v_mfma_f32_16x16x32_bf16 v[156:159], a[48:51], v[228:231], v[156:159]
    v_mfma_f32_16x16x32_bf16 v[160:163], a[52:55], v[228:231], v[160:163]
    s_add_u32 m0, s63, 81920
    s_nop 0
    buffer_load_dwordx4 v17, s[12:15], s69 offen offset:0 sc1 lds
    v_mfma_f32_16x16x32_bf16 v[164:167], a[56:59], v[228:231], v[164:167]
    v_mfma_f32_16x16x32_bf16 a[160:163], a[40:43], v[232:235], a[160:163]
    v_mfma_f32_16x16x32_bf16 a[164:167], a[44:47], v[232:235], a[164:167]
    v_mfma_f32_16x16x32_bf16 a[168:171], a[48:51], v[232:235], a[168:171]
    buffer_load_dwordx4 v17, s[12:15], s69 offen offset:1024 sc1 lds
    v_mfma_f32_16x16x32_bf16 a[172:175], a[52:55], v[232:235], a[172:175]
    v_mfma_f32_16x16x32_bf16 a[176:179], a[56:59], v[232:235], a[176:179]
    v_mfma_f32_16x16x32_bf16 a[180:183], a[40:43], v[236:239], a[180:183]
    v_mfma_f32_16x16x32_bf16 a[184:187], a[44:47], v[236:239], a[184:187]
    buffer_load_dwordx4 a[100:103], v17, s[12:15], s69 offen offset:2048 sc1
    v_mfma_f32_16x16x32_bf16 a[188:191], a[48:51], v[236:239], a[188:191]
    v_mfma_f32_16x16x32_bf16 a[192:195], a[52:55], v[236:239], a[192:195]
    v_mfma_f32_16x16x32_bf16 a[196:199], a[56:59], v[236:239], a[196:199]
    buffer_load_dword v7, v6, s[12:15], s57 offen offset:256 sc1
    v_mfma_f32_16x16x32_bf16 v[128:131], a[60:63], v[240:243], v[128:131]
    buffer_load_dwordx4 a[104:107], v17, s[12:15], s69 offen offset:3072 sc1
    v_mfma_f32_16x16x32_bf16 v[132:135], a[64:67], v[240:243], v[132:135]
    v_mfma_f32_16x16x32_bf16 v[136:139], a[68:71], v[240:243], v[136:139]
    v_mfma_f32_16x16x32_bf16 v[140:143], a[72:75], v[240:243], v[140:143]
    v_mfma_f32_16x16x32_bf16 v[144:147], a[76:79], v[240:243], v[144:147]
    buffer_load_dwordx4 a[108:111], v18, s[12:15], s69 offen offset:0 sc1
    v_mfma_f32_16x16x32_bf16 v[148:151], a[60:63], v[244:247], v[148:151]
    v_mfma_f32_16x16x32_bf16 v[152:155], a[64:67], v[244:247], v[152:155]
    v_mfma_f32_16x16x32_bf16 v[156:159], a[68:71], v[244:247], v[156:159]
    v_mfma_f32_16x16x32_bf16 v[160:163], a[72:75], v[244:247], v[160:163]
    buffer_load_dwordx4 a[112:115], v18, s[12:15], s69 offen offset:1024 sc1
    v_mfma_f32_16x16x32_bf16 v[164:167], a[76:79], v[244:247], v[164:167]
    v_mfma_f32_16x16x32_bf16 a[160:163], a[60:63], v[248:251], a[160:163]
    v_mfma_f32_16x16x32_bf16 a[164:167], a[64:67], v[248:251], a[164:167]
    v_mfma_f32_16x16x32_bf16 a[168:171], a[68:71], v[248:251], a[168:171]
    buffer_load_dwordx4 a[116:119], v18, s[12:15], s69 offen offset:2048 sc1
    v_mfma_f32_16x16x32_bf16 a[172:175], a[72:75], v[248:251], a[172:175]
    v_mfma_f32_16x16x32_bf16 a[176:179], a[76:79], v[248:251], a[176:179]
    v_mfma_f32_16x16x32_bf16 a[180:183], a[60:63], v[252:255], a[180:183]
    v_mfma_f32_16x16x32_bf16 a[184:187], a[64:67], v[252:255], a[184:187]
    v_mfma_f32_16x16x32_bf16 a[188:191], a[68:71], v[252:255], a[188:191]
    v_mfma_f32_16x16x32_bf16 a[192:195], a[72:75], v[252:255], a[192:195]
    v_mfma_f32_16x16x32_bf16 a[196:199], a[76:79], v[252:255], a[196:199]
    s_waitcnt vmcnt(4)
    s_cmp_eq_u32 s26, 0
    s_cbranch_scc1 L_slow_p1g
L_back_p1g:
    v_cmp_ne_u32 vcc, 1, v7
    s_nop 0
    s_and_b32 s58, vcc_lo, 0xff
    s_cselect_b32 s26, 0, 16777216
    s_waitcnt vmcnt(12)
    v_mfma_f32_16x16x32_bf16 v[128:131], a[80:83], v[64:67], v[128:131]
    s_add_u32 s46, s44, 65536
    buffer_load_dwordx4 v[192:195], v29, s[24:27], s46 offen offset:0 sc1
    v_mfma_f32_16x16x32_bf16 v[132:135], a[84:87], v[64:67], v[132:135]
    v_mfma_f32_16x16x32_bf16 v[136:139], a[88:91], v[64:67], v[136:139]
    v_mfma_f32_16x16x32_bf16 v[140:143], a[92:95], v[64:67], v[140:143]
    v_mfma_f32_16x16x32_bf16 v[144:147], a[96:99], v[64:67], v[144:147]
    buffer_load_dwordx4 v[196:199], v30, s[24:27], s46 offen offset:0 sc1
    v_mfma_f32_16x16x32_bf16 v[148:151], a[80:83], v[68:71], v[148:151]
    v_mfma_f32_16x16x32_bf16 v[152:155], a[84:87], v[68:71], v[152:155]
    v_mfma_f32_16x16x32_bf16 v[156:159], a[88:91], v[68:71], v[156:159]
    v_mfma_f32_16x16x32_bf16 v[160:163], a[92:95], v[68:71], v[160:163]
    buffer_load_dwordx4 v[200:203], v31, s[24:27], s46 offen offset:0 sc1
    v_mfma_f32_16x16x32_bf16 v[164:167], a[96:99], v[68:71], v[164:167]
    v_mfma_f32_16x16x32_bf16 a[160:163], a[80:83], v[72:75], a[160:163]
    v_mfma_f32_16x16x32_bf16 a[164:167], a[84:87], v[72:75], a[164:167]
    v_mfma_f32_16x16x32_bf16 a[168:171], a[88:91], v[72:75], a[168:171]
    buffer_load_dwordx4 v[204:207], v32, s[24:27], s46 offen offset:0 sc1
    v_mfma_f32_16x16x32_bf16 a[172:175], a[92:95], v[72:75], a[172:175]
    v_mfma_f32_16x16x32_bf16 a[176:179], a[96:99], v[72:75], a[176:179]
    v_mfma_f32_16x16x32_bf16 a[180:183], a[80:83], v[76:79], a[180:183]
    v_mfma_f32_16x16x32_bf16 a[184:187], a[84:87], v[76:79], a[184:187]
    buffer_load_dwordx4 v[208:211], v29, s[24:27], s46 offen offset:2048 sc1
    v_mfma_f32_16x16x32_bf16 a[188:191], a[88:91], v[76:79], a[188:191]
    v_mfma_f32_16x16x32_bf16 a[192:195], a[92:95], v[76:79], a[192:195]
    v_mfma_f32_16x16x32_bf16 a[196:199], a[96:99], v[76:79], a[196:199]
    s_waitcnt vmcnt(13)
    v_mfma_f32_16x16x32_bf16 v[128:131], a[200:203], v[80:83], v[128:131]
    buffer_load_dwordx4 v[212:215], v30, s[24:27], s46 offen offset:2048 sc1
    v_mfma_f32_16x16x32_bf16 v[132:135], a[204:207], v[80:83], v[132:135]
    v_mfma_f32_16x16x32_bf16 v[136:139], a[208:211], v[80:83], v[136:139]
    v_mfma_f32_16x16x32_bf16 v[140:143], a[212:215], v[80:83], v[140:143]
    v_mfma_f32_16x16x32_bf16 v[144:147], a[216:219], v[80:83], v[144:147]
    buffer_load_dwordx4 v[216:219], v31, s[24:27], s46 offen offset:2048 sc1
    v_mfma_f32_16x16x32_bf16 v[148:151], a[200:203], v[84:87], v[148:151]
    ds_read_b128 a[0:3], v43 offset:3072
    v_mfma_f32_16x16x32_bf16 v[152:155], a[204:207], v[84:87], v[152:155]
    ds_read_b128 a[4:7], v44 offset:32768
    v_mfma_f32_16x16x32_bf16 v[156:159], a[208:211], v[84:87], v[156:159]
    buffer_load_dwordx4 v[220:223], v32, s[24:27], s46 offen offset:2048 sc1
    ds_read_b128 a[8:11], v44 offset:33792
    v_mfma_f32_16x16x32_bf16 v[160:163], a[212:215], v[84:87], v[160:163]
    ds_read_b128 a[12:15], v44 offset:34816
    v_mfma_f32_16x16x32_bf16 v[164:167], a[216:219], v[84:87], v[164:167]
    ds_read_b128 a[16:19], v44 offset:35840
    v_mfma_f32_16x16x32_bf16 a[160:163], a[200:203], v[88:91], a[160:163]
    s_add_u32 s46, s46, 4096
    buffer_load_dwordx4 v[224:227], v29, s[24:27], s46 offen offset:0 sc1
    v_mfma_f32_16x16x32_bf16 a[164:167], a[204:207], v[88:91], a[164:167]
    v_mfma_f32_16x16x32_bf16 a[168:171], a[208:211], v[88:91], a[168:171]
    v_mfma_f32_16x16x32_bf16 a[172:175], a[212:215], v[88:91], a[172:175]
    v_mfma_f32_16x16x32_bf16 a[176:179], a[216:219], v[88:91], a[176:179]
    buffer_load_dwordx4 v[228:231], v30, s[24:27], s46 offen offset:0 sc1
    v_mfma_f32_16x16x32_bf16 a[180:183], a[200:203], v[92:95], a[180:183]
    v_mfma_f32_16x16x32_bf16 a[184:187], a[204:207], v[92:95], a[184:187]
    v_mfma_f32_16x16x32_bf16 a[188:191], a[208:211], v[92:95], a[188:191]
    v_mfma_f32_16x16x32_bf16 a[192:195], a[212:215], v[92:95], a[192:195]
    buffer_load_dwordx4 v[232:235], v31, s[24:27], s46 offen offset:0 sc1
    v_mfma_f32_16x16x32_bf16 a[196:199], a[216:219], v[92:95], a[196:199]
    s_waitcnt vmcnt(15)
    v_mfma_f32_16x16x32_bf16 v[128:131], a[220:223], v[96:99], v[128:131]
    v_mfma_f32_16x16x32_bf16 v[132:135], a[224:227], v[96:99], v[132:135]
    v_mfma_f32_16x16x32_bf16 v[136:139], a[228:231], v[96:99], v[136:139]
    buffer_load_dwordx4 v[236:239], v32, s[24:27], s46 offen offset:0 sc1
    v_mfma_f32_16x16x32_bf16 v[140:143], a[232:235], v[96:99], v[140:143]
    v_mfma_f32_16x16x32_bf16 v[144:147], a[236:239], v[96:99], v[144:147]
    v_mfma_f32_16x16x32_bf16 v[148:151], a[220:223], v[100:103], v[148:151]
    ds_read_b128 a[20:23], v43 offset:16384
    v_mfma_f32_16x16x32_bf16 v[152:155], a[224:227], v[100:103], v[152:155]
    buffer_load_dwordx4 v[240:243], v29, s[24:27], s46 offen offset:2048 sc1
    ds_read_b128 a[24:27], v43 offset:17408
    v_mfma_f32_16x16x32_bf16 v[156:159], a[228:231], v[100:103], v[156:159]
    ds_read_b128 a[28:31], v43 offset:18432
    v_mfma_f32_16x16x32_bf16 v[160:163], a[232:235], v[100:103], v[160:163]
    ds_read_b128 a[32:35], v43 offset:19456
    v_mfma_f32_16x16x32_bf16 v[164:167], a[236:239], v[100:103], v[164:167]
    buffer_load_dwordx4 v[244:247], v30, s[24:27], s46 offen offset:2048 sc1
    ds_read_b128 a[36:39], v43 offset:32768
    v_mfma_f32_16x16x32_bf16 a[160:163], a[220:223], v[104:107], a[160:163]
    v_mfma_f32_16x16x32_bf16 a[164:167], a[224:227], v[104:107], a[164:167]
    v_mfma_f32_16x16x32_bf16 a[168:171], a[228:231], v[104:107], a[168:171]
    v_mfma_f32_16x16x32_bf16 a[172:175], a[232:235], v[104:107], a[172:175]
    buffer_load_dwordx4 v[248:251], v31, s[24:27], s46 offen offset:2048 sc1
    v_mfma_f32_16x16x32_bf16 a[176:179], a[236:239], v[104:107], a[176:179]
    v_mfma_f32_16x16x32_bf16 a[180:183], a[220:223], v[108:111], a[180:183]
    v_mfma_f32_16x16x32_bf16 a[184:187], a[224:227], v[108:111], a[184:187]
    v_mfma_f32_16x16x32_bf16 a[188:191], a[228:231], v[108:111], a[188:191]
    buffer_load_dwordx4 v[252:255], v32, s[24:27], s46 offen offset:2048 sc1
    v_mfma_f32_16x16x32_bf16 a[192:195], a[232:235], v[108:111], a[192:195]
    v_mfma_f32_16x16x32_bf16 a[196:199], a[236:239], v[108:111], a[196:199]
    s_waitcnt vmcnt(16)
    buffer_load_dword v8, v6, s[12:15], s57 offen offset:384 sc1
    s_waitcnt lgkmcnt(9)
    v_mfma_f32_16x16x32_bf16 v[128:131], a[0:3], v[112:115], v[128:131]
    buffer_load_dwordx4 a[120:123], v18, s[12:15], s69 offen offset:3072 sc1
    s_waitcnt lgkmcnt(8)
    v_mfma_f32_16x16x32_bf16 v[132:135], a[4:7], v[112:115], v[132:135]
    s_waitcnt lgkmcnt(7)
    v_mfma_f32_16x16x32_bf16 v[136:139], a[8:11], v[112:115], v[136:139]
    s_waitcnt lgkmcnt(6)
    v_mfma_f32_16x16x32_bf16 v[140:143], a[12:15], v[112:115], v[140:143]
    s_waitcnt lgkmcnt(5)
    v_mfma_f32_16x16x32_bf16 v[144:147], a[16:19], v[112:115], v[144:147]
    buffer_load_dwordx4 a[124:127], v19, s[12:15], s69 offen offset:0 sc1
    v_mfma_f32_16x16x32_bf16 v[148:151], a[0:3], v[116:119], v[148:151]
    ds_read_b128 a[40:43], v43 offset:33792
    v_mfma_f32_16x16x32_bf16 v[152:155], a[4:7], v[116:119], v[152:155]
    ds_read_b128 a[44:47], v43 offset:34816
    v_mfma_f32_16x16x32_bf16 v[156:159], a[8:11], v[116:119], v[156:159]
    buffer_load_dwordx4 a[128:131], v19, s[12:15], s69 offen offset:1024 sc1
    ds_read_b128 a[48:51], v43 offset:35840
    v_mfma_f32_16x16x32_bf16 v[160:163], a[12:15], v[116:119], v[160:163]
    ds_read_b128 a[52:55], v43 offset:49152
    v_mfma_f32_16x16x32_bf16 v[164:167], a[16:19], v[116:119], v[164:167]
    ds_read_b128 a[56:59], v43 offset:50176
    v_mfma_f32_16x16x32_bf16 a[160:163], a[0:3], v[120:123], a[160:163]
    buffer_load_dwordx4 a[132:135], v19, s[12:15], s69 offen offset:2048 sc1
    v_mfma_f32_16x16x32_bf16 a[164:167], a[4:7], v[120:123], a[164:167]
    v_mfma_f32_16x16x32_bf16 a[168:171], a[8:11], v[120:123], a[168:171]
    v_mfma_f32_16x16x32_bf16 a[172:175], a[12:15], v[120:123], a[172:175]
    v_mfma_f32_16x16x32_bf16 a[176:179], a[16:19], v[120:123], a[176:179]
    buffer_load_dwordx4 a[136:139], v19, s[12:15], s69 offen offset:3072 sc1
    v_mfma_f32_16x16x32_bf16 a[180:183], a[0:3], v[124:127], a[180:183]
    v_mfma_f32_16x16x32_bf16 a[184:187], a[4:7], v[124:127], a[184:187]
    v_mfma_f32_16x16x32_bf16 a[188:191], a[8:11], v[124:127], a[188:191]
    v_mfma_f32_16x16x32_bf16 a[192:195], a[12:15], v[124:127], a[192:195]
    v_mfma_f32_16x16x32_bf16 a[196:199], a[16:19], v[124:127], a[196:199]
    s_waitcnt vmcnt(5)
    s_cmp_eq_u32 s26, 0
    s_cbranch_scc1 L_slow_p2g
L_back_p2g:
    v_cmp_ne_u32 vcc, 1, v8
    s_nop 0
    s_and_b32 s58, vcc_lo, 0xff
    s_cselect_b32 s26, 0, 16777216
    s_waitcnt vmcnt(12)
    s_waitcnt lgkmcnt(9)
    v_mfma_f32_16x16x32_bf16 v[128:131], a[20:23], v[192:195], v[128:131]
    s_mov_b32 s46, s45
    s_add_u32 s47, s45, 4096
    s_add_u32 s48, s45, 8192
    buffer_load_dwordx4 v[52:55], v30, s[24:27], s46 offen offset:0 sc1
    s_waitcnt lgkmcnt(8)
    v_mfma_f32_16x16x32_bf16 v[132:135], a[24:27], v[192:195], v[132:135]
    s_waitcnt lgkmcnt(7)
    v_mfma_f32_16x16x32_bf16 v[136:139], a[28:31], v[192:195], v[136:139]
    s_waitcnt lgkmcnt(6)
    v_mfma_f32_16x16x32_bf16 v[140:143], a[32:35], v[192:195], v[140:143]
    s_waitcnt lgkmcnt(5)
    v_mfma_f32_16x16x32_bf16 v[144:147], a[36:39], v[192:195], v[144:147]
    buffer_load_dwordx4 v[68:71], v30, s[24:27], s46 offen offset:2048 sc1
    v_mfma_f32_16x16x32_bf16 v[148:151], a[20:23], v[196:199], v[148:151]
    ds_read_b128 a[60:63], v43 offset:51200
    v_mfma_f32_16x16x32_bf16 v[152:155], a[24:27], v[196:199], v[152:155]
    ds_read_b128 a[64:67], v43 offset:52224
    v_mfma_f32_16x16x32_bf16 v[156:159], a[28:31], v[196:199], v[156:159]
    buffer_load_dwordx4 v[84:87], v30, s[24:27], s47 offen offset:0 sc1
    ds_read_b128 a[68:71], v44 offset:49152
    v_mfma_f32_16x16x32_bf16 v[160:163], a[32:35], v[196:199], v[160:163]
    ds_read_b128 a[72:75], v44 offset:50176
    v_mfma_f32_16x16x32_bf16 v[164:167], a[36:39], v[196:199], v[164:167]
    ds_read_b128 a[76:79], v44 offset:51200
    v_mfma_f32_16x16x32_bf16 a[160:163], a[20:23], v[200:203], a[160:163]
    buffer_load_dwordx4 v[100:103], v30, s[24:27], s47 offen offset:2048 sc1
    v_mfma_f32_16x16x32_bf16 a[164:167], a[24:27], v[200:203], a[164:167]
    v_mfma_f32_16x16x32_bf16 a[168:171], a[28:31], v[200:203], a[168:171]
    v_mfma_f32_16x16x32_bf16 a[172:175], a[32:35], v[200:203], a[172:175]
    v_mfma_f32_16x16x32_bf16 a[176:179], a[36:39], v[200:203], a[176:179]
    buffer_load_dwordx4 v[116:119], v30, s[24:27], s48 offen offset:0 sc1
    v_mfma_f32_16x16x32_bf16 a[180:183], a[20:23], v[204:207], a[180:183]
    v_mfma_f32_16x16x32_bf16 a[184:187], a[24:27], v[204:207], a[184:187]
    v_mfma_f32_16x16x32_bf16 a[188:191], a[28:31], v[204:207], a[188:191]
    v_mfma_f32_16x16x32_bf16 a[192:195], a[32:35], v[204:207], a[192:195]
    buffer_load_dwordx4 v[56:59], v31, s[24:27], s46 offen offset:0 sc1
    v_mfma_f32_16x16x32_bf16 a[196:199], a[36:39], v[204:207], a[196:199]
    s_waitcnt vmcnt(14)
    s_waitcnt lgkmcnt(9)
    v_mfma_f32_16x16x32_bf16 v[128:131], a[40:43], v[208:211], v[128:131]
    s_waitcnt lgkmcnt(8)
    v_mfma_f32_16x16x32_bf16 v[132:135], a[44:47], v[208:211], v[132:135]
    s_waitcnt lgkmcnt(7)
    v_mfma_f32_16x16x32_bf16 v[136:139], a[48:51], v[208:211], v[136:139]
    buffer_load_dwordx4 v[72:75], v31, s[24:27], s46 offen offset:2048 sc1
    s_waitcnt lgkmcnt(6)
    v_mfma_f32_16x16x32_bf16 v[140:143], a[52:55], v[208:211], v[140:143]
    s_waitcnt lgkmcnt(5)
    v_mfma_f32_16x16x32_bf16 v[144:147], a[56:59], v[208:211], v[144:147]
    v_mfma_f32_16x16x32_bf16 v[148:151], a[40:43], v[212:215], v[148:151]
    ds_read_b128 a[80:83], v44 offset:52224
    v_mfma_f32_16x16x32_bf16 v[152:155], a[44:47], v[212:215], v[152:155]
    buffer_load_dwordx4 v[88:91], v31, s[24:27], s47 offen offset:0 sc1
    ds_read_b128 a[84:87], v45 offset:0
    v_mfma_f32_16x16x32_bf16 v[156:159], a[48:51], v[212:215], v[156:159]
    ds_read_b128 a[88:91], v45 offset:1024
    v_mfma_f32_16x16x32_bf16 v[160:163], a[52:55], v[212:215], v[160:163]
    ds_read_b128 a[92:95], v45 offset:2048
    v_mfma_f32_16x16x32_bf16 v[164:167], a[56:59], v[212:215], v[164:167]
    buffer_load_dwordx4 v[104:107], v31, s[24:27], s47 offen offset:2048 sc1
    ds_read_b128 a[96:99], v45 offset:3072
    v_mfma_f32_16x16x32_bf16 a[160:163], a[40:43], v[216:219], a[160:163]
    v_mfma_f32_16x16x32_bf16 a[164:167], a[44:47], v[216:219], a[164:167]
    v_mfma_f32_16x16x32_bf16 a[168:171], a[48:51], v[216:219], a[168:171]
    v_mfma_f32_16x16x32_bf16 a[172:175], a[52:55], v[216:219], a[172:175]
    buffer_load_dwordx4 v[120:123], v31, s[24:27], s48 offen offset:0 sc1
    v_mfma_f32_16x16x32_bf16 a[176:179], a[56:59], v[216:219], a[176:179]
    v_mfma_f32_16x16x32_bf16 a[180:183], a[40:43], v[220:223], a[180:183]
    v_mfma_f32_16x16x32_bf16 a[184:187], a[44:47], v[220:223], a[184:187]
    v_mfma_f32_16x16x32_bf16 a[188:191], a[48:51], v[220:223], a[188:191]
    buffer_load_dwordx4 v[60:63], v32, s[24:27], s46 offen offset:0 sc1
    v_mfma_f32_16x16x32_bf16 a[192:195], a[52:55], v[220:223], a[192:195]
    v_mfma_f32_16x16x32_bf16 a[196:199], a[56:59], v[220:223], a[196:199]
    s_waitcnt vmcnt(15)
    s_waitcnt lgkmcnt(9)
    v_mfma_f32_16x16x32_bf16 v[128:131], a[60:63], v[224:227], v[128:131]
    s_waitcnt lgkmcnt(8)
    v_mfma_f32_16x16x32_bf16 v[132:135], a[64:67], v[224:227], v[132:135]
    buffer_load_dwordx4 v[76:79], v32, s[24:27], s46 offen offset:2048 sc1
    s_waitcnt lgkmcnt(7)
    v_mfma_f32_16x16x32_bf16 v[136:139], a[68:71], v[224:227], v[136:139]
    s_waitcnt lgkmcnt(6)
    v_mfma_f32_16x16x32_bf16 v[140:143], a[72:75], v[224:227], v[140:143]
    s_waitcnt lgkmcnt(5)
    v_mfma_f32_16x16x32_bf16 v[144:147], a[76:79], v[224:227], v[144:147]
    v_mfma_f32_16x16x32_bf16 v[148:151], a[60:63], v[228:231], v[148:151]
    buffer_load_dwordx4 v[92:95], v32, s[24:27], s47 offen offset:0 sc1
    ds_read_b128 a[200:203], v45 offset:16384
    v_mfma_f32_16x16x32_bf16 v[152:155], a[64:67], v[228:231], v[152:155]
    ds_read_b128 a[204:207], v45 offset:17408
    v_mfma_f32_16x16x32_bf16 v[156:159], a[68:71], v[228:231], v[156:159]
    ds_read_b128 a[208:211], v45 offset:18432
    v_mfma_f32_16x16x32_bf16 v[160:163], a[72:75], v[228:231], v[160:163]
    buffer_load_dwordx4 v[108:111], v32, s[24:27], s47 offen offset:2048 sc1
    ds_read_b128 a[212:215], v45 offset:19456
    v_mfma_f32_16x16x32_bf16 v[164:167], a[76:79], v[228:231], v[164:167]
    ds_read_b128 a[216:219], v44 offset:0
    v_mfma_f32_16x16x32_bf16 a[160:163], a[60:63], v[232:235], a[160:163]
    v_mfma_f32_16x16x32_bf16 a[164:167], a[64:67], v[232:235], a[164:167]
    buffer_load_dwordx4 v[124:127], v32, s[24:27], s48 offen offset:0 sc1
    v_mfma_f32_16x16x32_bf16 a[168:171], a[68:71], v[232:235], a[168:171]
    v_mfma_f32_16x16x32_bf16 a[172:175], a[72:75], v[232:235], a[172:175]
    v_mfma_f32_16x16x32_bf16 a[176:179], a[76:79], v[232:235], a[176:179]
    v_mfma_f32_16x16x32_bf16 a[180:183], a[60:63], v[236:239], a[180:183]
    buffer_load_dwordx4 v[48:51], v29, s[24:27], s46 offen offset:0 sc1
    v_mfma_f32_16x16x32_bf16 a[184:187], a[64:67], v[236:239], a[184:187]
    v_mfma_f32_16x16x32_bf16 a[188:191], a[68:71], v[236:239], a[188:191]
    v_mfma_f32_16x16x32_bf16 a[192:195], a[72:75], v[236:239], a[192:195]
    v_mfma_f32_16x16x32_bf16 a[196:199], a[76:79], v[236:239], a[196:199]
    s_waitcnt vmcnt(16)
    s_waitcnt lgkmcnt(9)
    v_mfma_f32_16x16x32_bf16 v[128:131], a[80:83], v[240:243], v[128:131]
    buffer_load_dwordx4 v[64:67], v29, s[24:27], s46 offen offset:2048 sc1
    s_waitcnt lgkmcnt(8)
    v_mfma_f32_16x16x32_bf16 v[132:135], a[84:87], v[240:243], v[132:135]
    s_waitcnt lgkmcnt(7)
    v_mfma_f32_16x16x32_bf16 v[136:139], a[88:91], v[240:243], v[136:139]
    s_waitcnt lgkmcnt(6)
    v_mfma_f32_16x16x32_bf16 v[140:143], a[92:95], v[240:243], v[140:143]
    s_waitcnt lgkmcnt(5)
    v_mfma_f32_16x16x32_bf16 v[144:147], a[96:99], v[240:243], v[144:147]
    buffer_load_dwordx4 v[80:83], v29, s[24:27], s47 offen offset:0 sc1
    v_mfma_f32_16x16x32_bf16 v[148:151], a[80:83], v[244:247], v[148:151]
    ds_read_b128 a[220:223], v44 offset:1024
    v_mfma_f32_16x16x32_bf16 v[152:155], a[84:87], v[244:247], v[152:155]
    ds_read_b128 a[224:227], v44 offset:2048
    v_mfma_f32_16x16x32_bf16 v[156:159], a[88:91], v[244:247], v[156:159]
    buffer_load_dwordx4 v[96:99], v29, s[24:27], s47 offen offset:2048 sc1
    ds_read_b128 a[228:231], v44 offset:3072
    v_mfma_f32_16x16x32_bf16 v[160:163], a[92:95], v[244:247], v[160:163]
    ds_read_b128 a[232:235], v44 offset:16384
    v_mfma_f32_16x16x32_bf16 v[164:167], a[96:99], v[244:247], v[164:167]
    ds_read_b128 a[236:239], v44 offset:17408
    v_mfma_f32_16x16x32_bf16 a[160:163], a[80:83], v[248:251], a[160:163]
    buffer_load_dwordx4 v[112:115], v29, s[24:27], s48 offen offset:0 sc1
    v_mfma_f32_16x16x32_bf16 a[164:167], a[84:87], v[248:251], a[164:167]
    v_mfma_f32_16x16x32_bf16 a[168:171], a[88:91], v[248:251], a[168:171]
    v_mfma_f32_16x16x32_bf16 a[172:175], a[92:95], v[248:251], a[172:175]
    v_mfma_f32_16x16x32_bf16 a[176:179], a[96:99], v[248:251], a[176:179]
    buffer_load_dwordx4 a[140:143], v13, s[12:15], s69 offen offset:0 sc1
    v_mfma_f32_16x16x32_bf16 a[180:183], a[80:83], v[252:255], a[180:183]
    v_mfma_f32_16x16x32_bf16 a[184:187], a[84:87], v[252:255], a[184:187]
    v_mfma_f32_16x16x32_bf16 a[188:191], a[88:91], v[252:255], a[188:191]
    v_mfma_f32_16x16x32_bf16 a[192:195], a[92:95], v[252:255], a[192:195]
    buffer_load_dwordx4 a[144:147], v13, s[12:15], s69 offen offset:1024 sc1
    v_mfma_f32_16x16x32_bf16 a[196:199], a[96:99], v[252:255], a[196:199]
    buffer_load_dwordx4 a[148:151], v13, s[12:15], s69 offen offset:2048 sc1
    buffer_load_dwordx4 a[152:155], v13, s[12:15], s69 offen offset:3072 sc1
    buffer_load_dwordx4 a[156:159], v14, s[12:15], s69 offen offset:0 sc1
    s_cmp_eq_u32 s26, 0
    s_cbranch_scc1 L_slow_p3g
L_back_p3g:
    s_waitcnt lgkmcnt(0)
    s_barrier
    s_waitcnt vmcnt(19)
    v_mfma_f32_16x16x32_bf16 v[148:151], a[200:203], v[52:55], v[148:151]
    s_add_u32 s58, s28, 1
    s_and_b32 s58, s58, 3
    s_mul_i32 s58, s58, 15360
    s_add_u32 s58, s58, 0
    v_mfma_f32_16x16x32_bf16 v[152:155], a[204:207], v[52:55], v[152:155]
    v_add_u32 v37, s58, v2
    s_add_u32 s58, s28, 2
    s_and_b32 s58, s58, 3
    s_mul_i32 s58, s58, 15360
    s_add_u32 s58, s58, 5120
    v_mfma_f32_16x16x32_bf16 v[156:159], a[208:211], v[52:55], v[156:159]
    v_add_u32 v38, s58, v2
    s_add_u32 s58, s28, 3
    s_and_b32 s58, s58, 3
    s_mul_i32 s58, s58, 15360
    s_add_u32 s58, s58, 10240
    v_mfma_f32_16x16x32_bf16 v[160:163], a[212:215], v[52:55], v[160:163]
    v_mfma_f32_16x16x32_bf16 v[164:167], a[216:219], v[52:55], v[164:167]
    v_add_u32 v39, s58, v2
    s_mul_i32 s58, s28, 15360
    s_waitcnt vmcnt(18)
    v_mfma_f32_16x16x32_bf16 v[148:151], a[220:223], v[68:71], v[148:151]
    v_add_u32 v36, s58, v2
    v_mfma_f32_16x16x32_bf16 v[152:155], a[224:227], v[68:71], v[152:155]
    v_mfma_f32_16x16x32_bf16 v[156:159], a[228:231], v[68:71], v[156:159]
    v_accvgpr_read_b32 v168, a240
    v_mfma_f32_16x16x32_bf16 v[160:163], a[232:235], v[68:71], v[160:163]
    v_accvgpr_read_b32 v169, a241
    v_mfma_f32_16x16x32_bf16 v[164:167], a[236:239], v[68:71], v[164:167]
    s_waitcnt vmcnt(17)
    v_mfma_f32_16x16x32_bf16 v[148:151], a[100:103], v[84:87], v[148:151]
    v_accvgpr_read_b32 v170, a242
    v_mfma_f32_16x16x32_bf16 v[152:155], a[104:107], v[84:87], v[152:155]
    v_accvgpr_read_b32 v171, a243
    v_mfma_f32_16x16x32_bf16 v[156:159], a[108:111], v[84:87], v[156:159]
    v_accvgpr_read_b32 v172, a244
    v_mfma_f32_16x16x32_bf16 v[160:163], a[112:115], v[84:87], v[160:163]
    v_mfma_f32_16x16x32_bf16 v[164:167], a[116:119], v[84:87], v[164:167]
    v_accvgpr_read_b32 v173, a245
    s_waitcnt vmcnt(16)
    v_mfma_f32_16x16x32_bf16 v[148:151], a[120:123], v[100:103], v[148:151]
    v_accvgpr_read_b32 v174, a246
    v_mfma_f32_16x16x32_bf16 v[152:155], a[124:127], v[100:103], v[152:155]
    v_mfma_f32_16x16x32_bf16 v[156:159], a[128:131], v[100:103], v[156:159]
    v_accvgpr_read_b32 v175, a247
    v_mfma_f32_16x16x32_bf16 v[160:163], a[132:135], v[100:103], v[160:163]
    v_accvgpr_read_b32 v176, a248
    v_mfma_f32_16x16x32_bf16 v[164:167], a[136:139], v[100:103], v[164:167]
    s_waitcnt vmcnt(15)
    s_waitcnt vmcnt(4)
    v_mfma_f32_16x16x32_bf16 v[148:151], a[140:143], v[116:119], v[148:151]
    v_accvgpr_read_b32 v177, a249
    s_waitcnt vmcnt(3)
    v_mfma_f32_16x16x32_bf16 v[152:155], a[144:147], v[116:119], v[152:155]
    s_waitcnt vmcnt(2)
    v_mfma_f32_16x16x32_bf16 v[156:159], a[148:151], v[116:119], v[156:159]
    s_waitcnt vmcnt(1)
    v_mfma_f32_16x16x32_bf16 v[160:163], a[152:155], v[116:119], v[160:163]
    s_waitcnt vmcnt(0)
    v_mfma_f32_16x16x32_bf16 v[164:167], a[156:159], v[116:119], v[164:167]
    s_waitcnt vmcnt(14)
    v_mfma_f32_16x16x32_bf16 a[160:163], a[200:203], v[56:59], a[160:163]
    v_mfma_f32_16x16x32_bf16 a[164:167], a[204:207], v[56:59], a[164:167]
    v_mfma_f32_16x16x32_bf16 a[168:171], a[208:211], v[56:59], a[168:171]
    v_mfma_f32_16x16x32_bf16 a[172:175], a[212:215], v[56:59], a[172:175]
    ds_write_b128 v37, v[148:151] offset:0
    v_mfma_f32_16x16x32_bf16 a[176:179], a[216:219], v[56:59], a[176:179]
    s_waitcnt vmcnt(13)
    v_mfma_f32_16x16x32_bf16 a[160:163], a[220:223], v[72:75], a[160:163]
    v_mfma_f32_16x16x32_bf16 a[164:167], a[224:227], v[72:75], a[164:167]
    v_mfma_f32_16x16x32_bf16 a[168:171], a[228:231], v[72:75], a[168:171]
    v_mfma_f32_16x16x32_bf16 a[172:175], a[232:235], v[72:75], a[172:175]
    ds_write_b128 v37, v[152:155] offset:1024
    v_mfma_f32_16x16x32_bf16 a[176:179], a[236:239], v[72:75], a[176:179]
    s_waitcnt vmcnt(12)
    v_mfma_f32_16x16x32_bf16 a[160:163], a[100:103], v[88:91], a[160:163]
    v_mfma_f32_16x16x32_bf16 a[164:167], a[104:107], v[88:91], a[164:167]
    v_mfma_f32_16x16x32_bf16 a[168:171], a[108:111], v[88:91], a[168:171]
    v_mfma_f32_16x16x32_bf16 a[172:175], a[112:115], v[88:91], a[172:175]
    ds_write_b128 v37, v[156:159] offset:2048
    v_mfma_f32_16x16x32_bf16 a[176:179], a[116:119], v[88:91], a[176:179]
    s_waitcnt vmcnt(11)
    v_mfma_f32_16x16x32_bf16 a[160:163], a[120:123], v[104:107], a[160:163]
    v_mfma_f32_16x16x32_bf16 a[164:167], a[124:127], v[104:107], a[164:167]
    v_mfma_f32_16x16x32_bf16 a[168:171], a[128:131], v[104:107], a[168:171]
    v_mfma_f32_16x16x32_bf16 a[172:175], a[132:135], v[104:107], a[172:175]
    ds_write_b128 v37, v[160:163] offset:3072
    v_mfma_f32_16x16x32_bf16 a[176:179], a[136:139], v[104:107], a[176:179]
    s_waitcnt vmcnt(10)
    v_mfma_f32_16x16x32_bf16 a[160:163], a[140:143], v[120:123], a[160:163]
    v_mfma_f32_16x16x32_bf16 a[164:167], a[144:147], v[120:123], a[164:167]
    v_mfma_f32_16x16x32_bf16 a[168:171], a[148:151], v[120:123], a[168:171]
    v_mfma_f32_16x16x32_bf16 a[172:175], a[152:155], v[120:123], a[172:175]
    ds_write_b128 v37, v[164:167] offset:4096
    v_mfma_f32_16x16x32_bf16 a[176:179], a[156:159], v[120:123], a[176:179]
    s_waitcnt vmcnt(9)
    v_mfma_f32_16x16x32_bf16 a[180:183], a[200:203], v[60:63], a[180:183]
    v_mfma_f32_16x16x32_bf16 a[184:187], a[204:207], v[60:63], a[184:187]
    v_mfma_f32_16x16x32_bf16 a[188:191], a[208:211], v[60:63], a[188:191]
    v_mfma_f32_16x16x32_bf16 a[192:195], a[212:215], v[60:63], a[192:195]
    ds_write_b128 v38, a[160:163] offset:0
    v_lshlrev_b32 v148, 16, v168
    v_mfma_f32_16x16x32_bf16 a[196:199], a[216:219], v[60:63], a[196:199]
    v_and_b32 v149, 0xffff0000, v168
    s_waitcnt vmcnt(8)
    v_mfma_f32_16x16x32_bf16 a[180:183], a[220:223], v[76:79], a[180:183]
    v_lshlrev_b32 v150, 16, v169
    v_mfma_f32_16x16x32_bf16 a[184:187], a[224:227], v[76:79], a[184:187]
    v_and_b32 v151, 0xffff0000, v169
    v_mfma_f32_16x16x32_bf16 a[188:191], a[228:231], v[76:79], a[188:191]
    v_lshlrev_b32 v152, 16, v170
    v_mfma_f32_16x16x32_bf16 a[192:195], a[232:235], v[76:79], a[192:195]
    ds_write_b128 v38, a[164:167] offset:1024
    v_and_b32 v153, 0xffff0000, v170
    v_mfma_f32_16x16x32_bf16 a[196:199], a[236:239], v[76:79], a[196:199]
    v_lshlrev_b32 v154, 16, v171
    s_waitcnt vmcnt(7)
    v_mfma_f32_16x16x32_bf16 a[180:183], a[100:103], v[92:95], a[180:183]
    v_and_b32 v155, 0xffff0000, v171
    v_mfma_f32_16x16x32_bf16 a[184:187], a[104:107], v[92:95], a[184:187]
    v_mfma_f32_16x16x32_bf16 a[188:191], a[108:111], v[92:95], a[188:191]
    v_lshlrev_b32 v156, 16, v172
    v_mfma_f32_16x16x32_bf16 a[192:195], a[112:115], v[92:95], a[192:195]
    ds_write_b128 v38, a[168:171] offset:2048
    v_and_b32 v157, 0xffff0000, v172
    v_mfma_f32_16x16x32_bf16 a[196:199], a[116:119], v[92:95], a[196:199]
    v_lshlrev_b32 v158, 16, v173
    s_waitcnt vmcnt(6)
    v_mfma_f32_16x16x32_bf16 a[180:183], a[120:123], v[108:111], a[180:183]
    v_and_b32 v159, 0xffff0000, v173
    v_mfma_f32_16x16x32_bf16 a[184:187], a[124:127], v[108:111], a[184:187]
    v_lshlrev_b32 v160, 16, v174
    v_mfma_f32_16x16x32_bf16 a[188:191], a[128:131], v[108:111], a[188:191]
    v_and_b32 v161, 0xffff0000, v174
    v_mfma_f32_16x16x32_bf16 a[192:195], a[132:135], v[108:111], a[192:195]
    ds_write_b128 v38, a[172:175] offset:3072
    v_lshlrev_b32 v162, 16, v175
    v_mfma_f32_16x16x32_bf16 a[196:199], a[136:139], v[108:111], a[196:199]
    v_and_b32 v163, 0xffff0000, v175
    s_waitcnt vmcnt(5)
    v_mfma_f32_16x16x32_bf16 a[180:183], a[140:143], v[124:127], a[180:183]
    v_lshlrev_b32 v164, 16, v176
    v_mfma_f32_16x16x32_bf16 a[184:187], a[144:147], v[124:127], a[184:187]
    v_mfma_f32_16x16x32_bf16 a[188:191], a[148:151], v[124:127], a[188:191]
    v_and_b32 v165, 0xffff0000, v176
    v_mfma_f32_16x16x32_bf16 a[192:195], a[152:155], v[124:127], a[192:195]
    ds_write_b128 v38, a[176:179] offset:4096
    v_lshlrev_b32 v166, 16, v177
    v_mfma_f32_16x16x32_bf16 a[196:199], a[156:159], v[124:127], a[196:199]
    v_and_b32 v167, 0xffff0000, v177
    s_waitcnt vmcnt(4)
    v_mfma_f32_16x16x32_bf16 v[128:131], a[200:203], v[48:51], v[128:131]
    v_mfma_f32_16x16x32_bf16 v[132:135], a[204:207], v[48:51], v[132:135]
    v_mfma_f32_16x16x32_bf16 v[136:139], a[208:211], v[48:51], v[136:139]
    ds_write_b128 v39, a[180:183] offset:0
    v_mfma_f32_16x16x32_bf16 v[140:143], a[212:215], v[48:51], v[140:143]
    v_mfma_f32_16x16x32_bf16 v[144:147], a[216:219], v[48:51], v[144:147]
    ds_write_b128 v39, a[184:187] offset:1024
    s_waitcnt vmcnt(3)
    v_mfma_f32_16x16x32_bf16 v[128:131], a[220:223], v[64:67], v[128:131]
    v_mfma_f32_16x16x32_bf16 v[132:135], a[224:227], v[64:67], v[132:135]
    ds_write_b128 v39, a[188:191] offset:2048
    v_mfma_f32_16x16x32_bf16 v[136:139], a[228:231], v[64:67], v[136:139]
    v_mfma_f32_16x16x32_bf16 v[140:143], a[232:235], v[64:67], v[140:143]
    ds_write_b128 v39, a[192:195] offset:3072
    v_mfma_f32_16x16x32_bf16 v[144:147], a[236:239], v[64:67], v[144:147]
    s_waitcnt vmcnt(2)
    v_mfma_f32_16x16x32_bf16 v[128:131], a[100:103], v[80:83], v[128:131]
    ds_write_b128 v39, a[196:199] offset:4096
    v_mfma_f32_16x16x32_bf16 v[132:135], a[104:107], v[80:83], v[132:135]
    v_mfma_f32_16x16x32_bf16 v[136:139], a[108:111], v[80:83], v[136:139]
    v_mfma_f32_16x16x32_bf16 v[140:143], a[112:115], v[80:83], v[140:143]
    v_mfma_f32_16x16x32_bf16 v[144:147], a[116:119], v[80:83], v[144:147]
    s_waitcnt vmcnt(1)
    v_mfma_f32_16x16x32_bf16 v[128:131], a[120:123], v[96:99], v[128:131]
    s_waitcnt lgkmcnt(0)
    s_barrier
    ds_read_b128 v[52:55], v36 offset:0
    ds_read_b128 v[68:71], v36 offset:1024
    v_mfma_f32_16x16x32_bf16 v[132:135], a[124:127], v[96:99], v[132:135]
    ds_read_b128 v[84:87], v36 offset:2048
    ds_read_b128 v[100:103], v36 offset:3072
    v_mfma_f32_16x16x32_bf16 v[136:139], a[128:131], v[96:99], v[136:139]
    ds_read_b128 v[116:119], v36 offset:4096
    ds_read_b128 v[56:59], v36 offset:5120
    v_mfma_f32_16x16x32_bf16 v[140:143], a[132:135], v[96:99], v[140:143]
    ds_read_b128 v[72:75], v36 offset:6144
    ds_read_b128 v[88:91], v36 offset:7168
    v_mfma_f32_16x16x32_bf16 v[144:147], a[136:139], v[96:99], v[144:147]
    ds_read_b128 v[104:107], v36 offset:8192
    ds_read_b128 v[120:123], v36 offset:9216
    s_waitcnt vmcnt(0)
    v_mfma_f32_16x16x32_bf16 v[128:131], a[140:143], v[112:115], v[128:131]
    ds_read_b128 v[60:63], v36 offset:10240
    ds_read_b128 v[76:79], v36 offset:11264
    v_mfma_f32_16x16x32_bf16 v[132:135], a[144:147], v[112:115], v[132:135]
    ds_read_b128 v[92:95], v36 offset:12288
    ds_read_b128 v[108:111], v36 offset:13312
    v_mfma_f32_16x16x32_bf16 v[136:139], a[148:151], v[112:115], v[136:139]
    ds_read_b128 v[124:127], v36 offset:14336
    v_mfma_f32_16x16x32_bf16 v[140:143], a[152:155], v[112:115], v[140:143]
    v_mfma_f32_16x16x32_bf16 v[144:147], a[156:159], v[112:115], v[144:147]
    s_waitcnt lgkmcnt(14)
    v_pk_add_f32 v[148:149], v[148:149], v[52:53]
    v_pk_add_f32 v[150:151], v[150:151], v[54:55]
    s_waitcnt lgkmcnt(13)
    v_pk_add_f32 v[152:153], v[152:153], v[68:69]
    v_pk_add_f32 v[154:155], v[154:155], v[70:71]
    s_waitcnt lgkmcnt(12)
    v_pk_add_f32 v[156:157], v[156:157], v[84:85]
    v_pk_add_f32 v[158:159], v[158:159], v[86:87]
    s_waitcnt lgkmcnt(11)
    v_pk_add_f32 v[160:161], v[160:161], v[100:101]
    v_pk_add_f32 v[162:163], v[162:163], v[102:103]
    s_waitcnt lgkmcnt(10)
    v_pk_add_f32 v[164:165], v[164:165], v[116:117]
    v_pk_add_f32 v[166:167], v[166:167], v[118:119]
    s_waitcnt lgkmcnt(9)
    v_pk_add_f32 v[148:149], v[148:149], v[56:57]
    v_pk_add_f32 v[150:151], v[150:151], v[58:59]
    s_waitcnt lgkmcnt(8)
    v_pk_add_f32 v[152:153], v[152:153], v[72:73]
    v_pk_add_f32 v[154:155], v[154:155], v[74:75]
    s_waitcnt lgkmcnt(7)
    v_pk_add_f32 v[156:157], v[156:157], v[88:89]
    v_pk_add_f32 v[158:159], v[158:159], v[90:91]
    s_waitcnt lgkmcnt(6)
    v_pk_add_f32 v[160:161], v[160:161], v[104:105]
    v_pk_add_f32 v[162:163], v[162:163], v[106:107]
    s_waitcnt lgkmcnt(5)
    v_pk_add_f32 v[164:165], v[164:165], v[120:121]
    v_pk_add_f32 v[166:167], v[166:167], v[122:123]
    s_waitcnt lgkmcnt(4)
    v_pk_add_f32 v[148:149], v[148:149], v[60:61]
    v_pk_add_f32 v[150:151], v[150:151], v[62:63]
    s_waitcnt lgkmcnt(3)
    v_pk_add_f32 v[152:153], v[152:153], v[76:77]
    v_pk_add_f32 v[154:155], v[154:155], v[78:79]
    s_waitcnt lgkmcnt(2)
    v_pk_add_f32 v[156:157], v[156:157], v[92:93]
    v_pk_add_f32 v[158:159], v[158:159], v[94:95]
    s_waitcnt lgkmcnt(1)
    v_pk_add_f32 v[160:161], v[160:161], v[108:109]
    v_pk_add_f32 v[162:163], v[162:163], v[110:111]
    s_waitcnt lgkmcnt(0)
    v_pk_add_f32 v[164:165], v[164:165], v[124:125]
    v_pk_add_f32 v[166:167], v[166:167], v[126:127]
    v_pk_add_f32 v[148:149], v[148:149], v[128:129]
    v_pk_add_f32 v[150:151], v[150:151], v[130:131]
    v_pk_add_f32 v[152:153], v[152:153], v[132:133]
    v_pk_add_f32 v[154:155], v[154:155], v[134:135]
    v_pk_add_f32 v[156:157], v[156:157], v[136:137]
    v_pk_add_f32 v[158:159], v[158:159], v[138:139]
    v_pk_add_f32 v[160:161], v[160:161], v[140:141]
    v_pk_add_f32 v[162:163], v[162:163], v[142:143]
    v_pk_add_f32 v[164:165], v[164:165], v[144:145]
    v_pk_add_f32 v[166:167], v[166:167], v[146:147]
    v_cvt_pk_bf16_f32 v168, v148, v149
    v_cvt_pk_bf16_f32 v169, v150, v151
    buffer_store_dwordx2 v[168:169], v9, s[20:23], s76 offen offset:0
    v_cvt_pk_bf16_f32 v170, v152, v153
    v_cvt_pk_bf16_f32 v171, v154, v155
    buffer_store_dwordx2 v[170:171], v9, s[20:23], s76 offen offset:32
    v_cvt_pk_bf16_f32 v172, v156, v157
    v_cvt_pk_bf16_f32 v173, v158, v159
    buffer_store_dwordx2 v[172:173], v9, s[20:23], s76 offen offset:64
    v_cvt_pk_bf16_f32 v174, v160, v161
    v_cvt_pk_bf16_f32 v175, v162, v163
    buffer_store_dwordx2 v[174:175], v9, s[20:23], s76 offen offset:96
    v_cvt_pk_bf16_f32 v176, v164, v165
    v_cvt_pk_bf16_f32 v177, v166, v167
    buffer_store_dwordx2 v[176:177], v9, s[20:23], s76 offen offset:128
    s_endpgm
.p2align 6
L_qkv:
    v_lshrrev_b32 v68, 6, v0
    v_and_b32 v1, 63, v0
    v_readfirstlane_b32 s28, v68
    v_lshlrev_b32 v2, 4, v1
    s_and_b32 s3, s2, 7
    s_lshr_b32 s58, s2, 3
    s_and_b32 s29, s3, 1
    s_lshl_b32 s29, s29, 3
    s_and_b32 s59, s58, 7
    s_add_u32 s29, s29, s59
    s_and_b32 s30, s3, 6
    s_bfe_u32 s60, s2, 0x10006
    s_add_u32 s30, s30, s60
    s_lshl_b32 s31, s3, 2
    s_and_b32 s60, s58, 3
    s_add_u32 s31, s31, s60
    s_lshr_b32 s52, s58, 2
    s_add_u32 s53, s29, s30
    s_mul_i32 s60, s53, 52
    s_lshr_b32 s60, s60, 8
    s_mul_i32 s60, s60, 5
    s_sub_u32 s53, s53, s60
    s_lshl_b32 s53, s53, 1
    v_mov_b32 v15, 0x7f000000
    v_cmp_eq_u32 vcc, 0, v0
    v_accvgpr_write_b32 a255, 1
    v_lshrrev_b32 v68, 3, v1
    v_cndmask_b32 v15, v15, 0, vcc
    v_mul_u32_u24 v68, 1280, v68
    v_lshrrev_b32 v69, 4, v1
    v_and_b32 v70, 7, v1
    v_xor_b32 v69, v69, v70
    v_lshl_add_u32 v3, v69, 4, v68
    v_xor_b32 v69, 4, v69
    v_lshl_add_u32 v4, v69, 4, v68
    v_add_u32 v4, 9216, v4
    v_add_u32 v112, 18432, v3
    v_add_u32 v113, 18432, v4
    s_mov_b32 s6, 2621440
    s_mov_b32 s7, 0x20000
    s_mov_b32 s14, 16777216
    s_mov_b32 s15, 0x20000
    s_mov_b32 s18, 256
    s_mov_b32 s19, 0x20000
    s_mov_b32 s22, 2621440
    s_mov_b32 s23, 0x20000
    s_mov_b32 s11, 0x20000
    s_mov_b32 s27, 0x20000
    s_lshl_b32 s54, s29, 2
    s_add_u32 s54, s54, s28
    s_mul_i32 s64, s54, 139264
    s_add_u32 s64, s64, 1048576
    s_mul_i32 s72, s54, 3072
    s_cmp_eq_u32 s30, 7
    s_cselect_b32 s26, 16777216, 0
    s_cselect_b32 s73, 0, 0x7f000000
    v_mov_b32 v100, 0
    v_mov_b32 v101, 0
    v_mov_b32 v102, 0
    v_mov_b32 v103, 0
    s_mul_i32 s54, s54, 40960
    s_lshl_b32 s62, s28, 14
    s_lshl_b32 s56, s53, 7
    s_add_u32 s56, s56, s54
    s_add_u32 s90, s54, 1280
    s_mov_b32 s10, 2457600
    s_mul_i32 s55, s30, 160
    s_mul_i32 s63, s28, 5120
    s_mul_i32 s80, s53, 245760
    s_add_u32 s80, s80, s55
    s_add_u32 s91, s55, 2457600
    s_mul_i32 s59, s28, 61440
    s_add_u32 s60, s59, 1280
    s_sub_u32 s61, s59, 1280
    v_add_u32 v68, 0, v1
    v_mul_u32_u24 v69, 3277, v68
    v_lshrrev_b32 v69, 16, v69
    v_mul_u32_u24 v70, 20, v69
    v_sub_u32 v70, v68, v70
    v_mul_u32_u24 v71, 13108, v70
    v_lshrrev_b32 v71, 16, v71
    v_mul_u32_u24 v72, 5, v71
    v_sub_u32 v72, v70, v72
    v_and_b32 v73, 1, v71
    v_lshrrev_b32 v71, 1, v71
    v_mul_u32_u24 v71, 80, v71
    v_lshl_add_u32 v71, v72, 4, v71
    v_mul_u32_u24 v74, 3840, v69
    v_mul_u32_u24 v75, 1280, v73
    v_add3_u32 v5, v74, v75, v71
    v_add_u32 v5, s60, v5
    v_lshrrev_b32 v74, 2, v69
    v_lshl_add_u32 v10, v74, 1, v73
    v_add_u32 v68, 64, v1
    v_mul_u32_u24 v69, 3277, v68
    v_lshrrev_b32 v69, 16, v69
    v_mul_u32_u24 v70, 20, v69
    v_sub_u32 v70, v68, v70
    v_mul_u32_u24 v71, 13108, v70
    v_lshrrev_b32 v71, 16, v71
    v_mul_u32_u24 v72, 5, v71
    v_sub_u32 v72, v70, v72
    v_and_b32 v73, 1, v71
    v_lshrrev_b32 v71, 1, v71
    v_mul_u32_u24 v71, 80, v71
    v_lshl_add_u32 v71, v72, 4, v71
    v_subrev_u32 v71, 1024, v71
    v_mul_u32_u24 v74, 3840, v69
    v_mul_u32_u24 v75, 1280, v73
    v_add3_u32 v6, v74, v75, v71
    v_add_u32 v6, s60, v6
    v_lshrrev_b32 v74, 2, v69
    v_lshl_add_u32 v11, v74, 1, v73
    v_add_u32 v68, 128, v1
    v_mul_u32_u24 v69, 3277, v68
    v_lshrrev_b32 v69, 16, v69
    v_mul_u32_u24 v70, 20, v69
    v_sub_u32 v70, v68, v70
    v_mul_u32_u24 v71, 13108, v70
    v_lshrrev_b32 v71, 16, v71
    v_mul_u32_u24 v72, 5, v71
    v_sub_u32 v72, v70, v72
    v_and_b32 v73, 1, v71
    v_lshrrev_b32 v71, 1, v71
    v_mul_u32_u24 v71, 80, v71
    v_lshl_add_u32 v71, v72, 4, v71
    v_subrev_u32 v71, 2048, v71
    v_mul_u32_u24 v74, 3840, v69
    v_mul_u32_u24 v75, 1280, v73
    v_add3_u32 v7, v74, v75, v71
    v_add_u32 v7, s60, v7
    v_lshrrev_b32 v74, 2, v69
    v_lshl_add_u32 v12, v74, 1, v73
    v_add_u32 v68, 192, v1
    v_mul_u32_u24 v69, 3277, v68
    v_lshrrev_b32 v69, 16, v69
    v_mul_u32_u24 v70, 20, v69
    v_sub_u32 v70, v68, v70
    v_mul_u32_u24 v71, 13108, v70
    v_lshrrev_b32 v71, 16, v71
    v_mul_u32_u24 v72, 5, v71
    v_sub_u32 v72, v70, v72
    v_and_b32 v73, 1, v71
    v_lshrrev_b32 v71, 1, v71
    v_mul_u32_u24 v71, 80, v71
    v_lshl_add_u32 v71, v72, 4, v71
    v_subrev_u32 v71, 3072, v71
    v_mul_u32_u24 v74, 3840, v69
    v_mul_u32_u24 v75, 1280, v73
    v_add3_u32 v8, v74, v75, v71
    v_add_u32 v8, s60, v8
    v_lshrrev_b32 v74, 2, v69
    v_lshl_add_u32 v13, v74, 1, v73
    v_add_u32 v68, 256, v1
    v_mul_u32_u24 v69, 3277, v68
    v_lshrrev_b32 v69, 16, v69
    v_mul_u32_u24 v70, 20, v69
    v_sub_u32 v70, v68, v70
    v_mul_u32_u24 v71, 13108, v70
    v_lshrrev_b32 v71, 16, v71
    v_mul_u32_u24 v72, 5, v71
    v_sub_u32 v72, v70, v72
    v_and_b32 v73, 1, v71
    v_lshrrev_b32 v71, 1, v71
    v_mul_u32_u24 v71, 80, v71
    v_lshl_add_u32 v71, v72, 4, v71
    v_mul_u32_u24 v74, 3840, v69
    v_mul_u32_u24 v75, 1280, v73
    v_add3_u32 v9, v74, v75, v71
    v_add_u32 v9, s60, v9
    v_lshrrev_b32 v74, 2, v69
    v_lshl_add_u32 v14, v74, 1, v73
    s_waitcnt lgkmcnt(0)
    s_mov_b32 s4, s32
    s_mov_b32 s5, s33
    s_mov_b32 s24, s12
    s_mov_b32 s25, s13
    buffer_store_dwordx4 v[100:103], v2, s[24:27], s72 offen offset:0 sc1
    buffer_store_dwordx4 v[100:103], v2, s[24:27], s72 offen offset:1024 sc1
    buffer_store_dwordx4 v[100:103], v2, s[24:27], s72 offen offset:2048 sc1
    s_add_u32 m0, s62, 0
    s_nop 0
    buffer_load_dwordx4 v3, s[4:7], s56 offen offset:0 lds
    buffer_load_dwordx4 v4, s[4:7], s56 offen offset:1024 lds
    buffer_load_dwordx4 v112, s[4:7], s56 offen offset:2048 lds
    buffer_load_dwordx4 v113, s[4:7], s56 offen offset:3072 lds
    s_add_u32 s56, s56, 128
    s_cmp_eq_u32 s56, s90
    s_cselect_b32 s56, s54, s56
    s_mov_b32 s8, s34
    s_mov_b32 s9, s35
    s_add_u32 m0, s63, 67584
    s_nop 0
    buffer_load_dwordx4 v5, s[8:11], s80 offen offset:0 lds
    buffer_load_dwordx4 v6, s[8:11], s80 offen offset:1024 lds
    buffer_load_dwordx4 v7, s[8:11], s80 offen offset:2048 lds
    buffer_load_dwordx4 v8, s[8:11], s80 offen offset:3072 lds
    s_add_u32 m0, s63, 71680
    s_nop 0
    buffer_load_dwordx4 v9, s[8:11], s80 offen lds
    s_mov_b32 s16, s50
    s_mov_b32 s17, s51
    s_mov_b32 s20, s48
    s_mov_b32 s21, s49
    s_add_u32 s81, s80, 245760
    s_add_u32 s82, s81, 245760
    s_cmp_eq_u32 s82, s91
    s_cselect_b32 s82, s55, s82
    s_add_u32 s83, s82, 245760
    s_add_u32 s84, s83, 245760
    s_cmp_eq_u32 s84, s91
    s_cselect_b32 s84, s55, s84
    s_add_u32 s85, s84, 245760
    s_add_u32 s86, s85, 245760
    s_cmp_eq_u32 s86, s91
    s_cselect_b32 s86, s55, s86
    s_add_u32 s87, s86, 245760
    s_add_u32 s88, s87, 245760
    s_cmp_eq_u32 s88, s91
    s_cselect_b32 s88, s55, s88
    s_add_u32 s89, s88, 245760
    v_lshrrev_b32 v74, 1, v10
    v_and_b32 v73, 1, v10
    v_mul_u32_u24 v74, 15360, v74
    v_mul_u32_u24 v73, 14080, v73
    v_add3_u32 v10, v74, v73, v5
    v_add_u32 v10, s61, v10
    v_lshrrev_b32 v74, 1, v11
    v_and_b32 v73, 1, v11
    v_mul_u32_u24 v74, 15360, v74
    v_mul_u32_u24 v73, 14080, v73
    v_add3_u32 v11, v74, v73, v6
    v_add_u32 v11, s61, v11
    v_lshrrev_b32 v74, 1, v12
    v_and_b32 v73, 1, v12
    v_mul_u32_u24 v74, 15360, v74
    v_mul_u32_u24 v73, 14080, v73
    v_add3_u32 v12, v74, v73, v7
    v_add_u32 v12, s61, v12
    v_lshrrev_b32 v74, 1, v13
    v_and_b32 v73, 1, v13
    v_mul_u32_u24 v74, 15360, v74
    v_mul_u32_u24 v73, 14080, v73
    v_add3_u32 v13, v74, v73, v8
    v_add_u32 v13, s61, v13
    v_lshrrev_b32 v74, 1, v14
    v_and_b32 v73, 1, v14
    v_mul_u32_u24 v74, 15360, v74
    v_mul_u32_u24 v73, 14080, v73
    v_add3_u32 v14, v74, v73, v9
    v_add_u32 v14, s61, v14
    s_getpc_b64 s[48:49]
L_pcq:
    s_sub_u32 s48, s48, (L_pcq-parallel_sum__linear_kernel_hedgehog__glu_gated_glu__prompt_kernel)
    s_subb_u32 s49, s49, 0
    s_lshr_b32 s50, s2, 3
    s_lshl_b32 s50, s50, 2
    s_add_u32 s50, s50, s28
    s_lshl_b32 s50, s50, 10
    v_and_b32 v68, 7, v1
    v_lshl_add_u32 v68, v68, 7, s50
    v_min_u32 v68, (L_end-parallel_sum__linear_kernel_hedgehog__glu_gated_glu__prompt_kernel), v68
    global_load_dword a254, v68, s[48:49]
    v_mov_b32 v70, 0
    v_mov_b32 v71, 0
    s_lshl_b32 s58, s28, 9
    s_add_u32 s58, s58, 149504
    v_lshl_add_u32 v72, v1, 3, s58
    ds_write_b64 v72, v[70:71]
    v_and_b32 v68, 31, v1
    v_bfe_u32 v69, v1, 1, 3
    v_lshrrev_b32 v70, 5, v1
    v_xor_b32 v69, v69, v70
    s_lshl_b32 s58, s28, 1
    v_xor_b32 v69, s58, v69
    v_lshlrev_b32 v68, 7, v68
    v_add_u32 v68, s62, v68
    v_xor_b32 v70, 0, v69
    v_lshl_add_u32 v16, v70, 4, v68
    v_xor_b32 v70, 2, v69
    v_lshl_add_u32 v17, v70, 4, v68
    v_xor_b32 v70, 4, v69
    v_lshl_add_u32 v18, v70, 4, v68
    v_xor_b32 v70, 6, v69
    v_lshl_add_u32 v19, v70, 4, v68
    v_lshrrev_b32 v68, 4, v1
    v_xor_b32 v68, v68, v1
    v_and_b32 v68, 1, v68
    v_cmp_eq_u32 vcc, 0, v68
    v_mov_b32 v69, 0x3f803f80
    s_nop 0
    v_cndmask_b32 v36, 0, v69, vcc
    v_cndmask_b32 v37, 0, v69, vcc
    v_cndmask_b32 v38, 0, v69, vcc
    v_cndmask_b32 v39, 0, v69, vcc
    s_mov_b32 s96, 0x0000ffff
    s_mov_b32 s97, 0x0000ffff
    v_lshrrev_b32 v68, 5, v1
    v_bfe_u32 v69, v1, 2, 2
    v_lshl_add_u32 v70, v68, 3, v69
    v_lshl_add_u32 v71, v68, 2, v69
    v_mul_u32_u24 v70, 320, v70
    v_mul_u32_u24 v71, 320, v71
    v_and_b32 v72, 1, v1
    v_mul_u32_u24 v72, 160, v72
    v_bfe_u32 v73, v1, 4, 1
    v_bfe_u32 v74, v1, 1, 1
    v_lshl_add_u32 v73, v73, 1, v74
    v_lshl_add_u32 v72, v73, 3, v72
    v_add_u32 v72, 67584, v72
    v_add_u32 v70, v70, v72
    v_add_u32 v71, v71, v72
    s_xor_b32 s58, s28, 0
    s_mul_i32 s59, s58, 5120
    s_mul_i32 s58, s58, 2560
    v_add_u32 v20, s59, v70
    v_add_u32 v28, s58, v71
    v_add_u32 v24, 61440, v20
    v_add_u32 v32, 40960, v28
    v_subrev_u32 v28, 20480, v28
    s_xor_b32 s58, s28, 1
    s_mul_i32 s59, s58, 5120
    s_mul_i32 s58, s58, 2560
    v_add_u32 v21, s59, v70
    v_add_u32 v29, s58, v71
    v_add_u32 v25, 61440, v21
    v_add_u32 v33, 40960, v29
    v_subrev_u32 v29, 20480, v29
    s_xor_b32 s58, s28, 2
    s_mul_i32 s59, s58, 5120
    s_mul_i32 s58, s58, 2560
    v_add_u32 v22, s59, v70
    v_add_u32 v30, s58, v71
    v_add_u32 v26, 61440, v22
    v_add_u32 v34, 40960, v30
    v_subrev_u32 v30, 20480, v30
    s_xor_b32 s58, s28, 3
    s_mul_i32 s59, s58, 5120
    s_mul_i32 s58, s58, 2560
    v_add_u32 v23, s59, v70
    v_add_u32 v31, s58, v71
    v_add_u32 v27, 61440, v23
    v_add_u32 v35, 40960, v31
    v_subrev_u32 v31, 20480, v31
    s_add_u32 s60, s28, s52
    s_and_b32 s65, s60, 3
    s_mul_i32 s60, s52, 348160
    s_add_u32 s60, s60, 12582912
    s_mul_i32 s66, s65, 20480
    s_add_u32 s66, s66, s60
    s_add_u32 s67, s66, 81920
    s_add_u32 s68, s66, 163840
    s_mul_i32 s69, s65, 25600
    s_add_u32 s69, s69, s60
    s_add_u32 s69, s69, 245760
    s_mul_i32 s92, s28, 10240
    s_mul_i32 s93, s28, 25600
    s_lshl_b32 s40, s30, 8
    s_add_u32 s40, s40, 185344
    s_lshl_b32 s41, s29, 7
    s_add_u32 s41, s41, 183296
    s_lshl_b32 s58, s29, 2
    s_add_u32 s43, s40, s58
    s_add_u32 s38, s58, s28
    s_lshl_b32 s38, s38, 7
    s_add_u32 s38, s38, 163840
    s_lshl_b32 s39, s30, 10
    s_add_u32 s39, s39, 155648
    v_and_b32 v119, 31, v1
    v_lshlrev_b32 v119, 2, v119
    s_cmp_lt_u32 s29, 5
    s_cselect_b32 s98, -1, 0
    s_mov_b32 s99, 0
    v_mov_b32 v116, 0x7f000000
    v_cndmask_b32 v116, v116, v119, s[98:99]
    s_cmp_lt_u32 s29, 5
    s_cselect_b32 s98, -1, 0
    s_mov_b32 s99, s98
    v_mov_b32 v117, 0x7f000000
    v_cndmask_b32 v117, v117, v15, s[98:99]
    v_and_b32 v120, 15, v1
    v_lshlrev_b32 v120, 2, v120
    v_add_u32 v118, s40, v120
    v_add_u32 v120, s41, v120
    v_cndmask_b32 v118, v120, v118, s[96:97]
    v_or_b32 v114, s73, v15
    s_lshl_b32 s73, s29, 2
    s_waitcnt vmcnt(10)
    s_barrier
    buffer_store_dword a255, v114, s[16:19], s73 offen sc1
    s_add_u32 m0, s62, 4096
    s_nop 0
    buffer_load_dwordx4 v3, s[4:7], s56 offen offset:0 lds
    buffer_load_dwordx4 v4, s[4:7], s56 offen offset:1024 lds
    buffer_load_dwordx4 v112, s[4:7], s56 offen offset:2048 lds
    buffer_load_dwordx4 v113, s[4:7], s56 offen offset:3072 lds
    s_add_u32 s56, s56, 128
    s_cmp_eq_u32 s56, s90
    s_cselect_b32 s56, s54, s56
    s_add_u32 m0, s63, 88064
    s_nop 0
    buffer_load_dwordx4 v5, s[8:11], s81 offen offset:0 lds
    buffer_load_dwordx4 v6, s[8:11], s81 offen offset:1024 lds
    buffer_load_dwordx4 v7, s[8:11], s81 offen offset:2048 lds
    buffer_load_dwordx4 v8, s[8:11], s81 offen offset:3072 lds
    s_add_u32 m0, s63, 92160
    s_nop 0
    buffer_load_dwordx4 v9, s[8:11], s81 offen lds
    s_waitcnt vmcnt(11)
    s_barrier
    ds_read_b128 a[0:3], v16 offset:0
    ds_read_b128 a[4:7], v17 offset:0
    ds_read_b128 a[8:11], v18 offset:0
    ds_read_b128 a[12:15], v19 offset:0
    ds_read_b64_tr_b16 a[160:161], v20 offset:0
    ds_read_b64_tr_b16 a[162:163], v20 offset:1280
    ds_read_b64_tr_b16 a[164:165], v20 offset:32
    ds_read_b64_tr_b16 a[166:167], v20 offset:1312
    ds_read_b64_tr_b16 a[168:169], v20 offset:64
    ds_read_b64_tr_b16 a[170:171], v20 offset:1344
    ds_read_b64_tr_b16 a[172:173], v20 offset:96
    ds_read_b64_tr_b16 a[174:175], v20 offset:1376
    ds_read_b64_tr_b16 a[176:177], v20 offset:128
    ds_read_b64_tr_b16 a[178:179], v20 offset:1408
    ds_read_b64_tr_b16 a[180:181], v21 offset:0
    ds_read_b64_tr_b16 a[182:183], v21 offset:1280
    ds_read_b64_tr_b16 a[184:185], v21 offset:32
    ds_read_b64_tr_b16 a[186:187], v21 offset:1312
    s_waitcnt lgkmcnt(10)
    v_mfma_f32_32x32x16_bf16 v[128:143], a[160:163], a[0:3], 0
    ds_read_b64_tr_b16 a[188:189], v21 offset:64
    ds_read_b64_tr_b16 a[190:191], v21 offset:1344
    s_add_u32 m0, s62, 8192
    s_nop 0
    buffer_load_dwordx4 v3, s[4:7], s56 offen offset:0 lds
    v_mfma_f32_16x16x32_bf16 v[48:51], v[36:39], a[160:163], 0
    v_mfma_f32_32x32x16_bf16 v[144:159], a[164:167], a[0:3], 0
    ds_read_b64_tr_b16 a[192:193], v21 offset:96
    ds_read_b64_tr_b16 a[194:195], v21 offset:1376
    buffer_load_dwordx4 v4, s[4:7], s56 offen offset:1024 lds
    v_mfma_f32_16x16x32_bf16 v[52:55], v[36:39], a[164:167], 0
    s_waitcnt lgkmcnt(10)
    v_mfma_f32_32x32x16_bf16 v[160:175], a[168:171], a[0:3], 0
    ds_read_b64_tr_b16 a[196:197], v21 offset:128
    ds_read_b64_tr_b16 a[198:199], v21 offset:1408
    buffer_load_dwordx4 v112, s[4:7], s56 offen offset:2048 lds
    v_mfma_f32_16x16x32_bf16 v[56:59], v[36:39], a[168:171], 0
    v_mfma_f32_32x32x16_bf16 v[176:191], a[172:175], a[0:3], 0
    ds_read_b64_tr_b16 a[160:161], v22 offset:0
    ds_read_b64_tr_b16 a[162:163], v22 offset:1280
    buffer_load_dwordx4 v113, s[4:7], s56 offen offset:3072 lds
    v_mfma_f32_16x16x32_bf16 v[60:63], v[36:39], a[172:175], 0
    s_waitcnt lgkmcnt(10)
    v_mfma_f32_32x32x16_bf16 v[192:207], a[176:179], a[0:3], 0
    ds_read_b64_tr_b16 a[164:165], v22 offset:32
    ds_read_b64_tr_b16 a[166:167], v22 offset:1312
    s_add_u32 s56, s56, 128
    s_cmp_eq_u32 s56, s90
    s_cselect_b32 s56, s54, s56
    s_add_u32 m0, s63, 108544
    s_nop 0
    buffer_load_dwordx4 v5, s[8:11], s82 offen offset:0 lds
    v_mfma_f32_16x16x32_bf16 v[64:67], v[36:39], a[176:179], 0
    v_mfma_f32_32x32x16_bf16 v[128:143], a[180:183], a[4:7], v[128:143]
    ds_read_b64_tr_b16 a[168:169], v22 offset:64
    ds_read_b64_tr_b16 a[170:171], v22 offset:1344
    buffer_load_dwordx4 v6, s[8:11], s82 offen offset:1024 lds
    s_waitcnt lgkmcnt(10)
    v_mfma_f32_32x32x16_bf16 v[144:159], a[184:187], a[4:7], v[144:159]
    ds_read_b64_tr_b16 a[172:173], v22 offset:96
    ds_read_b64_tr_b16 a[174:175], v22 offset:1376
    buffer_load_dwordx4 v7, s[8:11], s82 offen offset:2048 lds
    v_mfma_f32_32x32x16_bf16 v[160:175], a[188:191], a[4:7], v[160:175]
    ds_read_b64_tr_b16 a[176:177], v22 offset:128
    ds_read_b64_tr_b16 a[178:179], v22 offset:1408
    buffer_load_dwordx4 v8, s[8:11], s82 offen offset:3072 lds
    s_waitcnt lgkmcnt(10)
    v_mfma_f32_32x32x16_bf16 v[176:191], a[192:195], a[4:7], v[176:191]
    ds_read_b64_tr_b16 a[180:181], v23 offset:0
    ds_read_b64_tr_b16 a[182:183], v23 offset:1280
    s_add_u32 m0, s63, 112640
    s_nop 0
    buffer_load_dwordx4 v9, s[8:11], s82 offen lds
    v_mfma_f32_32x32x16_bf16 v[192:207], a[196:199], a[4:7], v[192:207]
    ds_read_b64_tr_b16 a[184:185], v23 offset:32
    ds_read_b64_tr_b16 a[186:187], v23 offset:1312
    s_mov_b32 s24, s36
    s_mov_b32 s25, s37
    s_mov_b32 s26, 25600
    s_mul_i32 s58, s30, 3200
    s_lshl_b32 s59, s28, 10
    s_add_u32 s58, s58, s59
    s_add_u32 m0, s59, 153600
    s_nop 0
    buffer_load_dwordx4 v2, s[24:27], s58 offen lds
    s_waitcnt lgkmcnt(10)
    v_mfma_f32_32x32x16_bf16 v[128:143], a[160:163], a[8:11], v[128:143]
    ds_read_b64_tr_b16 a[188:189], v23 offset:64
    ds_read_b64_tr_b16 a[190:191], v23 offset:1344
    s_mov_b32 s24, s12
    s_mov_b32 s25, s13
    s_add_u32 m0, s62, 12288
    s_nop 0
    buffer_load_dwordx4 v3, s[4:7], s56 offen offset:0 lds
    v_mfma_f32_32x32x16_bf16 v[144:159], a[164:167], a[8:11], v[144:159]
    ds_read_b64_tr_b16 a[192:193], v23 offset:96
    ds_read_b64_tr_b16 a[194:195], v23 offset:1376
    buffer_load_dwordx4 v4, s[4:7], s56 offen offset:1024 lds
    s_waitcnt lgkmcnt(10)
    v_mfma_f32_32x32x16_bf16 v[160:175], a[168:171], a[8:11], v[160:175]
    ds_read_b64_tr_b16 a[196:197], v23 offset:128
    ds_read_b64_tr_b16 a[198:199], v23 offset:1408
    buffer_load_dwordx4 v112, s[4:7], s56 offen offset:2048 lds
    v_mfma_f32_32x32x16_bf16 v[176:191], a[172:175], a[8:11], v[176:191]
    s_waitcnt vmcnt(13)
    s_barrier
    ds_read_b64_tr_b16 a[160:161], v20 offset:20480
    ds_read_b64_tr_b16 a[162:163], v20 offset:21760
    buffer_load_dwordx4 v113, s[4:7], s56 offen offset:3072 lds
    s_add_u32 s56, s56, 128
    s_cmp_eq_u32 s56, s90
    s_cselect_b32 s56, s54, s56
    ds_read_b128 a[16:19], v16 offset:4096
    s_waitcnt lgkmcnt(11)
    v_mfma_f32_32x32x16_bf16 v[192:207], a[176:179], a[8:11], v[192:207]
    ds_read_b64_tr_b16 a[164:165], v20 offset:20512
    ds_read_b64_tr_b16 a[166:167], v20 offset:21792
    ds_read_b128 a[20:23], v17 offset:4096
    s_add_u32 m0, s62, 0
    s_nop 0
    buffer_load_dwordx4 v3, s[4:7], s56 offen offset:0 lds
    v_mfma_f32_32x32x16_bf16 v[128:143], a[180:183], a[12:15], v[128:143]
    ds_read_b64_tr_b16 a[168:169], v20 offset:20544
    ds_read_b64_tr_b16 a[170:171], v20 offset:21824
    ds_read_b128 a[24:27], v18 offset:4096
    buffer_load_dwordx4 v4, s[4:7], s56 offen offset:1024 lds
    s_waitcnt lgkmcnt(13)
    v_mfma_f32_32x32x16_bf16 v[144:159], a[184:187], a[12:15], v[144:159]
    ds_read_b64_tr_b16 a[172:173], v20 offset:20576
    ds_read_b64_tr_b16 a[174:175], v20 offset:21856
    ds_read_b128 a[28:31], v19 offset:4096
    buffer_load_dwordx4 v112, s[4:7], s56 offen offset:2048 lds
    v_mfma_f32_32x32x16_bf16 v[160:175], a[188:191], a[12:15], v[160:175]
    ds_read_b64_tr_b16 a[176:177], v20 offset:20608
    ds_read_b64_tr_b16 a[178:179], v20 offset:21888
    buffer_load_dwordx4 v113, s[4:7], s56 offen offset:3072 lds
    s_waitcnt lgkmcnt(14)
    v_mfma_f32_32x32x16_bf16 v[176:191], a[192:195], a[12:15], v[176:191]
    ds_read_b64_tr_b16 a[180:181], v21 offset:20480
    ds_read_b64_tr_b16 a[182:183], v21 offset:21760
    s_add_u32 s56, s56, 128
    s_cmp_eq_u32 s56, s90
    s_cselect_b32 s56, s54, s56
    s_add_u32 m0, s63, 129024
    s_nop 0
    buffer_load_dwordx4 v5, s[8:11], s83 offen offset:0 lds
    v_mfma_f32_32x32x16_bf16 v[192:207], a[196:199], a[12:15], v[192:207]
    ds_read_b64_tr_b16 a[184:185], v21 offset:20512
    ds_read_b64_tr_b16 a[186:187], v21 offset:21792
    buffer_load_dwordx4 v6, s[8:11], s83 offen offset:1024 lds
    s_waitcnt lgkmcnt(13)
    v_mfma_f32_32x32x16_bf16 v[128:143], a[160:163], a[16:19], v[128:143]
    ds_read_b64_tr_b16 a[188:189], v21 offset:20544
    ds_read_b64_tr_b16 a[190:191], v21 offset:21824
    buffer_load_dwordx4 v7, s[8:11], s83 offen offset:2048 lds
    v_mfma_f32_16x16x32_bf16 v[48:51], v[36:39], a[160:163], v[48:51]
    v_mfma_f32_32x32x16_bf16 v[144:159], a[164:167], a[16:19], v[144:159]
    ds_read_b64_tr_b16 a[192:193], v21 offset:20576
    ds_read_b64_tr_b16 a[194:195], v21 offset:21856
    buffer_load_dwordx4 v8, s[8:11], s83 offen offset:3072 lds
    v_mfma_f32_16x16x32_bf16 v[52:55], v[36:39], a[164:167], v[52:55]
    s_waitcnt lgkmcnt(11)
    v_mfma_f32_32x32x16_bf16 v[160:175], a[168:171], a[16:19], v[160:175]
    ds_read_b64_tr_b16 a[196:197], v21 offset:20608
    ds_read_b64_tr_b16 a[198:199], v21 offset:21888
    s_add_u32 m0, s63, 133120
    s_nop 0
    buffer_load_dwordx4 v9, s[8:11], s83 offen lds
    v_mfma_f32_16x16x32_bf16 v[56:59], v[36:39], a[168:171], v[56:59]
    v_mfma_f32_32x32x16_bf16 v[176:191], a[172:175], a[16:19], v[176:191]
    ds_read_b64_tr_b16 a[160:161], v22 offset:20480
    ds_read_b64_tr_b16 a[162:163], v22 offset:21760
    v_mfma_f32_16x16x32_bf16 v[60:63], v[36:39], a[172:175], v[60:63]
    s_waitcnt lgkmcnt(10)
    v_mfma_f32_32x32x16_bf16 v[192:207], a[176:179], a[16:19], v[192:207]
    ds_read_b64_tr_b16 a[164:165], v22 offset:20512
    ds_read_b64_tr_b16 a[166:167], v22 offset:21792
    v_mfma_f32_16x16x32_bf16 v[64:67], v[36:39], a[176:179], v[64:67]
    v_mfma_f32_32x32x16_bf16 v[128:143], a[180:183], a[20:23], v[128:143]
    ds_read_b64_tr_b16 a[168:169], v22 offset:20544
    ds_read_b64_tr_b16 a[170:171], v22 offset:21824
    s_waitcnt lgkmcnt(10)
    v_mfma_f32_32x32x16_bf16 v[144:159], a[184:187], a[20:23], v[144:159]
    ds_read_b64_tr_b16 a[172:173], v22 offset:20576
    ds_read_b64_tr_b16 a[174:175], v22 offset:21856
    v_mfma_f32_32x32x16_bf16 v[160:175], a[188:191], a[20:23], v[160:175]
    ds_read_b64_tr_b16 a[176:177], v22 offset:20608
    ds_read_b64_tr_b16 a[178:179], v22 offset:21888
    s_waitcnt lgkmcnt(10)
    v_mfma_f32_32x32x16_bf16 v[176:191], a[192:195], a[20:23], v[176:191]
    ds_read_b64_tr_b16 a[180:181], v23 offset:20480
    ds_read_b64_tr_b16 a[182:183], v23 offset:21760
    v_mfma_f32_32x32x16_bf16 v[192:207], a[196:199], a[20:23], v[192:207]
    ds_read_b64_tr_b16 a[184:185], v23 offset:20512
    ds_read_b64_tr_b16 a[186:187], v23 offset:21792
    s_waitcnt lgkmcnt(10)
    v_mfma_f32_32x32x16_bf16 v[128:143], a[160:163], a[24:27], v[128:143]
    ds_read_b64_tr_b16 a[188:189], v23 offset:20544
    ds_read_b64_tr_b16 a[190:191], v23 offset:21824
    v_mfma_f32_32x32x16_bf16 v[144:159], a[164:167], a[24:27], v[144:159]
    ds_read_b64_tr_b16 a[192:193], v23 offset:20576
    ds_read_b64_tr_b16 a[194:195], v23 offset:21856
    s_waitcnt lgkmcnt(10)
    v_mfma_f32_32x32x16_bf16 v[160:175], a[168:171], a[24:27], v[160:175]
    ds_read_b64_tr_b16 a[196:197], v23 offset:20608
    ds_read_b64_tr_b16 a[198:199], v23 offset:21888
    v_mfma_f32_32x32x16_bf16 v[176:191], a[172:175], a[24:27], v[176:191]
    s_waitcnt vmcnt(14)
    s_barrier
    ds_read_b64_tr_b16 a[160:161], v20 offset:40960
    ds_read_b64_tr_b16 a[162:163], v20 offset:42240
    ds_read_b128 a[32:35], v16 offset:8192
    s_waitcnt lgkmcnt(11)
    v_mfma_f32_32x32x16_bf16 v[192:207], a[176:179], a[24:27], v[192:207]
    ds_read_b64_tr_b16 a[164:165], v20 offset:40992
    ds_read_b64_tr_b16 a[166:167], v20 offset:42272
    ds_read_b128 a[36:39], v17 offset:8192
    s_add_u32 m0, s62, 4096
    s_nop 0
    buffer_load_dwordx4 v3, s[4:7], s56 offen offset:0 lds
    v_mfma_f32_32x32x16_bf16 v[128:143], a[180:183], a[28:31], v[128:143]
    ds_read_b64_tr_b16 a[168:169], v20 offset:41024
    ds_read_b64_tr_b16 a[170:171], v20 offset:42304
    ds_read_b128 a[40:43], v18 offset:8192
    buffer_load_dwordx4 v4, s[4:7], s56 offen offset:1024 lds
    s_waitcnt lgkmcnt(13)
    v_mfma_f32_32x32x16_bf16 v[144:159], a[184:187], a[28:31], v[144:159]
    ds_read_b64_tr_b16 a[172:173], v20 offset:41056
    ds_read_b64_tr_b16 a[174:175], v20 offset:42336
    ds_read_b128 a[44:47], v19 offset:8192
    buffer_load_dwordx4 v112, s[4:7], s56 offen offset:2048 lds
    v_mfma_f32_32x32x16_bf16 v[160:175], a[188:191], a[28:31], v[160:175]
    ds_read_b64_tr_b16 a[176:177], v20 offset:41088
    ds_read_b64_tr_b16 a[178:179], v20 offset:42368
    buffer_load_dwordx4 v113, s[4:7], s56 offen offset:3072 lds
    s_waitcnt lgkmcnt(14)
    v_mfma_f32_32x32x16_bf16 v[176:191], a[192:195], a[28:31], v[176:191]
    ds_read_b64_tr_b16 a[180:181], v21 offset:40960
    ds_read_b64_tr_b16 a[182:183], v21 offset:42240
    s_add_u32 s56, s56, 128
    s_cmp_eq_u32 s56, s90
    s_cselect_b32 s56, s54, s56
    s_add_u32 m0, s63, 67584
    s_nop 0
    buffer_load_dwordx4 v5, s[8:11], s84 offen offset:0 lds
    v_mfma_f32_32x32x16_bf16 v[192:207], a[196:199], a[28:31], v[192:207]
    ds_read_b64_tr_b16 a[184:185], v21 offset:40992
    ds_read_b64_tr_b16 a[186:187], v21 offset:42272
    buffer_load_dwordx4 v6, s[8:11], s84 offen offset:1024 lds
    s_waitcnt lgkmcnt(13)
    v_mfma_f32_32x32x16_bf16 v[128:143], a[160:163], a[32:35], v[128:143]
    ds_read_b64_tr_b16 a[188:189], v21 offset:41024
    ds_read_b64_tr_b16 a[190:191], v21 offset:42304
    buffer_load_dwordx4 v7, s[8:11], s84 offen offset:2048 lds
    v_mfma_f32_32x32x16_bf16 v[144:159], a[164:167], a[32:35], v[144:159]
    ds_read_b64_tr_b16 a[192:193], v21 offset:41056
    ds_read_b64_tr_b16 a[194:195], v21 offset:42336
    buffer_load_dwordx4 v8, s[8:11], s84 offen offset:3072 lds
    s_waitcnt lgkmcnt(11)
    v_mfma_f32_32x32x16_bf16 v[160:175], a[168:171], a[32:35], v[160:175]
    ds_read_b64_tr_b16 a[196:197], v21 offset:41088
    ds_read_b64_tr_b16 a[198:199], v21 offset:42368
    s_add_u32 m0, s63, 71680
    s_nop 0
    buffer_load_dwordx4 v9, s[8:11], s84 offen lds
    v_mfma_f32_32x32x16_bf16 v[176:191], a[172:175], a[32:35], v[176:191]
    ds_read_b64_tr_b16 a[160:161], v22 offset:40960
    ds_read_b64_tr_b16 a[162:163], v22 offset:42240
    v_and_b32 v86, 15, v1
    v_lshlrev_b32 v86, 2, v86
    buffer_load_dword v84, v86, s[16:19], 0 offen sc1
    s_waitcnt lgkmcnt(10)
    v_mfma_f32_32x32x16_bf16 v[192:207], a[176:179], a[32:35], v[192:207]
    ds_read_b64_tr_b16 a[164:165], v22 offset:40992
    ds_read_b64_tr_b16 a[166:167], v22 offset:42272
    v_mfma_f32_32x32x16_bf16 v[128:143], a[180:183], a[36:39], v[128:143]
    ds_read_b64_tr_b16 a[168:169], v22 offset:41024
    ds_read_b64_tr_b16 a[170:171], v22 offset:42304
    s_waitcnt lgkmcnt(10)
    v_mfma_f32_32x32x16_bf16 v[144:159], a[184:187], a[36:39], v[144:159]
    ds_read_b64_tr_b16 a[172:173], v22 offset:41056
    ds_read_b64_tr_b16 a[174:175], v22 offset:42336
    v_mfma_f32_32x32x16_bf16 v[160:175], a[188:191], a[36:39], v[160:175]
    ds_read_b64_tr_b16 a[176:177], v22 offset:41088
    ds_read_b64_tr_b16 a[178:179], v22 offset:42368
    s_waitcnt lgkmcnt(10)
    v_mfma_f32_32x32x16_bf16 v[176:191], a[192:195], a[36:39], v[176:191]
    ds_read_b64_tr_b16 a[180:181], v23 offset:40960
    ds_read_b64_tr_b16 a[182:183], v23 offset:42240
    v_mfma_f32_32x32x16_bf16 v[192:207], a[196:199], a[36:39], v[192:207]
    ds_read_b64_tr_b16 a[184:185], v23 offset:40992
    ds_read_b64_tr_b16 a[186:187], v23 offset:42272
    s_waitcnt lgkmcnt(10)
    v_mfma_f32_32x32x16_bf16 v[128:143], a[160:163], a[40:43], v[128:143]
    ds_read_b64_tr_b16 a[188:189], v23 offset:41024
    ds_read_b64_tr_b16 a[190:191], v23 offset:42304
    v_mfma_f32_32x32x16_bf16 v[144:159], a[164:167], a[40:43], v[144:159]
    ds_read_b64_tr_b16 a[192:193], v23 offset:41056
    ds_read_b64_tr_b16 a[194:195], v23 offset:42336
    s_waitcnt lgkmcnt(10)
    v_mfma_f32_32x32x16_bf16 v[160:175], a[168:171], a[40:43], v[160:175]
    ds_read_b64_tr_b16 a[196:197], v23 offset:41088
    ds_read_b64_tr_b16 a[198:199], v23 offset:42368
    v_mfma_f32_32x32x16_bf16 v[176:191], a[172:175], a[40:43], v[176:191]
    s_waitcnt vmcnt(10)
    s_barrier
    ds_read_b64_tr_b16 a[160:161], v24 offset:0
    ds_read_b64_tr_b16 a[162:163], v24 offset:1280
    ds_read_b128 a[48:51], v16 offset:12288
    s_waitcnt lgkmcnt(11)
    v_mfma_f32_32x32x16_bf16 v[192:207], a[176:179], a[40:43], v[192:207]
    ds_read_b64_tr_b16 a[164:165], v24 offset:32
    ds_read_b64_tr_b16 a[166:167], v24 offset:1312
    ds_read_b128 a[52:55], v17 offset:12288
    s_add_u32 m0, s62, 8192
    s_nop 0
    buffer_load_dwordx4 v3, s[4:7], s56 offen offset:0 lds
    v_mfma_f32_32x32x16_bf16 v[128:143], a[180:183], a[44:47], v[128:143]
    ds_read_b64_tr_b16 a[168:169], v24 offset:64
    ds_read_b64_tr_b16 a[170:171], v24 offset:1344
    ds_read_b128 a[56:59], v18 offset:12288
    buffer_load_dwordx4 v4, s[4:7], s56 offen offset:1024 lds
    s_waitcnt lgkmcnt(13)
    v_mfma_f32_32x32x16_bf16 v[144:159], a[184:187], a[44:47], v[144:159]
    ds_read_b64_tr_b16 a[172:173], v24 offset:96
    ds_read_b64_tr_b16 a[174:175], v24 offset:1376
    ds_read_b128 a[60:63], v19 offset:12288
    buffer_load_dwordx4 v112, s[4:7], s56 offen offset:2048 lds
    v_mfma_f32_32x32x16_bf16 v[160:175], a[188:191], a[44:47], v[160:175]
    ds_read_b64_tr_b16 a[176:177], v24 offset:128
    ds_read_b64_tr_b16 a[178:179], v24 offset:1408
    buffer_load_dwordx4 v113, s[4:7], s56 offen offset:3072 lds
    s_waitcnt lgkmcnt(14)
    v_mfma_f32_32x32x16_bf16 v[176:191], a[192:195], a[44:47], v[176:191]
    ds_read_b64_tr_b16 a[180:181], v25 offset:0
    ds_read_b64_tr_b16 a[182:183], v25 offset:1280
    s_add_u32 s56, s56, 128
    s_cmp_eq_u32 s56, s90
    s_cselect_b32 s56, s54, s56
    s_add_u32 m0, s63, 88064
    s_nop 0
    buffer_load_dwordx4 v5, s[8:11], s85 offen offset:0 lds
    v_mfma_f32_32x32x16_bf16 v[192:207], a[196:199], a[44:47], v[192:207]
    ds_read_b64_tr_b16 a[184:185], v25 offset:32
    ds_read_b64_tr_b16 a[186:187], v25 offset:1312
    buffer_load_dwordx4 v6, s[8:11], s85 offen offset:1024 lds
    s_waitcnt lgkmcnt(13)
    v_mfma_f32_32x32x16_bf16 v[128:143], a[160:163], a[48:51], v[128:143]
    ds_read_b64_tr_b16 a[188:189], v25 offset:64
    ds_read_b64_tr_b16 a[190:191], v25 offset:1344
    buffer_load_dwordx4 v7, s[8:11], s85 offen offset:2048 lds
    v_mfma_f32_32x32x16_bf16 v[144:159], a[164:167], a[48:51], v[144:159]
    ds_read_b64_tr_b16 a[192:193], v25 offset:96
    ds_read_b64_tr_b16 a[194:195], v25 offset:1376
    buffer_load_dwordx4 v8, s[8:11], s85 offen offset:3072 lds
    s_waitcnt lgkmcnt(11)
    v_mfma_f32_32x32x16_bf16 v[160:175], a[168:171], a[48:51], v[160:175]
    ds_read_b64_tr_b16 a[196:197], v25 offset:128
    ds_read_b64_tr_b16 a[198:199], v25 offset:1408
    s_add_u32 m0, s63, 92160
    s_nop 0
    buffer_load_dwordx4 v9, s[8:11], s85 offen lds
    v_mfma_f32_32x32x16_bf16 v[176:191], a[172:175], a[48:51], v[176:191]
    ds_read_b64_tr_b16 a[160:161], v26 offset:0
    ds_read_b64_tr_b16 a[162:163], v26 offset:1280
    s_waitcnt vmcnt(9)
    v_cmp_ne_u32 vcc, 1, v84
    s_nop 0
    s_and_b32 s58, vcc_lo, 0xffff
    s_cbranch_scc1 L_slow_iq
L_back_iq:
    v_cndmask_b32 v48, v49, v48, s[96:97]
    buffer_atomic_add_f32 v48, v116, s[12:15], s39 offen offset:0
    s_waitcnt lgkmcnt(10)
    v_mfma_f32_32x32x16_bf16 v[192:207], a[176:179], a[48:51], v[192:207]
    ds_read_b64_tr_b16 a[164:165], v26 offset:32
    ds_read_b64_tr_b16 a[166:167], v26 offset:1312
    v_cndmask_b32 v52, v53, v52, s[96:97]
    buffer_atomic_add_f32 v52, v116, s[12:15], s39 offen offset:128
    v_mfma_f32_32x32x16_bf16 v[128:143], a[180:183], a[52:55], v[128:143]
    ds_read_b64_tr_b16 a[168:169], v26 offset:64
    ds_read_b64_tr_b16 a[170:171], v26 offset:1344
    v_cndmask_b32 v56, v57, v56, s[96:97]
    buffer_atomic_add_f32 v56, v116, s[12:15], s39 offen offset:256
    s_waitcnt lgkmcnt(10)
    v_mfma_f32_32x32x16_bf16 v[144:159], a[184:187], a[52:55], v[144:159]
    ds_read_b64_tr_b16 a[172:173], v26 offset:96
    ds_read_b64_tr_b16 a[174:175], v26 offset:1376
    v_cndmask_b32 v60, v61, v60, s[96:97]
    buffer_atomic_add_f32 v60, v116, s[12:15], s39 offen offset:384
    v_mfma_f32_32x32x16_bf16 v[160:175], a[188:191], a[52:55], v[160:175]
    ds_read_b64_tr_b16 a[176:177], v26 offset:128
    ds_read_b64_tr_b16 a[178:179], v26 offset:1408
    v_cndmask_b32 v64, v65, v64, s[96:97]
    buffer_atomic_add_f32 v64, v116, s[12:15], s39 offen offset:512
    s_waitcnt lgkmcnt(10)
    v_mfma_f32_32x32x16_bf16 v[176:191], a[192:195], a[52:55], v[176:191]
    ds_read_b64_tr_b16 a[180:181], v27 offset:0
    ds_read_b64_tr_b16 a[182:183], v27 offset:1280
    v_mfma_f32_32x32x16_bf16 v[192:207], a[196:199], a[52:55], v[192:207]
    ds_read_b64_tr_b16 a[184:185], v27 offset:32
    ds_read_b64_tr_b16 a[186:187], v27 offset:1312
    s_waitcnt lgkmcnt(10)
    v_mfma_f32_32x32x16_bf16 v[128:143], a[160:163], a[56:59], v[128:143]
    ds_read_b64_tr_b16 a[188:189], v27 offset:64
    ds_read_b64_tr_b16 a[190:191], v27 offset:1344
    v_mfma_f32_32x32x16_bf16 v[144:159], a[164:167], a[56:59], v[144:159]
    ds_read_b64_tr_b16 a[192:193], v27 offset:96
    ds_read_b64_tr_b16 a[194:195], v27 offset:1376
    s_waitcnt lgkmcnt(10)
    v_mfma_f32_32x32x16_bf16 v[160:175], a[168:171], a[56:59], v[160:175]
    ds_read_b64_tr_b16 a[196:197], v27 offset:128
    ds_read_b64_tr_b16 a[198:199], v27 offset:1408
    v_mfma_f32_32x32x16_bf16 v[176:191], a[172:175], a[56:59], v[176:191]
    s_barrier
    ds_read_b64_tr_b16 a[160:161], v20 offset:0
    ds_read_b64_tr_b16 a[162:163], v20 offset:1280
    ds_read_b128 a[64:67], v16 offset:0
    s_waitcnt lgkmcnt(11)
    v_mfma_f32_32x32x16_bf16 v[192:207], a[176:179], a[56:59], v[192:207]
    ds_read_b64_tr_b16 a[164:165], v20 offset:32
    ds_read_b64_tr_b16 a[166:167], v20 offset:1312
    ds_read_b128 a[68:71], v17 offset:0
    s_add_u32 m0, s62, 12288
    s_nop 0
    buffer_load_dwordx4 v3, s[4:7], s56 offen offset:0 lds
    v_mfma_f32_32x32x16_bf16 v[128:143], a[180:183], a[60:63], v[128:143]
    ds_read_b64_tr_b16 a[168:169], v20 offset:64
    ds_read_b64_tr_b16 a[170:171], v20 offset:1344
    ds_read_b128 a[72:75], v18 offset:0
    buffer_load_dwordx4 v4, s[4:7], s56 offen offset:1024 lds
    s_waitcnt lgkmcnt(13)
    v_mfma_f32_32x32x16_bf16 v[144:159], a[184:187], a[60:63], v[144:159]
    ds_read_b64_tr_b16 a[172:173], v20 offset:96
    ds_read_b64_tr_b16 a[174:175], v20 offset:1376
    ds_read_b128 a[76:79], v19 offset:0
    buffer_load_dwordx4 v112, s[4:7], s56 offen offset:2048 lds
    v_mfma_f32_32x32x16_bf16 v[160:175], a[188:191], a[60:63], v[160:175]
    ds_read_b64_tr_b16 a[176:177], v20 offset:128
    ds_read_b64_tr_b16 a[178:179], v20 offset:1408
    buffer_load_dwordx4 v113, s[4:7], s56 offen offset:3072 lds
    s_waitcnt lgkmcnt(14)
    v_mfma_f32_32x32x16_bf16 v[176:191], a[192:195], a[60:63], v[176:191]
    ds_read_b64_tr_b16 a[180:181], v21 offset:0
    ds_read_b64_tr_b16 a[182:183], v21 offset:1280
    s_add_u32 s56, s56, 128
    s_cmp_eq_u32 s56, s90
    s_cselect_b32 s56, s54, s56
    s_add_u32 m0, s63, 108544
    s_nop 0
    buffer_load_dwordx4 v5, s[8:11], s86 offen offset:0 lds
    v_mfma_f32_32x32x16_bf16 v[192:207], a[196:199], a[60:63], v[192:207]
    ds_read_b64_tr_b16 a[184:185], v21 offset:32
    ds_read_b64_tr_b16 a[186:187], v21 offset:1312
    buffer_load_dwordx4 v6, s[8:11], s86 offen offset:1024 lds
    s_waitcnt lgkmcnt(13)
    v_mfma_f32_32x32x16_bf16 v[128:143], a[160:163], a[64:67], v[128:143]
    ds_read_b64_tr_b16 a[188:189], v21 offset:64
    ds_read_b64_tr_b16 a[190:191], v21 offset:1344
    buffer_load_dwordx4 v7, s[8:11], s86 offen offset:2048 lds
    v_mfma_f32_32x32x16_bf16 v[144:159], a[164:167], a[64:67], v[144:159]
    ds_read_b64_tr_b16 a[192:193], v21 offset:96
    ds_read_b64_tr_b16 a[194:195], v21 offset:1376
    buffer_load_dwordx4 v8, s[8:11], s86 offen offset:3072 lds
    s_waitcnt lgkmcnt(11)
    v_mfma_f32_32x32x16_bf16 v[160:175], a[168:171], a[64:67], v[160:175]
    ds_read_b64_tr_b16 a[196:197], v21 offset:128
    ds_read_b64_tr_b16 a[198:199], v21 offset:1408
    s_add_u32 m0, s63, 112640
    s_nop 0
    buffer_load_dwordx4 v9, s[8:11], s86 offen lds
    v_mfma_f32_32x32x16_bf16 v[176:191], a[172:175], a[64:67], v[176:191]
    ds_read_b64_tr_b16 a[160:161], v22 offset:0
    ds_read_b64_tr_b16 a[162:163], v22 offset:1280
    v_bfe_u32 v68, v1, 4, 1
    v_bfe_u32 v69, v1, 1, 1
    v_lshl_add_u32 v68, v68, 1, v69
    v_lshrrev_b32 v69, 5, v1
    v_and_b32 v70, 1, v1
    v_cmp_eq_u32 s[98:99], v69, v70
    v_mul_u32_u24 v69, 1600, v69
    v_bfe_u32 v70, v1, 2, 2
    v_mul_u32_u24 v70, 40, v70
    v_add3_u32 v69, v69, v70, 0
    v_add_u32 v69, 153600, v69
    v_lshl_add_u32 v69, v68, 3, v69
    v_mov_b32 v71, 149504
    v_add_u32 v72, 0, v69
    v_cndmask_b32 v72, v71, v72, s[98:99]
    v_add_u32 v73, 32, v69
    v_cndmask_b32 v73, v71, v73, s[98:99]
    v_cmp_gt_u32 vcc, 1, v68
    s_nop 1
    v_cndmask_b32 v73, v71, v73, vcc
    v_add_u32 v74, 792, v69
    v_cndmask_b32 v74, v71, v74, s[98:99]
    v_cmp_le_u32 vcc, 1, v68
    s_nop 1
    v_cndmask_b32 v74, v71, v74, vcc
    v_add_u32 v75, 824, v69
    v_cndmask_b32 v75, v71, v75, s[98:99]
    v_cmp_gt_u32 vcc, 2, v68
    s_nop 1
    v_cndmask_b32 v75, v71, v75, vcc
    ds_read_b64_tr_b16 a[200:201], v72 offset:0
    ds_read_b64_tr_b16 a[202:203], v72 offset:160
    s_waitcnt lgkmcnt(12)
    v_mfma_f32_32x32x16_bf16 v[192:207], a[176:179], a[64:67], v[192:207]
    ds_read_b64_tr_b16 a[164:165], v22 offset:32
    ds_read_b64_tr_b16 a[166:167], v22 offset:1312
    ds_read_b64_tr_b16 a[204:205], v72 offset:320
    ds_read_b64_tr_b16 a[206:207], v72 offset:480
    v_mfma_f32_32x32x16_bf16 v[128:143], a[180:183], a[68:71], v[128:143]
    ds_read_b64_tr_b16 a[168:169], v22 offset:64
    ds_read_b64_tr_b16 a[170:171], v22 offset:1344
    ds_read_b64_tr_b16 a[208:209], v72 offset:640
    ds_read_b64_tr_b16 a[210:211], v71
    s_waitcnt lgkmcnt(15)
    v_mfma_f32_32x32x16_bf16 v[144:159], a[184:187], a[68:71], v[144:159]
    ds_read_b64_tr_b16 a[172:173], v22 offset:96
    ds_read_b64_tr_b16 a[174:175], v22 offset:1376
    ds_read_b64_tr_b16 a[212:213], v73 offset:0
    ds_read_b64_tr_b16 a[214:215], v73 offset:160
    v_mfma_f32_32x32x16_bf16 v[160:175], a[188:191], a[68:71], v[160:175]
    ds_read_b64_tr_b16 a[176:177], v22 offset:128
    ds_read_b64_tr_b16 a[178:179], v22 offset:1408
    ds_read_b64_tr_b16 a[216:217], v73 offset:320
    ds_read_b64_tr_b16 a[218:219], v73 offset:480
    s_waitcnt lgkmcnt(15)
    v_mfma_f32_32x32x16_bf16 v[176:191], a[192:195], a[68:71], v[176:191]
    ds_read_b64_tr_b16 a[180:181], v23 offset:0
    ds_read_b64_tr_b16 a[182:183], v23 offset:1280
    ds_read_b64_tr_b16 a[220:221], v73 offset:640
    ds_read_b64_tr_b16 a[222:223], v74 offset:0
    v_mfma_f32_32x32x16_bf16 v[192:207], a[196:199], a[68:71], v[192:207]
    ds_read_b64_tr_b16 a[184:185], v23 offset:32
    ds_read_b64_tr_b16 a[186:187], v23 offset:1312
    ds_read_b64_tr_b16 a[224:225], v74 offset:160
    ds_read_b64_tr_b16 a[226:227], v74 offset:320
    s_waitcnt lgkmcnt(15)
    v_mfma_f32_32x32x16_bf16 v[128:143], a[160:163], a[72:75], v[128:143]
    ds_read_b64_tr_b16 a[188:189], v23 offset:64
    ds_read_b64_tr_b16 a[190:191], v23 offset:1344
    ds_read_b64_tr_b16 a[228:229], v74 offset:480
    ds_read_b64_tr_b16 a[230:231], v74 offset:640
    v_mfma_f32_32x32x16_bf16 v[144:159], a[164:167], a[72:75], v[144:159]
    ds_read_b64_tr_b16 a[192:193], v23 offset:96
    ds_read_b64_tr_b16 a[194:195], v23 offset:1376
    ds_read_b64_tr_b16 a[232:233], v71
    ds_read_b64_tr_b16 a[234:235], v75 offset:0
    s_waitcnt lgkmcnt(15)
    v_mfma_f32_32x32x16_bf16 v[160:175], a[168:171], a[72:75], v[160:175]
    ds_read_b64_tr_b16 a[196:197], v23 offset:128
    ds_read_b64_tr_b16 a[198:199], v23 offset:1408
    ds_read_b64_tr_b16 a[236:237], v75 offset:160
    ds_read_b64_tr_b16 a[238:239], v75 offset:320
    v_mfma_f32_32x32x16_bf16 v[176:191], a[172:175], a[72:75], v[176:191]
    s_waitcnt vmcnt(9)
    s_barrier
    ds_read_b64_tr_b16 a[160:161], v20 offset:20480
    ds_read_b64_tr_b16 a[162:163], v20 offset:21760
    ds_read_b64_tr_b16 a[240:241], v75 offset:480
    ds_read_b64_tr_b16 a[242:243], v75 offset:640
    ds_read_b128 a[80:83], v16 offset:4096
    s_waitcnt lgkmcnt(15)
    v_mfma_f32_32x32x16_bf16 v[192:207], a[176:179], a[72:75], v[192:207]
    ds_read_b64_tr_b16 a[164:165], v20 offset:20512
    ds_read_b64_tr_b16 a[166:167], v20 offset:21792
    ds_read_b128 a[84:87], v17 offset:4096
    s_add_u32 m0, s62, 0
    s_nop 0
    buffer_load_dwordx4 v3, s[4:7], s56 offen offset:0 lds
    v_mfma_f32_32x32x16_bf16 v[128:143], a[180:183], a[76:79], v[128:143]
    ds_read_b64_tr_b16 a[168:169], v20 offset:20544
    ds_read_b64_tr_b16 a[170:171], v20 offset:21824
    ds_read_b128 a[88:91], v18 offset:4096
    buffer_load_dwordx4 v4, s[4:7], s56 offen offset:1024 lds
    v_mfma_f32_32x32x16_bf16 v[144:159], a[184:187], a[76:79], v[144:159]
    ds_read_b64_tr_b16 a[172:173], v20 offset:20576
    ds_read_b64_tr_b16 a[174:175], v20 offset:21856
    ds_read_b128 a[92:95], v19 offset:4096
    buffer_load_dwordx4 v112, s[4:7], s56 offen offset:2048 lds
    v_mfma_f32_32x32x16_bf16 v[160:175], a[188:191], a[76:79], v[160:175]
    ds_read_b64_tr_b16 a[176:177], v20 offset:20608
    ds_read_b64_tr_b16 a[178:179], v20 offset:21888
    buffer_load_dwordx4 v113, s[4:7], s56 offen offset:3072 lds
    s_waitcnt lgkmcnt(15)
    v_mfma_f32_32x32x16_bf16 v[176:191], a[192:195], a[76:79], v[176:191]
    ds_read_b64_tr_b16 a[180:181], v21 offset:20480
    ds_read_b64_tr_b16 a[182:183], v21 offset:21760
    s_add_u32 s56, s56, 128
    s_cmp_eq_u32 s56, s90
    s_cselect_b32 s56, s54, s56
    s_add_u32 m0, s63, 129024
    s_nop 0
    buffer_load_dwordx4 v5, s[8:11], s87 offen offset:0 lds
    v_mfma_f32_32x32x16_bf16 v[192:207], a[196:199], a[76:79], v[192:207]
    ds_read_b64_tr_b16 a[184:185], v21 offset:20512
    ds_read_b64_tr_b16 a[186:187], v21 offset:21792
    buffer_load_dwordx4 v6, s[8:11], s87 offen offset:1024 lds
    s_waitcnt lgkmcnt(13)
    v_mfma_f32_32x32x16_bf16 v[128:143], a[160:163], a[80:83], v[128:143]
    ds_read_b64_tr_b16 a[188:189], v21 offset:20544
    ds_read_b64_tr_b16 a[190:191], v21 offset:21824
    buffer_load_dwordx4 v7, s[8:11], s87 offen offset:2048 lds
    v_mfma_f32_32x32x16_bf16 v[144:159], a[164:167], a[80:83], v[144:159]
    ds_read_b64_tr_b16 a[192:193], v21 offset:20576
    ds_read_b64_tr_b16 a[194:195], v21 offset:21856
    buffer_load_dwordx4 v8, s[8:11], s87 offen offset:3072 lds
    s_waitcnt lgkmcnt(11)
    v_mfma_f32_32x32x16_bf16 v[160:175], a[168:171], a[80:83], v[160:175]
    ds_read_b64_tr_b16 a[196:197], v21 offset:20608
    ds_read_b64_tr_b16 a[198:199], v21 offset:21888
    s_add_u32 m0, s63, 133120
    s_nop 0
    buffer_load_dwordx4 v9, s[8:11], s87 offen lds
    v_mfma_f32_32x32x16_bf16 v[176:191], a[172:175], a[80:83], v[176:191]
    ds_read_b64_tr_b16 a[160:161], v22 offset:20480
    ds_read_b64_tr_b16 a[162:163], v22 offset:21760
    buffer_store_dword a255, v117, s[12:15], s43 offen offset:0 sc1
    s_waitcnt lgkmcnt(10)
    v_mfma_f32_32x32x16_bf16 v[192:207], a[176:179], a[80:83], v[192:207]
    ds_read_b64_tr_b16 a[164:165], v22 offset:20512
    ds_read_b64_tr_b16 a[166:167], v22 offset:21792
    v_mfma_f32_32x32x16_bf16 v[128:143], a[180:183], a[84:87], v[128:143]
    ds_read_b64_tr_b16 a[168:169], v22 offset:20544
    ds_read_b64_tr_b16 a[170:171], v22 offset:21824
    s_waitcnt lgkmcnt(10)
    v_mfma_f32_32x32x16_bf16 v[144:159], a[184:187], a[84:87], v[144:159]
    ds_read_b64_tr_b16 a[172:173], v22 offset:20576
    ds_read_b64_tr_b16 a[174:175], v22 offset:21856
    v_mfma_f32_32x32x16_bf16 v[160:175], a[188:191], a[84:87], v[160:175]
    ds_read_b64_tr_b16 a[176:177], v22 offset:20608
    ds_read_b64_tr_b16 a[178:179], v22 offset:21888
    s_waitcnt lgkmcnt(10)
    v_mfma_f32_32x32x16_bf16 v[176:191], a[192:195], a[84:87], v[176:191]
    ds_read_b64_tr_b16 a[180:181], v23 offset:20480
    ds_read_b64_tr_b16 a[182:183], v23 offset:21760
    v_mfma_f32_32x32x16_bf16 v[192:207], a[196:199], a[84:87], v[192:207]
    ds_read_b64_tr_b16 a[184:185], v23 offset:20512
    ds_read_b64_tr_b16 a[186:187], v23 offset:21792
    s_waitcnt lgkmcnt(10)
    v_mfma_f32_32x32x16_bf16 v[128:143], a[160:163], a[88:91], v[128:143]
    ds_read_b64_tr_b16 a[188:189], v23 offset:20544
    ds_read_b64_tr_b16 a[190:191], v23 offset:21824
    v_mfma_f32_32x32x16_bf16 v[144:159], a[164:167], a[88:91], v[144:159]
    ds_read_b64_tr_b16 a[192:193], v23 offset:20576
    ds_read_b64_tr_b16 a[194:195], v23 offset:21856
    s_waitcnt lgkmcnt(10)
    v_mfma_f32_32x32x16_bf16 v[160:175], a[168:171], a[88:91], v[160:175]
    ds_read_b64_tr_b16 a[196:197], v23 offset:20608
    ds_read_b64_tr_b16 a[198:199], v23 offset:21888
    v_mfma_f32_32x32x16_bf16 v[176:191], a[172:175], a[88:91], v[176:191]
    s_waitcnt vmcnt(10)
    s_barrier
    ds_read_b64_tr_b16 a[160:161], v20 offset:40960
    ds_read_b64_tr_b16 a[162:163], v20 offset:42240
    ds_read_b128 a[96:99], v16 offset:8192
    s_waitcnt lgkmcnt(11)
    v_mfma_f32_32x32x16_bf16 v[192:207], a[176:179], a[88:91], v[192:207]
    ds_read_b64_tr_b16 a[164:165], v20 offset:40992
    ds_read_b64_tr_b16 a[166:167], v20 offset:42272
    ds_read_b128 a[100:103], v17 offset:8192
    s_add_u32 m0, s62, 4096
    s_nop 0
    buffer_load_dwordx4 v3, s[4:7], s56 offen offset:0 lds
    v_mfma_f32_32x32x16_bf16 v[128:143], a[180:183], a[92:95], v[128:143]
    ds_read_b64_tr_b16 a[168:169], v20 offset:41024
    ds_read_b64_tr_b16 a[170:171], v20 offset:42304
    ds_read_b128 a[104:107], v18 offset:8192
    buffer_load_dwordx4 v4, s[4:7], s56 offen offset:1024 lds
    s_waitcnt lgkmcnt(13)
    v_mfma_f32_32x32x16_bf16 v[144:159], a[184:187], a[92:95], v[144:159]
    ds_read_b64_tr_b16 a[172:173], v20 offset:41056
    ds_read_b64_tr_b16 a[174:175], v20 offset:42336
    ds_read_b128 a[108:111], v19 offset:8192
    buffer_load_dwordx4 v112, s[4:7], s56 offen offset:2048 lds
    v_mfma_f32_32x32x16_bf16 v[160:175], a[188:191], a[92:95], v[160:175]
    ds_read_b64_tr_b16 a[176:177], v20 offset:41088
    ds_read_b64_tr_b16 a[178:179], v20 offset:42368
    buffer_load_dwordx4 v113, s[4:7], s56 offen offset:3072 lds
    s_waitcnt lgkmcnt(14)
    v_mfma_f32_32x32x16_bf16 v[176:191], a[192:195], a[92:95], v[176:191]
    ds_read_b64_tr_b16 a[180:181], v21 offset:40960
    ds_read_b64_tr_b16 a[182:183], v21 offset:42240
    s_add_u32 m0, s63, 67584
    s_nop 0
    buffer_load_dwordx4 v5, s[8:11], s88 offen offset:0 lds
    v_mfma_f32_32x32x16_bf16 v[192:207], a[196:199], a[92:95], v[192:207]
    ds_read_b64_tr_b16 a[184:185], v21 offset:40992
    ds_read_b64_tr_b16 a[186:187], v21 offset:42272
    buffer_load_dwordx4 v6, s[8:11], s88 offen offset:1024 lds
    s_waitcnt lgkmcnt(13)
    v_mfma_f32_32x32x16_bf16 v[128:143], a[160:163], a[96:99], v[128:143]
    ds_read_b64_tr_b16 a[188:189], v21 offset:41024
    ds_read_b64_tr_b16 a[190:191], v21 offset:42304
    buffer_load_dwordx4 v7, s[8:11], s88 offen offset:2048 lds
    v_mfma_f32_32x32x16_bf16 v[144:159], a[164:167], a[96:99], v[144:159]
    ds_read_b64_tr_b16 a[192:193], v21 offset:41056
    ds_read_b64_tr_b16 a[194:195], v21 offset:42336
    buffer_load_dwordx4 v8, s[8:11], s88 offen offset:3072 lds
    s_waitcnt lgkmcnt(11)
    v_mfma_f32_32x32x16_bf16 v[160:175], a[168:171], a[96:99], v[160:175]
    ds_read_b64_tr_b16 a[196:197], v21 offset:41088
    ds_read_b64_tr_b16 a[198:199], v21 offset:42368
    s_add_u32 m0, s63, 71680
    s_nop 0
    buffer_load_dwordx4 v9, s[8:11], s88 offen lds
    v_mfma_f32_32x32x16_bf16 v[176:191], a[172:175], a[96:99], v[176:191]
    ds_read_b64_tr_b16 a[160:161], v22 offset:40960
    ds_read_b64_tr_b16 a[162:163], v22 offset:42240
    s_waitcnt lgkmcnt(10)
    v_mfma_f32_32x32x16_bf16 v[192:207], a[176:179], a[96:99], v[192:207]
    ds_read_b64_tr_b16 a[164:165], v22 offset:40992
    ds_read_b64_tr_b16 a[166:167], v22 offset:42272
    v_mfma_f32_32x32x16_bf16 v[128:143], a[180:183], a[100:103], v[128:143]
    ds_read_b64_tr_b16 a[168:169], v22 offset:41024
    ds_read_b64_tr_b16 a[170:171], v22 offset:42304
    s_waitcnt lgkmcnt(10)
    v_mfma_f32_32x32x16_bf16 v[144:159], a[184:187], a[100:103], v[144:159]
    ds_read_b64_tr_b16 a[172:173], v22 offset:41056
    ds_read_b64_tr_b16 a[174:175], v22 offset:42336
    v_mfma_f32_32x32x16_bf16 v[160:175], a[188:191], a[100:103], v[160:175]
    ds_read_b64_tr_b16 a[176:177], v22 offset:41088
    ds_read_b64_tr_b16 a[178:179], v22 offset:42368
    s_waitcnt lgkmcnt(10)
    v_mfma_f32_32x32x16_bf16 v[176:191], a[192:195], a[100:103], v[176:191]
    ds_read_b64_tr_b16 a[180:181], v23 offset:40960
    ds_read_b64_tr_b16 a[182:183], v23 offset:42240
    v_mfma_f32_32x32x16_bf16 v[192:207], a[196:199], a[100:103], v[192:207]
    ds_read_b64_tr_b16 a[184:185], v23 offset:40992
    ds_read_b64_tr_b16 a[186:187], v23 offset:42272
    s_waitcnt lgkmcnt(10)
    v_mfma_f32_32x32x16_bf16 v[128:143], a[160:163], a[104:107], v[128:143]
    ds_read_b64_tr_b16 a[188:189], v23 offset:41024
    ds_read_b64_tr_b16 a[190:191], v23 offset:42304
    v_mfma_f32_32x32x16_bf16 v[144:159], a[164:167], a[104:107], v[144:159]
    ds_read_b64_tr_b16 a[192:193], v23 offset:41056
    ds_read_b64_tr_b16 a[194:195], v23 offset:42336
    s_waitcnt lgkmcnt(10)
    v_mfma_f32_32x32x16_bf16 v[160:175], a[168:171], a[104:107], v[160:175]
    ds_read_b64_tr_b16 a[196:197], v23 offset:41088
    ds_read_b64_tr_b16 a[198:199], v23 offset:42368
    v_mfma_f32_32x32x16_bf16 v[176:191], a[172:175], a[104:107], v[176:191]
    s_waitcnt vmcnt(10)
    s_barrier
    ds_read_b64_tr_b16 a[160:161], v24 offset:0
    ds_read_b64_tr_b16 a[162:163], v24 offset:1280
    ds_read_b128 a[112:115], v16 offset:12288
    s_waitcnt lgkmcnt(11)
    v_mfma_f32_32x32x16_bf16 v[192:207], a[176:179], a[104:107], v[192:207]
    ds_read_b64_tr_b16 a[164:165], v24 offset:32
    ds_read_b64_tr_b16 a[166:167], v24 offset:1312
    ds_read_b128 a[116:119], v17 offset:12288
    s_add_u32 m0, s63, 88064
    s_nop 0
    buffer_load_dwordx4 v5, s[8:11], s89 offen offset:0 lds
    v_mfma_f32_32x32x16_bf16 v[128:143], a[180:183], a[108:111], v[128:143]
    ds_read_b64_tr_b16 a[168:169], v24 offset:64
    ds_read_b64_tr_b16 a[170:171], v24 offset:1344
    ds_read_b128 a[120:123], v18 offset:12288
    buffer_load_dwordx4 v6, s[8:11], s89 offen offset:1024 lds
    s_waitcnt lgkmcnt(13)
    v_mfma_f32_32x32x16_bf16 v[144:159], a[184:187], a[108:111], v[144:159]
    ds_read_b64_tr_b16 a[172:173], v24 offset:96
    ds_read_b64_tr_b16 a[174:175], v24 offset:1376
    ds_read_b128 a[124:127], v19 offset:12288
    buffer_load_dwordx4 v7, s[8:11], s89 offen offset:2048 lds
    v_mfma_f32_32x32x16_bf16 v[160:175], a[188:191], a[108:111], v[160:175]
    ds_read_b64_tr_b16 a[176:177], v24 offset:128
    ds_read_b64_tr_b16 a[178:179], v24 offset:1408
    buffer_load_dwordx4 v8, s[8:11], s89 offen offset:3072 lds
    s_waitcnt lgkmcnt(14)
    v_mfma_f32_32x32x16_bf16 v[176:191], a[192:195], a[108:111], v[176:191]
    ds_read_b64_tr_b16 a[180:181], v25 offset:0
    ds_read_b64_tr_b16 a[182:183], v25 offset:1280
    s_add_u32 m0, s63, 92160
    s_nop 0
    buffer_load_dwordx4 v9, s[8:11], s89 offen lds
    v_mfma_f32_32x32x16_bf16 v[192:207], a[196:199], a[108:111], v[192:207]
    ds_read_b64_tr_b16 a[184:185], v25 offset:32
    ds_read_b64_tr_b16 a[186:187], v25 offset:1312
    buffer_load_dword v120, v118, s[12:15], 0 offen offset:0 sc1
    s_waitcnt lgkmcnt(13)
    v_mfma_f32_32x32x16_bf16 v[128:143], a[160:163], a[112:115], v[128:143]
    ds_read_b64_tr_b16 a[188:189], v25 offset:64
    ds_read_b64_tr_b16 a[190:191], v25 offset:1344
    v_mfma_f32_32x32x16_bf16 v[144:159], a[164:167], a[112:115], v[144:159]
    ds_read_b64_tr_b16 a[192:193], v25 offset:96
    ds_read_b64_tr_b16 a[194:195], v25 offset:1376
    s_waitcnt lgkmcnt(11)
    v_mfma_f32_32x32x16_bf16 v[160:175], a[168:171], a[112:115], v[160:175]
    ds_read_b64_tr_b16 a[196:197], v25 offset:128
    ds_read_b64_tr_b16 a[198:199], v25 offset:1408
    v_mfma_f32_32x32x16_bf16 v[176:191], a[172:175], a[112:115], v[176:191]
    ds_read_b64_tr_b16 a[160:161], v26 offset:0
    ds_read_b64_tr_b16 a[162:163], v26 offset:1280
    s_waitcnt lgkmcnt(10)
    v_mfma_f32_32x32x16_bf16 v[192:207], a[176:179], a[112:115], v[192:207]
    ds_read_b64_tr_b16 a[164:165], v26 offset:32
    ds_read_b64_tr_b16 a[166:167], v26 offset:1312
    v_mfma_f32_32x32x16_bf16 v[128:143], a[180:183], a[116:119], v[128:143]
    ds_read_b64_tr_b16 a[168:169], v26 offset:64
    ds_read_b64_tr_b16 a[170:171], v26 offset:1344
    s_waitcnt lgkmcnt(10)
    v_mfma_f32_32x32x16_bf16 v[144:159], a[184:187], a[116:119], v[144:159]
    ds_read_b64_tr_b16 a[172:173], v26 offset:96
    ds_read_b64_tr_b16 a[174:175], v26 offset:1376
    v_mfma_f32_32x32x16_bf16 v[160:175], a[188:191], a[116:119], v[160:175]
    ds_read_b64_tr_b16 a[176:177], v26 offset:128
    ds_read_b64_tr_b16 a[178:179], v26 offset:1408
    s_waitcnt lgkmcnt(10)
    v_mfma_f32_32x32x16_bf16 v[176:191], a[192:195], a[116:119], v[176:191]
    ds_read_b64_tr_b16 a[180:181], v27 offset:0
    ds_read_b64_tr_b16 a[182:183], v27 offset:1280
    v_mfma_f32_32x32x16_bf16 v[192:207], a[196:199], a[116:119], v[192:207]
    ds_read_b64_tr_b16 a[184:185], v27 offset:32
    ds_read_b64_tr_b16 a[186:187], v27 offset:1312
    s_waitcnt lgkmcnt(10)
    v_mfma_f32_32x32x16_bf16 v[128:143], a[160:163], a[120:123], v[128:143]
    ds_read_b64_tr_b16 a[188:189], v27 offset:64
    ds_read_b64_tr_b16 a[190:191], v27 offset:1344
    v_mfma_f32_32x32x16_bf16 v[144:159], a[164:167], a[120:123], v[144:159]
    ds_read_b64_tr_b16 a[192:193], v27 offset:96
    ds_read_b64_tr_b16 a[194:195], v27 offset:1376
    s_waitcnt lgkmcnt(10)
    v_mfma_f32_32x32x16_bf16 v[160:175], a[168:171], a[120:123], v[160:175]
    ds_read_b64_tr_b16 a[196:197], v27 offset:128
    ds_read_b64_tr_b16 a[198:199], v27 offset:1408
    v_mfma_f32_32x32x16_bf16 v[176:191], a[172:175], a[120:123], v[176:191]
    s_waitcnt vmcnt(6)
    s_barrier
    ds_read_b64_tr_b16 a[160:161], v20 offset:0
    ds_read_b64_tr_b16 a[162:163], v20 offset:1280
    ds_read_b128 a[128:131], v16 offset:0
    s_waitcnt lgkmcnt(11)
    v_mfma_f32_32x32x16_bf16 v[192:207], a[176:179], a[120:123], v[192:207]
    ds_read_b64_tr_b16 a[164:165], v20 offset:32
    ds_read_b64_tr_b16 a[166:167], v20 offset:1312
    ds_read_b128 a[132:135], v17 offset:0
    s_waitcnt vmcnt(0)
    v_cmp_ne_u32 vcc, 1, v120
    s_nop 0
    s_and_b32 s58, vcc_lo, 0x1f001f
    s_cbranch_scc1 L_slow_cs0q
L_back_cs0q:
    buffer_load_dword v88, v119, s[12:15], s39 offen offset:0 sc1
    v_mfma_f32_32x32x16_bf16 v[128:143], a[180:183], a[124:127], v[128:143]
    ds_read_b64_tr_b16 a[168:169], v20 offset:64
    ds_read_b64_tr_b16 a[170:171], v20 offset:1344
    ds_read_b128 a[136:139], v18 offset:0
    buffer_load_dword v89, v119, s[12:15], s39 offen offset:128 sc1
    s_waitcnt lgkmcnt(13)
    v_mfma_f32_32x32x16_bf16 v[144:159], a[184:187], a[124:127], v[144:159]
    ds_read_b64_tr_b16 a[172:173], v20 offset:96
    ds_read_b64_tr_b16 a[174:175], v20 offset:1376
    ds_read_b128 a[140:143], v19 offset:0
    buffer_load_dword v90, v119, s[12:15], s39 offen offset:256 sc1
    v_mfma_f32_32x32x16_bf16 v[160:175], a[188:191], a[124:127], v[160:175]
    ds_read_b64_tr_b16 a[176:177], v20 offset:128
    ds_read_b64_tr_b16 a[178:179], v20 offset:1408
    buffer_load_dword v91, v119, s[12:15], s39 offen offset:384 sc1
    s_waitcnt lgkmcnt(14)
    v_mfma_f32_32x32x16_bf16 v[176:191], a[192:195], a[124:127], v[176:191]
    ds_read_b64_tr_b16 a[180:181], v21 offset:0
    ds_read_b64_tr_b16 a[182:183], v21 offset:1280
    buffer_load_dword v92, v119, s[12:15], s39 offen offset:512 sc1
    v_mfma_f32_32x32x16_bf16 v[192:207], a[196:199], a[124:127], v[192:207]
    ds_read_b64_tr_b16 a[184:185], v21 offset:32
    ds_read_b64_tr_b16 a[186:187], v21 offset:1312
    buffer_load_dword v93, v119, s[12:15], s38 offen sc1
    s_waitcnt lgkmcnt(13)
    v_mfma_f32_32x32x16_bf16 v[128:143], a[160:163], a[128:131], v[128:143]
    ds_read_b64_tr_b16 a[188:189], v21 offset:64
    ds_read_b64_tr_b16 a[190:191], v21 offset:1344
    s_add_u32 s38, s38, 8192
    buffer_load_dword v94, v119, s[12:15], s38 offen sc1
    v_mfma_f32_32x32x16_bf16 v[144:159], a[164:167], a[128:131], v[144:159]
    ds_read_b64_tr_b16 a[192:193], v21 offset:96
    ds_read_b64_tr_b16 a[194:195], v21 offset:1376
    s_add_u32 m0, s63, 108544
    s_nop 0
    buffer_load_dwordx4 v10, s[8:11], s80 offen offset:0 lds
    s_waitcnt lgkmcnt(11)
    v_mfma_f32_32x32x16_bf16 v[160:175], a[168:171], a[128:131], v[160:175]
    ds_read_b64_tr_b16 a[196:197], v21 offset:128
    ds_read_b64_tr_b16 a[198:199], v21 offset:1408
    buffer_load_dwordx4 v11, s[8:11], s80 offen offset:1024 lds
    v_mfma_f32_32x32x16_bf16 v[176:191], a[172:175], a[128:131], v[176:191]
    ds_read_b64_tr_b16 a[160:161], v22 offset:0
    ds_read_b64_tr_b16 a[162:163], v22 offset:1280
    buffer_load_dwordx4 v12, s[8:11], s80 offen offset:2048 lds
    s_waitcnt lgkmcnt(10)
    v_mfma_f32_32x32x16_bf16 v[192:207], a[176:179], a[128:131], v[192:207]
    ds_read_b64_tr_b16 a[164:165], v22 offset:32
    ds_read_b64_tr_b16 a[166:167], v22 offset:1312
    buffer_load_dwordx4 v13, s[8:11], s80 offen offset:3072 lds
    v_mfma_f32_32x32x16_bf16 v[128:143], a[180:183], a[132:135], v[128:143]
    ds_read_b64_tr_b16 a[168:169], v22 offset:64
    ds_read_b64_tr_b16 a[170:171], v22 offset:1344
    s_add_u32 m0, s63, 112640
    s_nop 0
    buffer_load_dwordx4 v14, s[8:11], s80 offen lds
    s_waitcnt lgkmcnt(10)
    v_mfma_f32_32x32x16_bf16 v[144:159], a[184:187], a[132:135], v[144:159]
    ds_read_b64_tr_b16 a[172:173], v22 offset:96
    ds_read_b64_tr_b16 a[174:175], v22 offset:1376
    v_lshrrev_b32 v76, 4, v1
    v_and_b32 v77, 15, v1
    v_lshlrev_b32 v79, 9, v76
    v_lshl_add_u32 v79, v77, 4, v79
    s_add_u32 s60, s28, 0
    s_and_b32 s3, s60, 1
    s_lshl_b32 s3, s3, 8
    s_bfe_u32 s60, s60, 0x10001
    s_mul_i32 s60, s60, 139264
    s_add_u32 s60, s60, s3
    v_add_u32 v3, s60, v79
    s_add_u32 s60, s28, 1
    s_and_b32 s3, s60, 1
    s_lshl_b32 s3, s3, 8
    s_bfe_u32 s60, s60, 0x10001
    s_mul_i32 s60, s60, 139264
    s_add_u32 s60, s60, s3
    v_add_u32 v4, s60, v79
    s_add_u32 s60, s28, 2
    s_and_b32 s3, s60, 1
    s_lshl_b32 s3, s3, 8
    s_bfe_u32 s60, s60, 0x10001
    s_mul_i32 s60, s60, 139264
    s_add_u32 s60, s60, s3
    v_add_u32 v5, s60, v79
    s_add_u32 s60, s28, 3
    s_and_b32 s3, s60, 1
    s_lshl_b32 s3, s3, 8
    s_bfe_u32 s60, s60, 0x10001
    s_mul_i32 s60, s60, 139264
    s_add_u32 s60, s60, s3
    v_add_u32 v8, s60, v79
    v_and_b32 v6, 7, v1
    v_lshlrev_b32 v6, 2, v6
    s_lshr_b32 s57, s31, 1
    s_lshl_b32 s57, s57, 9
    v_mul_u32_u24 v9, 1280, v77
    v_lshl_add_u32 v9, v76, 3, v9
    s_lshl_b32 s76, s31, 2
    s_add_u32 s76, s76, s28
    s_mul_i32 s76, s76, 20480
    s_mul_i32 s60, s52, 160
    s_add_u32 s76, s76, s60
    s_mul_i32 s60, s31, 278528
    s_add_u32 s60, s60, 1048576
    s_lshl_b32 s44, s65, 13
    s_add_u32 s44, s44, s60
    s_mul_i32 s45, s65, 10240
    s_add_u32 s45, s45, s60
    s_add_u32 s45, s45, 98304
    buffer_load_dwordx2 a[244:245], v9, s[4:7], s76 offen offset:0
    v_mfma_f32_32x32x16_bf16 v[160:175], a[188:191], a[132:135], v[160:175]
    ds_read_b64_tr_b16 a[176:177], v22 offset:128
    ds_read_b64_tr_b16 a[178:179], v22 offset:1408
    buffer_load_dwordx2 a[246:247], v9, s[4:7], s76 offen offset:32
    s_waitcnt lgkmcnt(10)
    v_mfma_f32_32x32x16_bf16 v[176:191], a[192:195], a[132:135], v[176:191]
    ds_read_b64_tr_b16 a[180:181], v23 offset:0
    ds_read_b64_tr_b16 a[182:183], v23 offset:1280
    buffer_load_dwordx2 a[248:249], v9, s[4:7], s76 offen offset:64
    v_mfma_f32_32x32x16_bf16 v[192:207], a[196:199], a[132:135], v[192:207]
    ds_read_b64_tr_b16 a[184:185], v23 offset:32
    ds_read_b64_tr_b16 a[186:187], v23 offset:1312
    buffer_load_dwordx2 a[250:251], v9, s[4:7], s76 offen offset:96
    s_waitcnt lgkmcnt(10)
    v_mfma_f32_32x32x16_bf16 v[128:143], a[160:163], a[136:139], v[128:143]
    ds_read_b64_tr_b16 a[188:189], v23 offset:64
    ds_read_b64_tr_b16 a[190:191], v23 offset:1344
    buffer_load_dwordx2 a[252:253], v9, s[4:7], s76 offen offset:128
    v_mfma_f32_32x32x16_bf16 v[144:159], a[164:167], a[136:139], v[144:159]
    ds_read_b64_tr_b16 a[192:193], v23 offset:96
    ds_read_b64_tr_b16 a[194:195], v23 offset:1376
    s_waitcnt lgkmcnt(10)
    v_mfma_f32_32x32x16_bf16 v[160:175], a[168:171], a[136:139], v[160:175]
    ds_read_b64_tr_b16 a[196:197], v23 offset:128
    ds_read_b64_tr_b16 a[198:199], v23 offset:1408
    v_mfma_f32_32x32x16_bf16 v[176:191], a[172:175], a[136:139], v[176:191]
    s_barrier
    ds_read_b64_tr_b16 a[160:161], v20 offset:20480
    ds_read_b64_tr_b16 a[162:163], v20 offset:21760
    ds_read_b128 a[144:147], v16 offset:4096
    s_waitcnt lgkmcnt(11)
    v_mfma_f32_32x32x16_bf16 v[192:207], a[176:179], a[136:139], v[192:207]
    ds_read_b64_tr_b16 a[164:165], v20 offset:20512
    ds_read_b64_tr_b16 a[166:167], v20 offset:21792
    ds_read_b128 a[148:151], v17 offset:4096
    s_add_u32 m0, s63, 129024
    s_nop 0
    buffer_load_dwordx4 v10, s[8:11], s82 offen offset:0 lds
    v_mfma_f32_32x32x16_bf16 v[128:143], a[180:183], a[140:143], v[128:143]
    ds_read_b64_tr_b16 a[168:169], v20 offset:20544
    ds_read_b64_tr_b16 a[170:171], v20 offset:21824
    ds_read_b128 a[152:155], v18 offset:4096
    buffer_load_dwordx4 v11, s[8:11], s82 offen offset:1024 lds
    s_waitcnt lgkmcnt(13)
    v_mfma_f32_32x32x16_bf16 v[144:159], a[184:187], a[140:143], v[144:159]
    ds_read_b64_tr_b16 a[172:173], v20 offset:20576
    ds_read_b64_tr_b16 a[174:175], v20 offset:21856
    ds_read_b128 a[156:159], v19 offset:4096
    buffer_load_dwordx4 v12, s[8:11], s82 offen offset:2048 lds
    v_mfma_f32_32x32x16_bf16 v[160:175], a[188:191], a[140:143], v[160:175]
    ds_read_b64_tr_b16 a[176:177], v20 offset:20608
    ds_read_b64_tr_b16 a[178:179], v20 offset:21888
    buffer_load_dwordx4 v13, s[8:11], s82 offen offset:3072 lds
    s_waitcnt lgkmcnt(14)
    v_mfma_f32_32x32x16_bf16 v[176:191], a[192:195], a[140:143], v[176:191]
    ds_read_b64_tr_b16 a[180:181], v21 offset:20480
    ds_read_b64_tr_b16 a[182:183], v21 offset:21760
    s_add_u32 m0, s63, 133120
    s_nop 0
    buffer_load_dwordx4 v14, s[8:11], s82 offen lds
    v_mfma_f32_32x32x16_bf16 v[192:207], a[196:199], a[140:143], v[192:207]
    ds_read_b64_tr_b16 a[184:185], v21 offset:20512
    ds_read_b64_tr_b16 a[186:187], v21 offset:21792
    s_waitcnt lgkmcnt(13)
    v_mfma_f32_32x32x16_bf16 v[128:143], a[160:163], a[144:147], v[128:143]
    ds_read_b64_tr_b16 a[188:189], v21 offset:20544
    ds_read_b64_tr_b16 a[190:191], v21 offset:21824
    v_mfma_f32_32x32x16_bf16 v[144:159], a[164:167], a[144:147], v[144:159]
    ds_read_b64_tr_b16 a[192:193], v21 offset:20576
    ds_read_b64_tr_b16 a[194:195], v21 offset:21856
    s_waitcnt vmcnt(16)
    v_mul_f32 v46, 0x3acccccd, v93
    s_waitcnt vmcnt(15)
    v_mul_f32 v94, 0x3acccccd, v94
    v_fma_f32 v94, -v46, v46, v94
    v_max_f32 v94, 0, v94
    s_waitcnt lgkmcnt(11)
    v_mfma_f32_32x32x16_bf16 v[160:175], a[168:171], a[144:147], v[160:175]
    ds_read_b64_tr_b16 a[196:197], v21 offset:20608
    ds_read_b64_tr_b16 a[198:199], v21 offset:21888
    v_cvt_pk_bf16_f32 v94, v94, v94
    v_lshlrev_b32 v94, 16, v94
    v_add_f32 v94, 0x3727c5ac, v94
    v_cvt_pk_bf16_f32 v94, v94, v94
    v_mfma_f32_32x32x16_bf16 v[176:191], a[172:175], a[144:147], v[176:191]
    ds_read_b64_tr_b16 a[160:161], v22 offset:20480
    ds_read_b64_tr_b16 a[162:163], v22 offset:21760
    v_lshlrev_b32 v94, 16, v94
    v_sqrt_f32 v45, v94
    s_mov_b32 s98, -1
    s_mov_b32 s99, 0
    v_sub_f32 v80, 0, v46
    s_waitcnt lgkmcnt(10)
    v_mfma_f32_32x32x16_bf16 v[192:207], a[176:179], a[144:147], v[192:207]
    ds_read_b64_tr_b16 a[164:165], v22 offset:20512
    ds_read_b64_tr_b16 a[166:167], v22 offset:21792
    v_cndmask_b32 v80, 0, v80, s[98:99]
    v_cvt_pk_bf16_f32 v45, v45, v45
    v_lshlrev_b32 v45, 16, v45
    v_mfma_f32_32x32x16_bf16 v[128:143], a[180:183], a[148:151], v[128:143]
    ds_read_b64_tr_b16 a[168:169], v22 offset:20544
    ds_read_b64_tr_b16 a[170:171], v22 offset:21824
    v_rcp_f32 v47, v45
    v_cvt_pk_bf16_f32 v40, v80, 0
    v_cvt_pk_bf16_f32 v41, 0, v80
    v_mov_b32 v42, v41
    s_waitcnt lgkmcnt(10)
    v_mfma_f32_32x32x16_bf16 v[144:159], a[184:187], a[148:151], v[144:159]
    ds_read_b64_tr_b16 a[172:173], v22 offset:20576
    ds_read_b64_tr_b16 a[174:175], v22 offset:21856
    v_mov_b32 v43, 0
    v_mul_f32 v44, 0x3fb8aa3b, v47
    v_cvt_pk_bf16_f32 v96, v88, v88
    v_lshlrev_b32 v98, 16, v96
    v_mfma_f32_32x32x16_bf16 v[160:175], a[188:191], a[148:151], v[160:175]
    ds_read_b64_tr_b16 a[176:177], v22 offset:20608
    ds_read_b64_tr_b16 a[178:179], v22 offset:21888
    v_sub_f32 v97, v88, v98
    v_mov_b32 v48, v96
    v_cvt_pk_bf16_f32 v49, v88, v97
    v_and_b32 v98, 0xffff0000, v49
    s_waitcnt lgkmcnt(10)
    v_mfma_f32_32x32x16_bf16 v[176:191], a[192:195], a[148:151], v[176:191]
    ds_read_b64_tr_b16 a[180:181], v23 offset:20480
    ds_read_b64_tr_b16 a[182:183], v23 offset:21760
    v_sub_f32 v98, v97, v98
    v_cvt_pk_bf16_f32 v50, v97, v98
    v_mov_b32 v51, 0
    v_cvt_pk_bf16_f32 v96, v89, v89
    v_mfma_f32_32x32x16_bf16 v[192:207], a[196:199], a[148:151], v[192:207]
    ds_read_b64_tr_b16 a[184:185], v23 offset:20512
    ds_read_b64_tr_b16 a[186:187], v23 offset:21792
    v_lshlrev_b32 v98, 16, v96
    v_sub_f32 v97, v89, v98
    v_mov_b32 v52, v96
    v_cvt_pk_bf16_f32 v53, v89, v97
    s_waitcnt lgkmcnt(10)
    v_mfma_f32_32x32x16_bf16 v[128:143], a[160:163], a[152:155], v[128:143]
    ds_read_b64_tr_b16 a[188:189], v23 offset:20544
    ds_read_b64_tr_b16 a[190:191], v23 offset:21824
    v_and_b32 v98, 0xffff0000, v53
    v_sub_f32 v98, v97, v98
    v_cvt_pk_bf16_f32 v54, v97, v98
    v_mov_b32 v55, 0
    v_mfma_f32_32x32x16_bf16 v[144:159], a[164:167], a[152:155], v[144:159]
    ds_read_b64_tr_b16 a[192:193], v23 offset:20576
    ds_read_b64_tr_b16 a[194:195], v23 offset:21856
    v_cvt_pk_bf16_f32 v96, v90, v90
    v_lshlrev_b32 v98, 16, v96
    v_sub_f32 v97, v90, v98
    v_mov_b32 v56, v96
    s_waitcnt lgkmcnt(10)
    v_mfma_f32_32x32x16_bf16 v[160:175], a[168:171], a[152:155], v[160:175]
    ds_read_b64_tr_b16 a[196:197], v23 offset:20608
    ds_read_b64_tr_b16 a[198:199], v23 offset:21888
    v_cvt_pk_bf16_f32 v57, v90, v97
    v_and_b32 v98, 0xffff0000, v57
    v_sub_f32 v98, v97, v98
    v_cvt_pk_bf16_f32 v58, v97, v98
    v_mfma_f32_32x32x16_bf16 v[176:191], a[172:175], a[152:155], v[176:191]
    v_mov_b32 v59, 0
    v_cvt_pk_bf16_f32 v96, v91, v91
    v_lshlrev_b32 v98, 16, v96
    v_sub_f32 v97, v91, v98
    s_waitcnt lgkmcnt(8)
    v_mfma_f32_32x32x16_bf16 v[192:207], a[176:179], a[152:155], v[192:207]
    v_mov_b32 v60, v96
    v_cvt_pk_bf16_f32 v61, v91, v97
    v_and_b32 v98, 0xffff0000, v61
    v_sub_f32 v98, v97, v98
    v_mfma_f32_32x32x16_bf16 v[128:143], a[180:183], a[156:159], v[128:143]
    v_cvt_pk_bf16_f32 v62, v97, v98
    v_mov_b32 v63, 0
    v_cvt_pk_bf16_f32 v96, v92, v92
    v_lshlrev_b32 v98, 16, v96
    s_waitcnt lgkmcnt(4)
    v_mfma_f32_32x32x16_bf16 v[144:159], a[184:187], a[156:159], v[144:159]
    v_sub_f32 v97, v92, v98
    v_mov_b32 v64, v96
    v_cvt_pk_bf16_f32 v65, v92, v97
    v_and_b32 v98, 0xffff0000, v65
    v_mfma_f32_32x32x16_bf16 v[160:175], a[188:191], a[156:159], v[160:175]
    v_sub_f32 v98, v97, v98
    v_cvt_pk_bf16_f32 v66, v97, v98
    v_mov_b32 v67, 0
    v_mfma_f32_32x32x16_bf16 v[128:143], v[48:51], v[40:43], v[128:143]
    s_waitcnt lgkmcnt(0)
    v_mfma_f32_32x32x16_bf16 v[176:191], a[192:195], a[156:159], v[176:191]
    v_mfma_f32_32x32x16_bf16 v[144:159], v[52:55], v[40:43], v[144:159]
    v_mfma_f32_32x32x16_bf16 v[160:175], v[56:59], v[40:43], v[160:175]
    v_mfma_f32_32x32x16_bf16 v[176:191], v[60:63], v[40:43], v[176:191]
    v_mfma_f32_32x32x16_bf16 v[192:207], v[64:67], v[40:43], v[192:207]
    v_mfma_f32_32x32x16_bf16 v[192:207], a[196:199], a[156:159], v[192:207]
    v_mov_b32 v20, v8
    v_and_b32 v120, 31, v1
    s_lshl_b32 s58, s28, 5
    v_add_u32 v120, s58, v120
    v_mul_u32_u24 v120, 528, v120
    v_lshrrev_b32 v121, 5, v1
    v_mul_u32_u24 v122, 96, v121
    v_add_u32 v122, v122, v120
    v_mul_u32_u24 v121, 160, v121
    v_add_u32 v121, v121, v120
    v_lshrrev_b32 v23, 4, v1
    v_bfe_u32 v22, v1, 2, 2
    v_lshl_add_u32 v22, v23, 3, v22
    v_mul_u32_u24 v22, 528, v22
    v_and_b32 v21, 3, v1
    v_lshl_add_u32 v22, v21, 3, v22
    s_mul_i32 s58, s28, 80
    s_mul_i32 s59, s28, 48
    s_add_u32 s59, s59, 320
    v_add_u32 v21, s58, v22
    v_add_u32 v22, s59, v22
    s_waitcnt vmcnt(10)
    s_barrier
    ds_read_b64_tr_b16 a[160:161], v32 offset:0
    ds_read_b64_tr_b16 a[162:163], v32 offset:80
    ds_read_b64_tr_b16 a[164:165], v32 offset:32
    ds_read_b64_tr_b16 a[166:167], v32 offset:112
    ds_read_b64_tr_b16 a[168:169], v32 offset:64
    ds_read_b64_tr_b16 a[170:171], v32 offset:144
    ds_read_b64_tr_b16 a[172:173], v32 offset:10240
    ds_read_b64_tr_b16 a[174:175], v32 offset:10320
    ds_read_b64_tr_b16 a[176:177], v32 offset:10272
    ds_read_b64_tr_b16 a[178:179], v32 offset:10352
    ds_read_b64_tr_b16 a[180:181], v32 offset:10304
    ds_read_b64_tr_b16 a[182:183], v32 offset:10384
    v_cvt_pk_bf16_f32 v48, v128, v129
    s_add_u32 m0, s63, 67584
    s_nop 0
    buffer_load_dwordx4 v10, s[8:11], s84 offen offset:0 lds
    v_cvt_pk_bf16_f32 v49, v130, v131
    v_cvt_pk_bf16_f32 v50, v132, v133
    v_cvt_pk_bf16_f32 v51, v134, v135
    v_cvt_pk_bf16_f32 v52, v136, v137
    v_cvt_pk_bf16_f32 v53, v138, v139
    v_cvt_pk_bf16_f32 v54, v140, v141
    v_cvt_pk_bf16_f32 v55, v142, v143
    v_cvt_pk_bf16_f32 v56, v144, v145
    v_cvt_pk_bf16_f32 v57, v146, v147
    v_cvt_pk_bf16_f32 v58, v148, v149
    v_cvt_pk_bf16_f32 v59, v150, v151
    v_cvt_pk_bf16_f32 v60, v152, v153
    v_cvt_pk_bf16_f32 v61, v154, v155
    v_cvt_pk_bf16_f32 v62, v156, v157
    v_cvt_pk_bf16_f32 v63, v158, v159
    v_cvt_pk_bf16_f32 v64, v160, v161
    v_cvt_pk_bf16_f32 v65, v162, v163
    v_cvt_pk_bf16_f32 v66, v164, v165
    v_cvt_pk_bf16_f32 v67, v166, v167
    s_waitcnt lgkmcnt(10)
    v_mfma_f32_16x16x32_bf16 v[96:99], v[36:39], a[160:163], 0
    s_waitcnt lgkmcnt(8)
    v_mfma_f32_16x16x32_bf16 v[100:103], v[36:39], a[164:167], 0
    s_waitcnt lgkmcnt(6)
    v_mfma_f32_16x16x32_bf16 v[104:107], v[36:39], a[168:171], 0
    s_waitcnt lgkmcnt(4)
    v_mfma_f32_16x16x32_bf16 v[96:99], v[36:39], a[172:175], v[96:99]
    s_waitcnt lgkmcnt(2)
    v_mfma_f32_16x16x32_bf16 v[100:103], v[36:39], a[176:179], v[100:103]
    s_waitcnt lgkmcnt(0)
    v_mfma_f32_16x16x32_bf16 v[104:107], v[36:39], a[180:183], v[104:107]
    v_mfma_f32_32x32x16_bf16 v[208:223], a[200:203], v[48:51], 0
    v_mul_f32 v168, v168, v47
    v_mul_f32 v169, v169, v47
    v_mul_f32 v170, v170, v47
    v_mul_f32 v171, v171, v47
    v_mul_f32 v172, v172, v47
    v_mul_f32 v173, v173, v47
    buffer_load_dwordx4 v11, s[8:11], s84 offen offset:1024 lds
    v_mfma_f32_32x32x16_bf16 v[208:223], a[204:207], v[52:55], v[208:223]
    v_mul_f32 v174, v174, v47
    v_mul_f32 v175, v175, v47
    v_mul_f32 v176, v176, v47
    v_mul_f32 v177, v177, v47
    v_mul_f32 v178, v178, v47
    v_mul_f32 v179, v179, v47
    v_mfma_f32_32x32x16_bf16 v[208:223], a[208:211], v[56:59], v[208:223]
    v_mul_f32 v180, v180, v47
    v_mul_f32 v181, v181, v47
    v_mul_f32 v182, v182, v47
    v_mul_f32 v183, v183, v47
    v_mul_f32 v184, v184, v47
    v_mul_f32 v185, v185, v47
    v_mfma_f32_32x32x16_bf16 v[224:239], a[212:215], v[48:51], 0
    v_mul_f32 v186, v186, v47
    v_mul_f32 v187, v187, v47
    v_mul_f32 v188, v188, v47
    v_mul_f32 v189, v189, v47
    v_mul_f32 v190, v190, v47
    v_mul_f32 v191, v191, v47
    v_mfma_f32_32x32x16_bf16 v[224:239], a[216:219], v[52:55], v[224:239]
    v_mul_f32 v192, v192, v47
    v_mul_f32 v193, v193, v47
    v_mul_f32 v194, v194, v47
    v_mul_f32 v195, v195, v47
    v_mul_f32 v196, v196, v47
    v_mul_f32 v197, v197, v47
    v_mfma_f32_32x32x16_bf16 v[224:239], a[220:223], v[56:59], v[224:239]
    buffer_load_dwordx4 v12, s[8:11], s84 offen offset:2048 lds
    v_mul_f32 v198, v198, v47
    v_mul_f32 v199, v199, v47
    v_mul_f32 v200, v200, v47
    v_mul_f32 v201, v201, v47
    v_mul_f32 v202, v202, v47
    v_mul_f32 v203, v203, v47
    v_mfma_f32_32x32x16_bf16 v[224:239], a[224:227], v[60:63], v[224:239]
    v_mul_f32 v204, v204, v47
    v_mul_f32 v205, v205, v47
    v_mul_f32 v206, v206, v47
    v_mul_f32 v207, v207, v47
    v_cvt_pk_bf16_f32 v128, v168, v169
    v_cvt_pk_bf16_f32 v129, v170, v171
    v_mfma_f32_32x32x16_bf16 v[224:239], a[228:231], v[64:67], v[224:239]
    v_cvt_pk_bf16_f32 v130, v172, v173
    v_cvt_pk_bf16_f32 v131, v174, v175
    v_cvt_pk_bf16_f32 v132, v176, v177
    v_cvt_pk_bf16_f32 v133, v178, v179
    v_cvt_pk_bf16_f32 v134, v180, v181
    v_cvt_pk_bf16_f32 v135, v182, v183
    v_mfma_f32_32x32x16_bf16 v[240:255], a[232:235], v[56:59], 0
    v_cvt_pk_bf16_f32 v136, v184, v185
    v_cvt_pk_bf16_f32 v137, v186, v187
    v_mov_b32 v138, 0x3f80
    v_mov_b32 v139, 0
    v_cvt_pk_bf16_f32 v140, v188, v189
    v_cvt_pk_bf16_f32 v141, v190, v191
    v_mfma_f32_32x32x16_bf16 v[240:255], a[236:239], v[60:63], v[240:255]
    v_cvt_pk_bf16_f32 v142, v192, v193
    buffer_load_dwordx4 v13, s[8:11], s84 offen offset:3072 lds
    v_cvt_pk_bf16_f32 v143, v194, v195
    v_cvt_pk_bf16_f32 v144, v196, v197
    v_cvt_pk_bf16_f32 v145, v198, v199
    v_cvt_pk_bf16_f32 v146, v200, v201
    v_cvt_pk_bf16_f32 v147, v202, v203
    v_mfma_f32_32x32x16_bf16 v[240:255], a[240:243], v[64:67], v[240:255]
    v_cvt_pk_bf16_f32 v148, v204, v205
    v_cvt_pk_bf16_f32 v149, v206, v207
    v_mov_b32 v150, 0x3f80
    v_mov_b32 v151, 0
    v_cndmask_b32 v96, v97, v96, s[96:97]
    buffer_atomic_add_f32 v96, v116, s[12:15], s39 offen offset:640
    v_cndmask_b32 v100, v101, v100, s[96:97]
    buffer_atomic_add_f32 v100, v116, s[12:15], s39 offen offset:768
    v_cndmask_b32 v104, v105, v104, s[96:97]
    buffer_atomic_add_f32 v104, v116, s[12:15], s39 offen offset:896
    ds_write_b128 v122, v[128:131] offset:320
    ds_write_b128 v122, v[132:135] offset:336
    ds_write_b128 v122, v[136:139] offset:352
    ds_write_b128 v122, v[140:143] offset:368
    ds_write_b128 v122, v[144:147] offset:384
    ds_write_b128 v122, v[148:151] offset:400
    v_max3_f32 v108, v208, v209, v210
    v_min3_f32 v109, v208, v209, v210
    v_max3_f32 v108, v108, v211, v212
    v_min3_f32 v109, v109, v211, v212
    v_max3_f32 v108, v108, v213, v214
    v_min3_f32 v109, v109, v213, v214
    v_max3_f32 v108, v108, v215, v216
    v_min3_f32 v109, v109, v215, v216
    v_max3_f32 v108, v108, v217, v218
    v_min3_f32 v109, v109, v217, v218
    v_max3_f32 v108, v108, v219, v220
    v_min3_f32 v109, v109, v219, v220
    v_max3_f32 v108, v108, v221, v222
    s_add_u32 m0, s63, 71680
    s_nop 0
    buffer_load_dwordx4 v14, s[8:11], s84 offen lds
    v_min3_f32 v109, v109, v221, v222
    v_max3_f32 v108, v108, v223, v224
    v_min3_f32 v109, v109, v223, v224
    v_max3_f32 v108, v108, v225, v226
    v_min3_f32 v109, v109, v225, v226
    v_max_f32 v108, v108, v227
    v_min_f32 v109, v109, v227
    v_mul_f32 v108, v108, v44
    v_mul_f32 v109, v109, v44
    v_pk_fma_f32 v[68:69], v[208:209], v[44:45], v[108:109] op_sel:[0,0,0] op_sel_hi:[1,0,0] neg_lo:[0,0,1] neg_hi:[0,0,1]
    v_pk_fma_f32 v[70:71], v[210:211], v[44:45], v[108:109] op_sel:[0,0,0] op_sel_hi:[1,0,0] neg_lo:[0,0,1] neg_hi:[0,0,1]
    v_pk_fma_f32 v[72:73], v[212:213], v[44:45], v[108:109] op_sel:[0,0,0] op_sel_hi:[1,0,0] neg_lo:[0,0,1] neg_hi:[0,0,1]
    v_pk_fma_f32 v[74:75], v[214:215], v[44:45], v[108:109] op_sel:[0,0,0] op_sel_hi:[1,0,0] neg_lo:[0,0,1] neg_hi:[0,0,1]
    v_pk_fma_f32 v[76:77], v[216:217], v[44:45], v[108:109] op_sel:[0,0,0] op_sel_hi:[1,0,0] neg_lo:[0,0,1] neg_hi:[0,0,1]
    v_pk_fma_f32 v[78:79], v[218:219], v[44:45], v[108:109] op_sel:[0,0,0] op_sel_hi:[1,0,0] neg_lo:[0,0,1] neg_hi:[0,0,1]
    v_pk_fma_f32 v[80:81], v[220:221], v[44:45], v[108:109] op_sel:[0,0,0] op_sel_hi:[1,0,0] neg_lo:[0,0,1] neg_hi:[0,0,1]
    v_pk_fma_f32 v[82:83], v[222:223], v[44:45], v[108:109] op_sel:[0,0,0] op_sel_hi:[1,0,0] neg_lo:[0,0,1] neg_hi:[0,0,1]
    v_pk_fma_f32 v[84:85], v[224:225], v[44:45], v[108:109] op_sel:[0,0,0] op_sel_hi:[1,0,0] neg_lo:[0,0,1] neg_hi:[0,0,1]
    v_pk_fma_f32 v[86:87], v[226:227], v[44:45], v[108:109] op_sel:[0,0,0] op_sel_hi:[1,0,0] neg_lo:[0,0,1] neg_hi:[0,0,1]
    v_pk_fma_f32 v[88:89], v[208:209], v[44:45], v[108:109] op_sel:[0,0,1] op_sel_hi:[1,0,1] neg_lo:[1,0,0] neg_hi:[1,0,0]
    v_pk_fma_f32 v[90:91], v[210:211], v[44:45], v[108:109] op_sel:[0,0,1] op_sel_hi:[1,0,1] neg_lo:[1,0,0] neg_hi:[1,0,0]
    v_pk_fma_f32 v[92:93], v[212:213], v[44:45], v[108:109] op_sel:[0,0,1] op_sel_hi:[1,0,1] neg_lo:[1,0,0] neg_hi:[1,0,0]
    v_pk_fma_f32 v[94:95], v[214:215], v[44:45], v[108:109] op_sel:[0,0,1] op_sel_hi:[1,0,1] neg_lo:[1,0,0] neg_hi:[1,0,0]
    v_pk_fma_f32 v[96:97], v[216:217], v[44:45], v[108:109] op_sel:[0,0,1] op_sel_hi:[1,0,1] neg_lo:[1,0,0] neg_hi:[1,0,0]
    v_pk_fma_f32 v[98:99], v[218:219], v[44:45], v[108:109] op_sel:[0,0,1] op_sel_hi:[1,0,1] neg_lo:[1,0,0] neg_hi:[1,0,0]
    v_pk_fma_f32 v[100:101], v[220:221], v[44:45], v[108:109] op_sel:[0,0,1] op_sel_hi:[1,0,1] neg_lo:[1,0,0] neg_hi:[1,0,0]
    v_pk_fma_f32 v[102:103], v[222:223], v[44:45], v[108:109] op_sel:[0,0,1] op_sel_hi:[1,0,1] neg_lo:[1,0,0] neg_hi:[1,0,0]
    v_pk_fma_f32 v[104:105], v[224:225], v[44:45], v[108:109] op_sel:[0,0,1] op_sel_hi:[1,0,1] neg_lo:[1,0,0] neg_hi:[1,0,0]
    v_pk_fma_f32 v[106:107], v[226:227], v[44:45], v[108:109] op_sel:[0,0,1] op_sel_hi:[1,0,1] neg_lo:[1,0,0] neg_hi:[1,0,0]
    v_exp_f32 v68, v68
    v_exp_f32 v69, v69
    v_exp_f32 v70, v70
    v_exp_f32 v71, v71
    v_exp_f32 v72, v72
    v_exp_f32 v73, v73
    v_exp_f32 v74, v74
    v_exp_f32 v75, v75
    v_exp_f32 v76, v76
    v_exp_f32 v77, v77
    v_exp_f32 v78, v78
    v_exp_f32 v79, v79
    v_exp_f32 v80, v80
    v_exp_f32 v81, v81
    s_add_u32 m0, s63, 88064
    s_nop 0
    buffer_load_dwordx4 v10, s[8:11], s86 offen offset:0 lds
    v_exp_f32 v82, v82
    v_exp_f32 v83, v83
    v_exp_f32 v84, v84
    v_exp_f32 v85, v85
    v_exp_f32 v86, v86
    v_exp_f32 v87, v87
    v_exp_f32 v88, v88
    v_exp_f32 v89, v89
    v_exp_f32 v90, v90
    v_exp_f32 v91, v91
    v_exp_f32 v92, v92
    v_exp_f32 v93, v93
    v_exp_f32 v94, v94
    v_exp_f32 v95, v95
    v_exp_f32 v96, v96
    v_exp_f32 v97, v97
    v_exp_f32 v98, v98
    v_exp_f32 v99, v99
    v_exp_f32 v100, v100
    v_exp_f32 v101, v101
    v_exp_f32 v102, v102
    v_exp_f32 v103, v103
    v_exp_f32 v104, v104
    v_exp_f32 v105, v105
    v_exp_f32 v106, v106
    v_exp_f32 v107, v107
    v_pk_add_f32 v[208:209], v[68:69], v[70:71]
    v_pk_add_f32 v[210:211], v[72:73], v[74:75]
    v_pk_add_f32 v[212:213], v[76:77], v[78:79]
    v_pk_add_f32 v[214:215], v[80:81], v[82:83]
    v_pk_add_f32 v[216:217], v[84:85], v[86:87]
    v_pk_add_f32 v[218:219], v[88:89], v[90:91]
    v_pk_add_f32 v[220:221], v[92:93], v[94:95]
    v_pk_add_f32 v[222:223], v[96:97], v[98:99]
    v_pk_add_f32 v[224:225], v[100:101], v[102:103]
    buffer_load_dwordx4 v11, s[8:11], s86 offen offset:1024 lds
    v_pk_add_f32 v[226:227], v[104:105], v[106:107]
    v_pk_add_f32 v[208:209], v[208:209], v[210:211]
    v_pk_add_f32 v[212:213], v[212:213], v[214:215]
    v_pk_add_f32 v[218:219], v[218:219], v[220:221]
    v_pk_add_f32 v[222:223], v[222:223], v[224:225]
    v_pk_add_f32 v[208:209], v[208:209], v[212:213]
    v_pk_add_f32 v[218:219], v[218:219], v[222:223]
    v_pk_add_f32 v[208:209], v[208:209], v[216:217]
    v_pk_add_f32 v[218:219], v[218:219], v[226:227]
    v_add_f32 v112, v208, v209
    v_add_f32 v113, v218, v219
    v_rcp_f32 v110, v112
    v_rcp_f32 v111, v113
    s_nop 0
    v_pk_mul_f32 v[68:69], v[68:69], v[110:111] op_sel_hi:[1,0]
    v_pk_mul_f32 v[70:71], v[70:71], v[110:111] op_sel_hi:[1,0]
    v_pk_mul_f32 v[72:73], v[72:73], v[110:111] op_sel_hi:[1,0]
    v_pk_mul_f32 v[74:75], v[74:75], v[110:111] op_sel_hi:[1,0]
    v_pk_mul_f32 v[76:77], v[76:77], v[110:111] op_sel_hi:[1,0]
    v_pk_mul_f32 v[78:79], v[78:79], v[110:111] op_sel_hi:[1,0]
    v_pk_mul_f32 v[80:81], v[80:81], v[110:111] op_sel_hi:[1,0]
    v_pk_mul_f32 v[82:83], v[82:83], v[110:111] op_sel_hi:[1,0]
    v_pk_mul_f32 v[84:85], v[84:85], v[110:111] op_sel_hi:[1,0]
    v_pk_mul_f32 v[86:87], v[86:87], v[110:111] op_sel_hi:[1,0]
    v_pk_mul_f32 v[88:89], v[88:89], v[110:111] op_sel:[0,1] op_sel_hi:[1,1]
    v_pk_mul_f32 v[90:91], v[90:91], v[110:111] op_sel:[0,1] op_sel_hi:[1,1]
    v_pk_mul_f32 v[92:93], v[92:93], v[110:111] op_sel:[0,1] op_sel_hi:[1,1]
    v_pk_mul_f32 v[94:95], v[94:95], v[110:111] op_sel:[0,1] op_sel_hi:[1,1]
    v_pk_mul_f32 v[96:97], v[96:97], v[110:111] op_sel:[0,1] op_sel_hi:[1,1]
    v_pk_mul_f32 v[98:99], v[98:99], v[110:111] op_sel:[0,1] op_sel_hi:[1,1]
    v_pk_mul_f32 v[100:101], v[100:101], v[110:111] op_sel:[0,1] op_sel_hi:[1,1]
    v_pk_mul_f32 v[102:103], v[102:103], v[110:111] op_sel:[0,1] op_sel_hi:[1,1]
    v_pk_mul_f32 v[104:105], v[104:105], v[110:111] op_sel:[0,1] op_sel_hi:[1,1]
    v_pk_mul_f32 v[106:107], v[106:107], v[110:111] op_sel:[0,1] op_sel_hi:[1,1]
    v_cvt_pk_bf16_f32 v168, v68, v69
    v_cvt_pk_bf16_f32 v169, v70, v71
    v_cvt_pk_bf16_f32 v170, v72, v73
    v_cvt_pk_bf16_f32 v171, v74, v75
    v_cvt_pk_bf16_f32 v172, v76, v77
    v_cvt_pk_bf16_f32 v173, v78, v79
    v_cvt_pk_bf16_f32 v174, v80, v81
    v_cvt_pk_bf16_f32 v175, v82, v83
    v_cvt_pk_bf16_f32 v176, v84, v85
    v_cvt_pk_bf16_f32 v177, v86, v87
    v_cvt_pk_bf16_f32 v178, v88, v89
    v_cvt_pk_bf16_f32 v179, v90, v91
    v_cvt_pk_bf16_f32 v180, v92, v93
    v_cvt_pk_bf16_f32 v181, v94, v95
    v_cvt_pk_bf16_f32 v182, v96, v97
    v_cvt_pk_bf16_f32 v183, v98, v99
    buffer_load_dwordx4 v12, s[8:11], s86 offen offset:2048 lds
    v_cvt_pk_bf16_f32 v184, v100, v101
    v_cvt_pk_bf16_f32 v185, v102, v103
    v_cvt_pk_bf16_f32 v186, v104, v105
    v_cvt_pk_bf16_f32 v187, v106, v107
    ds_write_b128 v121, v[168:171] offset:0
    ds_write_b128 v121, v[172:175] offset:16
    ds_write_b128 v121, v[176:179] offset:32
    ds_write_b128 v121, v[180:183] offset:48
    ds_write_b128 v121, v[184:187] offset:64
    v_max3_f32 v108, v228, v229, v230
    v_min3_f32 v109, v228, v229, v230
    v_max3_f32 v108, v108, v231, v232
    v_min3_f32 v109, v109, v231, v232
    v_max3_f32 v108, v108, v233, v234
    v_min3_f32 v109, v109, v233, v234
    v_max3_f32 v108, v108, v235, v236
    v_min3_f32 v109, v109, v235, v236
    v_max3_f32 v108, v108, v237, v238
    v_min3_f32 v109, v109, v237, v238
    v_max3_f32 v108, v108, v239, v240
    v_min3_f32 v109, v109, v239, v240
    v_max3_f32 v108, v108, v241, v242
    v_min3_f32 v109, v109, v241, v242
    v_max3_f32 v108, v108, v243, v244
    v_min3_f32 v109, v109, v243, v244
    v_max3_f32 v108, v108, v245, v246
    v_min3_f32 v109, v109, v245, v246
    v_max_f32 v108, v108, v247
    v_min_f32 v109, v109, v247
    v_mul_f32 v108, v108, v44
    v_mul_f32 v109, v109, v44
    v_pk_fma_f32 v[68:69], v[228:229], v[44:45], v[108:109] op_sel:[0,0,0] op_sel_hi:[1,0,0] neg_lo:[0,0,1] neg_hi:[0,0,1]
    v_pk_fma_f32 v[70:71], v[230:231], v[44:45], v[108:109] op_sel:[0,0,0] op_sel_hi:[1,0,0] neg_lo:[0,0,1] neg_hi:[0,0,1]
    v_pk_fma_f32 v[72:73], v[232:233], v[44:45], v[108:109] op_sel:[0,0,0] op_sel_hi:[1,0,0] neg_lo:[0,0,1] neg_hi:[0,0,1]
    v_pk_fma_f32 v[74:75], v[234:235], v[44:45], v[108:109] op_sel:[0,0,0] op_sel_hi:[1,0,0] neg_lo:[0,0,1] neg_hi:[0,0,1]
    v_pk_fma_f32 v[76:77], v[236:237], v[44:45], v[108:109] op_sel:[0,0,0] op_sel_hi:[1,0,0] neg_lo:[0,0,1] neg_hi:[0,0,1]
    v_pk_fma_f32 v[78:79], v[238:239], v[44:45], v[108:109] op_sel:[0,0,0] op_sel_hi:[1,0,0] neg_lo:[0,0,1] neg_hi:[0,0,1]
    v_pk_fma_f32 v[80:81], v[240:241], v[44:45], v[108:109] op_sel:[0,0,0] op_sel_hi:[1,0,0] neg_lo:[0,0,1] neg_hi:[0,0,1]
    v_pk_fma_f32 v[82:83], v[242:243], v[44:45], v[108:109] op_sel:[0,0,0] op_sel_hi:[1,0,0] neg_lo:[0,0,1] neg_hi:[0,0,1]
    v_pk_fma_f32 v[84:85], v[244:245], v[44:45], v[108:109] op_sel:[0,0,0] op_sel_hi:[1,0,0] neg_lo:[0,0,1] neg_hi:[0,0,1]
    v_pk_fma_f32 v[86:87], v[246:247], v[44:45], v[108:109] op_sel:[0,0,0] op_sel_hi:[1,0,0] neg_lo:[0,0,1] neg_hi:[0,0,1]
    v_pk_fma_f32 v[88:89], v[228:229], v[44:45], v[108:109] op_sel:[0,0,1] op_sel_hi:[1,0,1] neg_lo:[1,0,0] neg_hi:[1,0,0]
    v_pk_fma_f32 v[90:91], v[230:231], v[44:45], v[108:109] op_sel:[0,0,1] op_sel_hi:[1,0,1] neg_lo:[1,0,0] neg_hi:[1,0,0]
    v_pk_fma_f32 v[92:93], v[232:233], v[44:45], v[108:109] op_sel:[0,0,1] op_sel_hi:[1,0,1] neg_lo:[1,0,0] neg_hi:[1,0,0]
    v_pk_fma_f32 v[94:95], v[234:235], v[44:45], v[108:109] op_sel:[0,0,1] op_sel_hi:[1,0,1] neg_lo:[1,0,0] neg_hi:[1,0,0]
    v_pk_fma_f32 v[96:97], v[236:237], v[44:45], v[108:109] op_sel:[0,0,1] op_sel_hi:[1,0,1] neg_lo:[1,0,0] neg_hi:[1,0,0]
    v_pk_fma_f32 v[98:99], v[238:239], v[44:45], v[108:109] op_sel:[0,0,1] op_sel_hi:[1,0,1] neg_lo:[1,0,0] neg_hi:[1,0,0]
    buffer_load_dwordx4 v13, s[8:11], s86 offen offset:3072 lds
    v_pk_fma_f32 v[100:101], v[240:241], v[44:45], v[108:109] op_sel:[0,0,1] op_sel_hi:[1,0,1] neg_lo:[1,0,0] neg_hi:[1,0,0]
    v_pk_fma_f32 v[102:103], v[242:243], v[44:45], v[108:109] op_sel:[0,0,1] op_sel_hi:[1,0,1] neg_lo:[1,0,0] neg_hi:[1,0,0]
    v_pk_fma_f32 v[104:105], v[244:245], v[44:45], v[108:109] op_sel:[0,0,1] op_sel_hi:[1,0,1] neg_lo:[1,0,0] neg_hi:[1,0,0]
    v_pk_fma_f32 v[106:107], v[246:247], v[44:45], v[108:109] op_sel:[0,0,1] op_sel_hi:[1,0,1] neg_lo:[1,0,0] neg_hi:[1,0,0]
    v_exp_f32 v68, v68
    v_exp_f32 v69, v69
    v_exp_f32 v70, v70
    v_exp_f32 v71, v71
    v_exp_f32 v72, v72
    v_exp_f32 v73, v73
    v_exp_f32 v74, v74
    v_exp_f32 v75, v75
    v_exp_f32 v76, v76
    v_exp_f32 v77, v77
    v_exp_f32 v78, v78
    v_exp_f32 v79, v79
    v_exp_f32 v80, v80
    v_exp_f32 v81, v81
    v_exp_f32 v82, v82
    v_exp_f32 v83, v83
    v_exp_f32 v84, v84
    v_exp_f32 v85, v85
    v_exp_f32 v86, v86
    v_exp_f32 v87, v87
    v_exp_f32 v88, v88
    v_exp_f32 v89, v89
    v_exp_f32 v90, v90
    v_exp_f32 v91, v91
    v_exp_f32 v92, v92
    v_exp_f32 v93, v93
    v_exp_f32 v94, v94
    v_exp_f32 v95, v95
    v_exp_f32 v96, v96
    s_add_u32 m0, s63, 92160
    s_nop 0
    buffer_load_dwordx4 v14, s[8:11], s86 offen lds
    v_exp_f32 v97, v97
    v_exp_f32 v98, v98
    v_exp_f32 v99, v99
    v_exp_f32 v100, v100
    v_exp_f32 v101, v101
    v_exp_f32 v102, v102
    v_exp_f32 v103, v103
    v_exp_f32 v104, v104
    v_exp_f32 v105, v105
    v_exp_f32 v106, v106
    v_exp_f32 v107, v107
    v_pk_add_f32 v[228:229], v[68:69], v[70:71]
    v_pk_add_f32 v[230:231], v[72:73], v[74:75]
    v_pk_add_f32 v[232:233], v[76:77], v[78:79]
    v_pk_add_f32 v[234:235], v[80:81], v[82:83]
    v_pk_add_f32 v[236:237], v[84:85], v[86:87]
    v_pk_add_f32 v[238:239], v[88:89], v[90:91]
    v_pk_add_f32 v[240:241], v[92:93], v[94:95]
    v_pk_add_f32 v[242:243], v[96:97], v[98:99]
    v_pk_add_f32 v[244:245], v[100:101], v[102:103]
    v_pk_add_f32 v[246:247], v[104:105], v[106:107]
    v_pk_add_f32 v[228:229], v[228:229], v[230:231]
    v_pk_add_f32 v[232:233], v[232:233], v[234:235]
    v_pk_add_f32 v[238:239], v[238:239], v[240:241]
    v_pk_add_f32 v[242:243], v[242:243], v[244:245]
    v_pk_add_f32 v[228:229], v[228:229], v[232:233]
    v_pk_add_f32 v[238:239], v[238:239], v[242:243]
    v_pk_add_f32 v[228:229], v[228:229], v[236:237]
    v_pk_add_f32 v[238:239], v[238:239], v[246:247]
    v_add_f32 v112, v228, v229
    v_add_f32 v113, v238, v239
    v_rcp_f32 v110, v112
    v_rcp_f32 v111, v113
    s_nop 0
    v_pk_mul_f32 v[68:69], v[68:69], v[110:111] op_sel_hi:[1,0]
    v_pk_mul_f32 v[70:71], v[70:71], v[110:111] op_sel_hi:[1,0]
    v_pk_mul_f32 v[72:73], v[72:73], v[110:111] op_sel_hi:[1,0]
    v_pk_mul_f32 v[74:75], v[74:75], v[110:111] op_sel_hi:[1,0]
    v_pk_mul_f32 v[76:77], v[76:77], v[110:111] op_sel_hi:[1,0]
    v_pk_mul_f32 v[78:79], v[78:79], v[110:111] op_sel_hi:[1,0]
    v_pk_mul_f32 v[80:81], v[80:81], v[110:111] op_sel_hi:[1,0]
    v_pk_mul_f32 v[82:83], v[82:83], v[110:111] op_sel_hi:[1,0]
    v_pk_mul_f32 v[84:85], v[84:85], v[110:111] op_sel_hi:[1,0]
    v_pk_mul_f32 v[86:87], v[86:87], v[110:111] op_sel_hi:[1,0]
    v_pk_mul_f32 v[88:89], v[88:89], v[110:111] op_sel:[0,1] op_sel_hi:[1,1]
    v_pk_mul_f32 v[90:91], v[90:91], v[110:111] op_sel:[0,1] op_sel_hi:[1,1]
    v_pk_mul_f32 v[92:93], v[92:93], v[110:111] op_sel:[0,1] op_sel_hi:[1,1]
    v_pk_mul_f32 v[94:95], v[94:95], v[110:111] op_sel:[0,1] op_sel_hi:[1,1]
    v_pk_mul_f32 v[96:97], v[96:97], v[110:111] op_sel:[0,1] op_sel_hi:[1,1]
    v_pk_mul_f32 v[98:99], v[98:99], v[110:111] op_sel:[0,1] op_sel_hi:[1,1]
    v_pk_mul_f32 v[100:101], v[100:101], v[110:111] op_sel:[0,1] op_sel_hi:[1,1]
    v_pk_mul_f32 v[102:103], v[102:103], v[110:111] op_sel:[0,1] op_sel_hi:[1,1]
    v_pk_mul_f32 v[104:105], v[104:105], v[110:111] op_sel:[0,1] op_sel_hi:[1,1]
    v_pk_mul_f32 v[106:107], v[106:107], v[110:111] op_sel:[0,1] op_sel_hi:[1,1]
    v_cvt_pk_bf16_f32 v188, v68, v69
    v_cvt_pk_bf16_f32 v189, v70, v71
    v_cvt_pk_bf16_f32 v190, v72, v73
    v_cvt_pk_bf16_f32 v191, v74, v75
    v_cvt_pk_bf16_f32 v192, v76, v77
    v_cvt_pk_bf16_f32 v193, v78, v79
    v_cvt_pk_bf16_f32 v194, v80, v81
    v_cvt_pk_bf16_f32 v195, v82, v83
    v_cvt_pk_bf16_f32 v196, v84, v85
    v_cvt_pk_bf16_f32 v197, v86, v87
    v_cvt_pk_bf16_f32 v198, v88, v89
    v_cvt_pk_bf16_f32 v199, v90, v91
    v_cvt_pk_bf16_f32 v200, v92, v93
    v_cvt_pk_bf16_f32 v201, v94, v95
    v_cvt_pk_bf16_f32 v202, v96, v97
    v_cvt_pk_bf16_f32 v203, v98, v99
    v_cvt_pk_bf16_f32 v204, v100, v101
    v_cvt_pk_bf16_f32 v205, v102, v103
    v_cvt_pk_bf16_f32 v206, v104, v105
    v_cvt_pk_bf16_f32 v207, v106, v107
    ds_write_b128 v121, v[188:191] offset:80
    ds_write_b128 v121, v[192:195] offset:96
    ds_write_b128 v121, v[196:199] offset:112
    ds_write_b128 v121, v[200:203] offset:128
    ds_write_b128 v121, v[204:207] offset:144
    s_waitcnt lgkmcnt(0)
    s_waitcnt vmcnt(6)
    s_barrier
    buffer_store_dword a255, v117, s[12:15], s43 offen offset:128 sc1
    ds_read_b64_tr_b16 v[128:129], v22 offset:0
    ds_read_b64_tr_b16 v[130:131], v22 offset:2112
    ds_read_b64_tr_b16 v[132:133], v22 offset:32
    ds_read_b64_tr_b16 v[134:135], v22 offset:2144
    ds_read_b64_tr_b16 v[136:137], v21 offset:0
    ds_read_b64_tr_b16 v[138:139], v21 offset:2112
    ds_read_b64_tr_b16 v[140:141], v21 offset:32
    ds_read_b64_tr_b16 v[142:143], v21 offset:2144
    ds_read_b64_tr_b16 v[144:145], v21 offset:64
    ds_read_b64_tr_b16 v[146:147], v21 offset:2176
    ds_read_b64_tr_b16 v[148:149], v22 offset:16896
    ds_read_b64_tr_b16 v[150:151], v22 offset:19008
    ds_read_b64_tr_b16 v[152:153], v22 offset:16928
    ds_read_b64_tr_b16 v[154:155], v22 offset:19040
    ds_read_b64_tr_b16 v[156:157], v21 offset:16896
    ds_read_b64_tr_b16 v[158:159], v21 offset:19008
    ds_read_b64_tr_b16 v[160:161], v21 offset:16928
    ds_read_b64_tr_b16 v[162:163], v21 offset:19040
    ds_read_b64_tr_b16 v[164:165], v21 offset:16960
    ds_read_b64_tr_b16 v[166:167], v21 offset:19072
    ds_read_b64_tr_b16 v[168:169], v22 offset:33792
    ds_read_b64_tr_b16 v[170:171], v22 offset:35904
    ds_read_b64_tr_b16 v[172:173], v22 offset:33824
    ds_read_b64_tr_b16 v[174:175], v22 offset:35936
    ds_read_b64_tr_b16 v[176:177], v21 offset:33792
    ds_read_b64_tr_b16 v[178:179], v21 offset:35904
    ds_read_b64_tr_b16 v[180:181], v21 offset:33824
    ds_read_b64_tr_b16 v[182:183], v21 offset:35936
    ds_read_b64_tr_b16 v[184:185], v21 offset:33856
    ds_read_b64_tr_b16 v[186:187], v21 offset:35968
    ds_read_b64_tr_b16 v[188:189], v22 offset:50688
    ds_read_b64_tr_b16 v[190:191], v22 offset:52800
    ds_read_b64_tr_b16 v[192:193], v22 offset:50720
    ds_read_b64_tr_b16 v[194:195], v22 offset:52832
    ds_read_b64_tr_b16 v[196:197], v21 offset:50688
    ds_read_b64_tr_b16 v[198:199], v21 offset:52800
    ds_read_b64_tr_b16 v[200:201], v21 offset:50720
    ds_read_b64_tr_b16 v[202:203], v21 offset:52832
    ds_read_b64_tr_b16 v[204:205], v21 offset:50752
    ds_read_b64_tr_b16 v[206:207], v21 offset:52864
    v_lshrrev_b32 v120, 4, v1
    v_mul_u32_u24 v124, 768, v120
    v_and_b32 v125, 15, v1
    v_lshl_add_u32 v124, v125, 2, v124
    v_lshlrev_b32 v126, 2, v125
    s_lshl_b32 s42, s30, 14
    s_mul_i32 s98, s28, 4032
    s_add_u32 s42, s42, s98
    s_add_u32 s42, s42, 12288
    v_mov_b32 v120, 0x7f000000
    s_mov_b32 s98, 0xffffffff
    s_mov_b32 s99, 0x0
    v_cndmask_b32 v116, v120, v124, s[98:99]
    s_mov_b32 s98, 0xffff
    s_mov_b32 s99, 0x0
    v_cndmask_b32 v117, v120, v124, s[98:99]
    s_mov_b32 s98, 0xff00ff
    s_mov_b32 s99, 0xff00ff
    v_cndmask_b32 v118, v120, v124, s[98:99]
    s_mov_b32 s98, 0xff00ff
    s_mov_b32 s99, 0x0
    v_cndmask_b32 v119, v120, v124, s[98:99]
    s_mov_b32 s98, 0xff
    s_mov_b32 s99, 0x0
    v_cndmask_b32 v125, v120, v124, s[98:99]
    s_waitcnt lgkmcnt(15)
    v_mfma_f32_16x16x32_bf16 v[92:95], v[128:131], v[136:139], 0
    v_mfma_f32_16x16x32_bf16 v[96:99], v[128:131], v[140:143], 0
    v_mfma_f32_16x16x32_bf16 v[100:103], v[128:131], v[144:147], 0
    v_mfma_f32_16x16x32_bf16 v[104:107], v[132:135], v[136:139], 0
    v_mfma_f32_16x16x32_bf16 v[108:111], v[132:135], v[140:143], 0
    v_mfma_f32_16x16x32_bf16 v[112:115], v[132:135], v[144:147], 0
    v_mfma_f32_16x16x32_bf16 v[92:95], v[148:151], v[156:159], v[92:95]
    v_mfma_f32_16x16x32_bf16 v[96:99], v[148:151], v[160:163], v[96:99]
    v_mfma_f32_16x16x32_bf16 v[100:103], v[148:151], v[164:167], v[100:103]
    v_mfma_f32_16x16x32_bf16 v[104:107], v[152:155], v[156:159], v[104:107]
    v_mfma_f32_16x16x32_bf16 v[108:111], v[152:155], v[160:163], v[108:111]
    v_mfma_f32_16x16x32_bf16 v[112:115], v[152:155], v[164:167], v[112:115]
    s_waitcnt lgkmcnt(14)
    v_mfma_f32_16x16x32_bf16 v[92:95], v[168:171], v[176:179], v[92:95]
    s_waitcnt lgkmcnt(12)
    v_mfma_f32_16x16x32_bf16 v[96:99], v[168:171], v[180:183], v[96:99]
    s_waitcnt lgkmcnt(10)
    v_mfma_f32_16x16x32_bf16 v[100:103], v[168:171], v[184:187], v[100:103]
    v_mfma_f32_16x16x32_bf16 v[104:107], v[172:175], v[176:179], v[104:107]
    v_mfma_f32_16x16x32_bf16 v[108:111], v[172:175], v[180:183], v[108:111]
    v_mfma_f32_16x16x32_bf16 v[112:115], v[172:175], v[184:187], v[112:115]
    s_waitcnt lgkmcnt(4)
    v_mfma_f32_16x16x32_bf16 v[92:95], v[188:191], v[196:199], v[92:95]
    s_waitcnt lgkmcnt(2)
    v_mfma_f32_16x16x32_bf16 v[96:99], v[188:191], v[200:203], v[96:99]
    s_waitcnt lgkmcnt(0)
    v_mfma_f32_16x16x32_bf16 v[100:103], v[188:191], v[204:207], v[100:103]
    v_mfma_f32_16x16x32_bf16 v[104:107], v[192:195], v[196:199], v[104:107]
    v_mfma_f32_16x16x32_bf16 v[108:111], v[192:195], v[200:203], v[108:111]
    v_mfma_f32_16x16x32_bf16 v[112:115], v[192:195], v[204:207], v[112:115]
    v_lshrrev_b32 v86, 2, v1
    v_lshlrev_b32 v86, 7, v86
    v_and_b32 v84, 3, v1
    v_lshl_add_u32 v86, v84, 3, v86
    s_mov_b32 s101, 9216
    buffer_load_dwordx2 v[84:85], v86, s[12:15], s101 offen sc1
    s_lshl_b32 s79, s30, 7
    s_add_u32 s79, s79, 8192
    s_lshl_b32 s58, s29, 2
    s_add_u32 s100, s79, s58
    v_and_b32 v71, 31, v1
    v_lshlrev_b32 v71, 2, v71
    s_cmp_lt_u32 s29, 5
    s_cselect_b32 s98, -1, 0
    s_mov_b32 s99, 0
    v_mov_b32 v68, 0x7f000000
    v_cndmask_b32 v68, v68, v71, s[98:99]
    s_cmp_lt_u32 s29, 5
    s_cselect_b32 s98, -1, 0
    s_mov_b32 s99, s98
    v_mov_b32 v69, 0x7f000000
    v_cndmask_b32 v69, v69, v15, s[98:99]
    v_and_b32 v72, 15, v1
    v_lshlrev_b32 v72, 2, v72
    v_add_u32 v70, s40, v72
    v_add_u32 v72, s41, v72
    v_cndmask_b32 v70, v72, v70, s[96:97]
    s_barrier
    ds_read_b64_tr_b16 a[160:161], v32 offset:0
    ds_read_b64_tr_b16 a[162:163], v32 offset:80
    ds_read_b64_tr_b16 a[164:165], v32 offset:32
    ds_read_b64_tr_b16 a[166:167], v32 offset:112
    ds_read_b64_tr_b16 a[168:169], v32 offset:64
    ds_read_b64_tr_b16 a[170:171], v32 offset:144
    ds_read_b64_tr_b16 a[172:173], v33 offset:0
    ds_read_b64_tr_b16 a[174:175], v33 offset:80
    ds_read_b64_tr_b16 a[176:177], v33 offset:32
    ds_read_b64_tr_b16 a[178:179], v33 offset:112
    ds_read_b64_tr_b16 a[180:181], v33 offset:64
    ds_read_b64_tr_b16 a[182:183], v33 offset:144
    ds_read_b64_tr_b16 a[184:185], v34 offset:0
    ds_read_b64_tr_b16 a[186:187], v34 offset:80
    s_waitcnt lgkmcnt(10)
    v_mfma_f32_32x32x16_bf16 v[208:223], a[160:163], a[0:3], 0
    ds_read_b64_tr_b16 a[188:189], v34 offset:32
    ds_read_b64_tr_b16 a[190:191], v34 offset:112
    s_add_u32 m0, s63, 47104
    s_nop 0
    buffer_load_dwordx4 v10, s[8:11], s88 offen offset:0 lds
    buffer_load_dword v72, v70, s[12:15], 0 offen offset:128 sc1
    v_mfma_f32_32x32x16_bf16 v[224:239], a[164:167], a[0:3], 0
    ds_read_b64_tr_b16 a[192:193], v34 offset:64
    ds_read_b64_tr_b16 a[194:195], v34 offset:144
    s_waitcnt lgkmcnt(10)
    v_mfma_f32_32x32x16_bf16 v[240:255], a[168:171], a[0:3], 0
    ds_read_b64_tr_b16 a[196:197], v35 offset:0
    ds_read_b64_tr_b16 a[198:199], v35 offset:80
    buffer_load_dwordx4 v11, s[8:11], s88 offen offset:1024 lds
    v_mfma_f32_32x32x16_bf16 v[208:223], a[172:175], a[4:7], v[208:223]
    ds_read_b64_tr_b16 a[160:161], v35 offset:32
    ds_read_b64_tr_b16 a[162:163], v35 offset:112
    s_waitcnt lgkmcnt(10)
    v_mfma_f32_32x32x16_bf16 v[224:239], a[176:179], a[4:7], v[224:239]
    ds_read_b64_tr_b16 a[164:165], v35 offset:64
    ds_read_b64_tr_b16 a[166:167], v35 offset:144
    buffer_load_dwordx4 v12, s[8:11], s88 offen offset:2048 lds
    v_mfma_f32_32x32x16_bf16 v[240:255], a[180:183], a[4:7], v[240:255]
    ds_read_b64_tr_b16 a[168:169], v32 offset:10240
    ds_read_b64_tr_b16 a[170:171], v32 offset:10320
    s_waitcnt lgkmcnt(10)
    v_mfma_f32_32x32x16_bf16 v[208:223], a[184:187], a[8:11], v[208:223]
    ds_read_b64_tr_b16 a[172:173], v32 offset:10272
    ds_read_b64_tr_b16 a[174:175], v32 offset:10352
    buffer_load_dwordx4 v13, s[8:11], s88 offen offset:3072 lds
    v_mfma_f32_32x32x16_bf16 v[224:239], a[188:191], a[8:11], v[224:239]
    ds_read_b64_tr_b16 a[176:177], v32 offset:10304
    ds_read_b64_tr_b16 a[178:179], v32 offset:10384
    s_waitcnt lgkmcnt(10)
    v_mfma_f32_32x32x16_bf16 v[240:255], a[192:195], a[8:11], v[240:255]
    ds_read_b64_tr_b16 a[180:181], v33 offset:10240
    ds_read_b64_tr_b16 a[182:183], v33 offset:10320
    s_add_u32 m0, s63, 51200
    s_nop 0
    buffer_load_dwordx4 v14, s[8:11], s88 offen lds
    v_mfma_f32_32x32x16_bf16 v[208:223], a[196:199], a[12:15], v[208:223]
    ds_read_b64_tr_b16 a[184:185], v33 offset:10272
    ds_read_b64_tr_b16 a[186:187], v33 offset:10352
    s_waitcnt lgkmcnt(10)
    v_mfma_f32_32x32x16_bf16 v[224:239], a[160:163], a[12:15], v[224:239]
    ds_read_b64_tr_b16 a[188:189], v33 offset:10304
    ds_read_b64_tr_b16 a[190:191], v33 offset:10384
    v_add_u32 v16, 4096, v2
    v_add_u32 v17, 8192, v2
    v_add_u32 v18, 12288, v2
    v_add_u32 v19, 16384, v2
    v_add_u32 v13, 20480, v2
    v_add_u32 v14, 24576, v2
    buffer_atomic_add_f32 v92, v124, s[12:15], s42 offen offset:0
    v_mfma_f32_32x32x16_bf16 v[240:255], a[164:167], a[12:15], v[240:255]
    ds_read_b64_tr_b16 a[192:193], v34 offset:10240
    ds_read_b64_tr_b16 a[194:195], v34 offset:10320
    s_waitcnt lgkmcnt(10)
    v_mfma_f32_32x32x16_bf16 v[208:223], a[168:171], a[16:19], v[208:223]
    ds_read_b64_tr_b16 a[196:197], v34 offset:10272
    ds_read_b64_tr_b16 a[198:199], v34 offset:10352
    buffer_atomic_add_f32 v96, v124, s[12:15], s42 offen offset:64
    v_mfma_f32_32x32x16_bf16 v[224:239], a[172:175], a[16:19], v[224:239]
    ds_read_b64_tr_b16 a[160:161], v34 offset:10304
    ds_read_b64_tr_b16 a[162:163], v34 offset:10384
    s_waitcnt lgkmcnt(10)
    v_mfma_f32_32x32x16_bf16 v[240:255], a[176:179], a[16:19], v[240:255]
    ds_read_b64_tr_b16 a[164:165], v35 offset:10240
    ds_read_b64_tr_b16 a[166:167], v35 offset:10320
    buffer_atomic_add_f32 v100, v118, s[12:15], s42 offen offset:128
    v_mfma_f32_32x32x16_bf16 v[208:223], a[180:183], a[20:23], v[208:223]
    ds_read_b64_tr_b16 a[168:169], v35 offset:10272
    ds_read_b64_tr_b16 a[170:171], v35 offset:10352
    s_waitcnt lgkmcnt(10)
    v_mfma_f32_32x32x16_bf16 v[224:239], a[184:187], a[20:23], v[224:239]
    ds_read_b64_tr_b16 a[172:173], v35 offset:10304
    ds_read_b64_tr_b16 a[174:175], v35 offset:10384
    buffer_atomic_add_f32 v93, v124, s[12:15], s42 offen offset:192
    s_waitcnt vmcnt(8)
    v_cmp_ne_u32 vcc, 1, v72
    s_nop 0
    s_and_b32 s58, vcc_lo, 0x1f
    s_cbranch_scc1 L_slow_cs1q
L_back_cs1q:
    buffer_load_dword v80, v71, s[12:15], s39 offen offset:640 sc1
    buffer_load_dword v81, v71, s[12:15], s39 offen offset:768 sc1
    buffer_load_dword v82, v71, s[12:15], s39 offen offset:896 sc1
    v_mfma_f32_32x32x16_bf16 v[240:255], a[188:191], a[20:23], v[240:255]
    s_barrier
    ds_read_b64_tr_b16 a[176:177], v32 offset:20480
    ds_read_b64_tr_b16 a[178:179], v32 offset:20560
    s_waitcnt lgkmcnt(10)
    v_mfma_f32_32x32x16_bf16 v[208:223], a[192:195], a[24:27], v[208:223]
    ds_read_b64_tr_b16 a[180:181], v32 offset:20512
    ds_read_b64_tr_b16 a[182:183], v32 offset:20592
    buffer_atomic_add_f32 v97, v124, s[12:15], s42 offen offset:256
    v_mfma_f32_32x32x16_bf16 v[224:239], a[196:199], a[24:27], v[224:239]
    ds_read_b64_tr_b16 a[184:185], v32 offset:20544
    ds_read_b64_tr_b16 a[186:187], v32 offset:20624
    s_waitcnt lgkmcnt(10)
    v_mfma_f32_32x32x16_bf16 v[240:255], a[160:163], a[24:27], v[240:255]
    ds_read_b64_tr_b16 a[188:189], v33 offset:20480
    ds_read_b64_tr_b16 a[190:191], v33 offset:20560
    buffer_atomic_add_f32 v101, v118, s[12:15], s42 offen offset:320
    v_mfma_f32_32x32x16_bf16 v[208:223], a[164:167], a[28:31], v[208:223]
    ds_read_b64_tr_b16 a[192:193], v33 offset:20512
    ds_read_b64_tr_b16 a[194:195], v33 offset:20592
    s_waitcnt lgkmcnt(10)
    v_mfma_f32_32x32x16_bf16 v[224:239], a[168:171], a[28:31], v[224:239]
    ds_read_b64_tr_b16 a[196:197], v33 offset:20544
    ds_read_b64_tr_b16 a[198:199], v33 offset:20624
    buffer_atomic_add_f32 v94, v124, s[12:15], s42 offen offset:384
    v_mfma_f32_32x32x16_bf16 v[240:255], a[172:175], a[28:31], v[240:255]
    ds_read_b64_tr_b16 a[160:161], v34 offset:20480
    ds_read_b64_tr_b16 a[162:163], v34 offset:20560
    s_waitcnt lgkmcnt(10)
    v_mfma_f32_32x32x16_bf16 v[208:223], a[176:179], a[32:35], v[208:223]
    ds_read_b64_tr_b16 a[164:165], v34 offset:20512
    ds_read_b64_tr_b16 a[166:167], v34 offset:20592
    buffer_atomic_add_f32 v98, v124, s[12:15], s42 offen offset:448
    v_mfma_f32_32x32x16_bf16 v[224:239], a[180:183], a[32:35], v[224:239]
    ds_read_b64_tr_b16 a[168:169], v34 offset:20544
    ds_read_b64_tr_b16 a[170:171], v34 offset:20624
    s_waitcnt lgkmcnt(10)
    v_mfma_f32_32x32x16_bf16 v[240:255], a[184:187], a[32:35], v[240:255]
    ds_read_b64_tr_b16 a[172:173], v35 offset:20480
    ds_read_b64_tr_b16 a[174:175], v35 offset:20560
    buffer_atomic_add_f32 v102, v118, s[12:15], s42 offen offset:512
    v_mfma_f32_32x32x16_bf16 v[208:223], a[188:191], a[36:39], v[208:223]
    ds_read_b64_tr_b16 a[176:177], v35 offset:20512
    ds_read_b64_tr_b16 a[178:179], v35 offset:20592
    s_waitcnt lgkmcnt(10)
    v_mfma_f32_32x32x16_bf16 v[224:239], a[192:195], a[36:39], v[224:239]
    ds_read_b64_tr_b16 a[180:181], v35 offset:20544
    ds_read_b64_tr_b16 a[182:183], v35 offset:20624
    buffer_atomic_add_f32 v95, v124, s[12:15], s42 offen offset:576
    v_mfma_f32_32x32x16_bf16 v[240:255], a[196:199], a[36:39], v[240:255]
    ds_read_b64_tr_b16 a[184:185], v32 offset:30720
    ds_read_b64_tr_b16 a[186:187], v32 offset:30800
    s_waitcnt lgkmcnt(10)
    v_mfma_f32_32x32x16_bf16 v[208:223], a[160:163], a[40:43], v[208:223]
    ds_read_b64_tr_b16 a[188:189], v32 offset:30752
    ds_read_b64_tr_b16 a[190:191], v32 offset:30832
    buffer_atomic_add_f32 v99, v124, s[12:15], s42 offen offset:640
    v_mfma_f32_32x32x16_bf16 v[224:239], a[164:167], a[40:43], v[224:239]
    ds_read_b64_tr_b16 a[192:193], v32 offset:30784
    ds_read_b64_tr_b16 a[194:195], v32 offset:30864
    s_waitcnt lgkmcnt(10)
    v_mfma_f32_32x32x16_bf16 v[240:255], a[168:171], a[40:43], v[240:255]
    ds_read_b64_tr_b16 a[196:197], v33 offset:30720
    ds_read_b64_tr_b16 a[198:199], v33 offset:30800
    buffer_atomic_add_f32 v103, v118, s[12:15], s42 offen offset:704
    v_mfma_f32_32x32x16_bf16 v[208:223], a[172:175], a[44:47], v[208:223]
    ds_read_b64_tr_b16 a[160:161], v33 offset:30752
    ds_read_b64_tr_b16 a[162:163], v33 offset:30832
    s_waitcnt lgkmcnt(10)
    v_mfma_f32_32x32x16_bf16 v[224:239], a[176:179], a[44:47], v[224:239]
    ds_read_b64_tr_b16 a[164:165], v33 offset:30784
    ds_read_b64_tr_b16 a[166:167], v33 offset:30864
    buffer_atomic_add_f32 v104, v116, s[12:15], s42 offen offset:3072
    v_mfma_f32_32x32x16_bf16 v[240:255], a[180:183], a[44:47], v[240:255]
    ds_read_b64_tr_b16 a[168:169], v34 offset:30720
    ds_read_b64_tr_b16 a[170:171], v34 offset:30800
    s_waitcnt lgkmcnt(10)
    v_mfma_f32_32x32x16_bf16 v[208:223], a[184:187], a[48:51], v[208:223]
    ds_read_b64_tr_b16 a[172:173], v34 offset:30752
    ds_read_b64_tr_b16 a[174:175], v34 offset:30832
    buffer_atomic_add_f32 v108, v116, s[12:15], s42 offen offset:3136
    v_mfma_f32_32x32x16_bf16 v[224:239], a[188:191], a[48:51], v[224:239]
    ds_read_b64_tr_b16 a[176:177], v34 offset:30784
    ds_read_b64_tr_b16 a[178:179], v34 offset:30864
    s_waitcnt lgkmcnt(10)
    v_mfma_f32_32x32x16_bf16 v[240:255], a[192:195], a[48:51], v[240:255]
    ds_read_b64_tr_b16 a[180:181], v35 offset:30720
    ds_read_b64_tr_b16 a[182:183], v35 offset:30800
    buffer_atomic_add_f32 v112, v119, s[12:15], s42 offen offset:3200
    v_mfma_f32_32x32x16_bf16 v[208:223], a[196:199], a[52:55], v[208:223]
    ds_read_b64_tr_b16 a[184:185], v35 offset:30752
    ds_read_b64_tr_b16 a[186:187], v35 offset:30832
    s_waitcnt lgkmcnt(10)
    v_mfma_f32_32x32x16_bf16 v[224:239], a[160:163], a[52:55], v[224:239]
    ds_read_b64_tr_b16 a[188:189], v35 offset:30784
    ds_read_b64_tr_b16 a[190:191], v35 offset:30864
    buffer_atomic_add_f32 v105, v117, s[12:15], s42 offen offset:3264
    v_mfma_f32_32x32x16_bf16 v[240:255], a[164:167], a[52:55], v[240:255]
    s_barrier
    ds_read_b64_tr_b16 a[192:193], v28 offset:20480
    ds_read_b64_tr_b16 a[194:195], v28 offset:20560
    s_waitcnt lgkmcnt(10)
    v_mfma_f32_32x32x16_bf16 v[208:223], a[168:171], a[56:59], v[208:223]
    ds_read_b64_tr_b16 a[196:197], v28 offset:20512
    ds_read_b64_tr_b16 a[198:199], v28 offset:20592
    buffer_atomic_add_f32 v109, v117, s[12:15], s42 offen offset:3328
    v_mfma_f32_32x32x16_bf16 v[224:239], a[172:175], a[56:59], v[224:239]
    ds_read_b64_tr_b16 a[160:161], v28 offset:20544
    ds_read_b64_tr_b16 a[162:163], v28 offset:20624
    s_waitcnt lgkmcnt(10)
    v_mfma_f32_32x32x16_bf16 v[240:255], a[176:179], a[56:59], v[240:255]
    ds_read_b64_tr_b16 a[164:165], v29 offset:20480
    ds_read_b64_tr_b16 a[166:167], v29 offset:20560
    buffer_atomic_add_f32 v113, v125, s[12:15], s42 offen offset:3392
    v_mfma_f32_32x32x16_bf16 v[208:223], a[180:183], a[60:63], v[208:223]
    ds_read_b64_tr_b16 a[168:169], v29 offset:20512
    ds_read_b64_tr_b16 a[170:171], v29 offset:20592
    s_waitcnt lgkmcnt(10)
    v_mfma_f32_32x32x16_bf16 v[224:239], a[184:187], a[60:63], v[224:239]
    ds_read_b64_tr_b16 a[172:173], v29 offset:20544
    ds_read_b64_tr_b16 a[174:175], v29 offset:20624
    buffer_atomic_add_f32 v106, v117, s[12:15], s42 offen offset:3456
    v_mfma_f32_32x32x16_bf16 v[240:255], a[188:191], a[60:63], v[240:255]
    ds_read_b64_tr_b16 a[176:177], v30 offset:20480
    ds_read_b64_tr_b16 a[178:179], v30 offset:20560
    s_waitcnt lgkmcnt(10)
    v_mfma_f32_32x32x16_bf16 v[208:223], a[192:195], a[64:67], v[208:223]
    ds_read_b64_tr_b16 a[180:181], v30 offset:20512
    ds_read_b64_tr_b16 a[182:183], v30 offset:20592
    buffer_atomic_add_f32 v110, v117, s[12:15], s42 offen offset:3520
    v_bfe_u32 v88, v1, 3, 2
    v_mfma_f32_32x32x16_bf16 v[224:239], a[196:199], a[64:67], v[224:239]
    ds_read_b64_tr_b16 a[184:185], v30 offset:20544
    ds_read_b64_tr_b16 a[186:187], v30 offset:20624
    v_bfe_u32 v89, v1, 2, 1
    s_waitcnt lgkmcnt(10)
    v_mfma_f32_32x32x16_bf16 v[240:255], a[160:163], a[64:67], v[240:255]
    ds_read_b64_tr_b16 a[188:189], v31 offset:20480
    ds_read_b64_tr_b16 a[190:191], v31 offset:20560
    buffer_atomic_add_f32 v114, v125, s[12:15], s42 offen offset:3584
    v_lshrrev_b32 v90, 5, v1
    v_mfma_f32_32x32x16_bf16 v[208:223], a[164:167], a[68:71], v[208:223]
    ds_read_b64_tr_b16 a[192:193], v31 offset:20512
    ds_read_b64_tr_b16 a[194:195], v31 offset:20592
    v_cmp_eq_u32 s[98:99], v89, v90
    s_waitcnt lgkmcnt(10)
    v_mfma_f32_32x32x16_bf16 v[224:239], a[168:171], a[68:71], v[224:239]
    ds_read_b64_tr_b16 a[196:197], v31 offset:20544
    ds_read_b64_tr_b16 a[198:199], v31 offset:20624
    buffer_atomic_add_f32 v107, v117, s[12:15], s42 offen offset:3648
    v_and_b32 v90, 3, v1
    v_mfma_f32_32x32x16_bf16 v[240:255], a[172:175], a[68:71], v[240:255]
    ds_read_b64_tr_b16 a[160:161], v28 offset:30720
    ds_read_b64_tr_b16 a[162:163], v28 offset:30800
    v_lshl_add_u32 v90, v88, 2, v90
    s_waitcnt lgkmcnt(10)
    v_mfma_f32_32x32x16_bf16 v[208:223], a[176:179], a[72:75], v[208:223]
    ds_read_b64_tr_b16 a[164:165], v28 offset:30752
    ds_read_b64_tr_b16 a[166:167], v28 offset:30832
    buffer_atomic_add_f32 v111, v117, s[12:15], s42 offen offset:3712
    v_mul_u32_u24 v89, 42, v89
    v_mfma_f32_32x32x16_bf16 v[224:239], a[180:183], a[72:75], v[224:239]
    ds_read_b64_tr_b16 a[168:169], v28 offset:30784
    ds_read_b64_tr_b16 a[170:171], v28 offset:30864
    v_add_u32 v90, v90, v89
    s_waitcnt lgkmcnt(10)
    v_mfma_f32_32x32x16_bf16 v[240:255], a[184:187], a[72:75], v[240:255]
    ds_read_b64_tr_b16 a[172:173], v29 offset:30720
    ds_read_b64_tr_b16 a[174:175], v29 offset:30800
    buffer_atomic_add_f32 v115, v125, s[12:15], s42 offen offset:3776
    v_mul_u32_u24 v90, 96, v90
    v_mfma_f32_32x32x16_bf16 v[208:223], a[188:191], a[76:79], v[208:223]
    ds_read_b64_tr_b16 a[176:177], v29 offset:30752
    ds_read_b64_tr_b16 a[178:179], v29 offset:30832
    v_mov_b32 v91, 149504
    s_waitcnt lgkmcnt(10)
    v_mfma_f32_32x32x16_bf16 v[224:239], a[192:195], a[76:79], v[224:239]
    ds_read_b64_tr_b16 a[180:181], v29 offset:30784
    ds_read_b64_tr_b16 a[182:183], v29 offset:30864
    v_and_b32 v84, v84, v85
    v_cmp_ne_u32 vcc, 1, v84
    s_nop 0
    s_and_b32 s58, vcc_lo, 0xffffffff
    s_and_b32 s59, vcc_hi, 0xffffffff
    s_or_b32 s58, s58, s59
    s_cbranch_scc1 L_slow_kq
L_back_kq:
    s_add_u32 m0, s92, 0
    s_nop 0
    buffer_load_dwordx4 v18, s[12:15], s67 offen offset:3072 sc1 lds
    v_cmp_gt_u32 s[50:51], 2, v88
    v_mfma_f32_32x32x16_bf16 v[240:255], a[196:199], a[76:79], v[240:255]
    ds_read_b64_tr_b16 a[184:185], v30 offset:30720
    ds_read_b64_tr_b16 a[186:187], v30 offset:30800
    v_add_u32 v21, 151552, v90
    s_waitcnt lgkmcnt(10)
    v_mfma_f32_32x32x16_bf16 v[208:223], a[160:163], a[80:83], v[208:223]
    ds_read_b64_tr_b16 a[188:189], v30 offset:30752
    ds_read_b64_tr_b16 a[190:191], v30 offset:30832
    s_add_u32 m0, s92, 4096
    s_nop 0
    buffer_load_dwordx4 v19, s[12:15], s67 offen offset:0 sc1 lds
    v_add_u32 v22, 153568, v90
    v_mfma_f32_32x32x16_bf16 v[224:239], a[164:167], a[80:83], v[224:239]
    ds_read_b64_tr_b16 a[192:193], v30 offset:30784
    ds_read_b64_tr_b16 a[194:195], v30 offset:30864
    v_add_u32 v23, 153088, v90
    s_waitcnt lgkmcnt(10)
    v_mfma_f32_32x32x16_bf16 v[240:255], a[168:171], a[80:83], v[240:255]
    ds_read_b64_tr_b16 a[196:197], v31 offset:30720
    ds_read_b64_tr_b16 a[198:199], v31 offset:30800
    buffer_load_dwordx4 v19, s[12:15], s67 offen offset:1024 sc1 lds
    v_add_u32 v24, 154336, v90
    v_mfma_f32_32x32x16_bf16 v[208:223], a[172:175], a[84:87], v[208:223]
    ds_read_b64_tr_b16 a[160:161], v31 offset:30752
    ds_read_b64_tr_b16 a[162:163], v31 offset:30832
    v_cndmask_b32 v23, v91, v23, s[50:51]
    s_waitcnt lgkmcnt(10)
    v_mfma_f32_32x32x16_bf16 v[224:239], a[176:179], a[84:87], v[224:239]
    ds_read_b64_tr_b16 a[164:165], v31 offset:30784
    ds_read_b64_tr_b16 a[166:167], v31 offset:30864
    buffer_load_dwordx4 v19, s[12:15], s67 offen offset:2048 sc1 lds
    v_cndmask_b32 v24, v24, v91, s[50:51]
    v_mfma_f32_32x32x16_bf16 v[240:255], a[180:183], a[84:87], v[240:255]
    s_barrier
    ds_read_b64_tr_b16 a[168:169], v28 offset:40960
    ds_read_b64_tr_b16 a[170:171], v28 offset:41040
    v_cndmask_b32 v21, v91, v21, s[98:99]
    s_waitcnt lgkmcnt(10)
    v_mfma_f32_32x32x16_bf16 v[208:223], a[184:187], a[88:91], v[208:223]
    ds_read_b64_tr_b16 a[172:173], v28 offset:40992
    ds_read_b64_tr_b16 a[174:175], v28 offset:41072
    buffer_load_dwordx4 v19, s[12:15], s67 offen offset:3072 sc1 lds
    v_cndmask_b32 v22, v91, v22, s[98:99]
    v_mfma_f32_32x32x16_bf16 v[224:239], a[188:191], a[88:91], v[224:239]
    ds_read_b64_tr_b16 a[176:177], v28 offset:41024
    ds_read_b64_tr_b16 a[178:179], v28 offset:41104
    v_cndmask_b32 v23, v91, v23, s[98:99]
    s_waitcnt lgkmcnt(10)
    v_mfma_f32_32x32x16_bf16 v[240:255], a[192:195], a[88:91], v[240:255]
    ds_read_b64_tr_b16 a[180:181], v29 offset:40960
    ds_read_b64_tr_b16 a[182:183], v29 offset:41040
    s_add_u32 m0, s92, 8192
    s_nop 0
    buffer_load_dwordx4 v2, s[12:15], s68 offen offset:0 sc1 lds
    v_cndmask_b32 v24, v91, v24, s[98:99]
    s_lshl_b32 s48, s28, 9
    s_add_u32 s48, s48, 151552
    v_mfma_f32_32x32x16_bf16 v[208:223], a[196:199], a[92:95], v[208:223]
    ds_read_b64_tr_b16 a[184:185], v29 offset:40992
    ds_read_b64_tr_b16 a[186:187], v29 offset:41072
    v_lshl_add_u32 v25, v1, 3, s48
    s_waitcnt lgkmcnt(10)
    v_mfma_f32_32x32x16_bf16 v[224:239], a[160:163], a[92:95], v[224:239]
    ds_read_b64_tr_b16 a[188:189], v29 offset:41024
    ds_read_b64_tr_b16 a[190:191], v29 offset:41104
    buffer_load_dwordx4 v2, s[12:15], s68 offen offset:1024 sc1 lds
    v_mfma_f32_32x32x16_bf16 v[240:255], a[164:167], a[92:95], v[240:255]
    ds_read_b64_tr_b16 a[192:193], v30 offset:40960
    ds_read_b64_tr_b16 a[194:195], v30 offset:41040
    s_waitcnt lgkmcnt(10)
    v_mfma_f32_32x32x16_bf16 v[208:223], a[168:171], a[96:99], v[208:223]
    ds_read_b64_tr_b16 a[196:197], v30 offset:40992
    ds_read_b64_tr_b16 a[198:199], v30 offset:41072
    buffer_load_dwordx4 v2, s[12:15], s68 offen offset:2048 sc1 lds
    v_mfma_f32_32x32x16_bf16 v[224:239], a[172:175], a[96:99], v[224:239]
    ds_read_b64_tr_b16 a[160:161], v30 offset:41024
    ds_read_b64_tr_b16 a[162:163], v30 offset:41104
    s_waitcnt lgkmcnt(10)
    v_mfma_f32_32x32x16_bf16 v[240:255], a[176:179], a[96:99], v[240:255]
    ds_read_b64_tr_b16 a[164:165], v31 offset:40960
    ds_read_b64_tr_b16 a[166:167], v31 offset:41040
    buffer_load_dwordx4 v2, s[12:15], s68 offen offset:3072 sc1 lds
    v_mfma_f32_32x32x16_bf16 v[208:223], a[180:183], a[100:103], v[208:223]
    ds_read_b64_tr_b16 a[168:169], v31 offset:40992
    ds_read_b64_tr_b16 a[170:171], v31 offset:41072
    s_waitcnt lgkmcnt(10)
    v_mfma_f32_32x32x16_bf16 v[224:239], a[184:187], a[100:103], v[224:239]
    ds_read_b64_tr_b16 a[172:173], v31 offset:41024
    ds_read_b64_tr_b16 a[174:175], v31 offset:41104
    s_add_u32 m0, s92, 12288
    s_nop 0
    buffer_load_dwordx4 v16, s[12:15], s68 offen offset:0 sc1 lds
    v_mfma_f32_32x32x16_bf16 v[240:255], a[188:191], a[100:103], v[240:255]
    ds_read_b64_tr_b16 a[176:177], v28 offset:51200
    ds_read_b64_tr_b16 a[178:179], v28 offset:51280
    s_waitcnt lgkmcnt(10)
    v_mfma_f32_32x32x16_bf16 v[208:223], a[192:195], a[104:107], v[208:223]
    ds_read_b64_tr_b16 a[180:181], v28 offset:51232
    ds_read_b64_tr_b16 a[182:183], v28 offset:51312
    buffer_load_dwordx4 a[0:3], v2, s[12:15], s66 offen offset:0 sc1
    v_mfma_f32_32x32x16_bf16 v[224:239], a[196:199], a[104:107], v[224:239]
    ds_read_b64_tr_b16 a[184:185], v28 offset:51264
    ds_read_b64_tr_b16 a[186:187], v28 offset:51344
    s_waitcnt lgkmcnt(10)
    v_mfma_f32_32x32x16_bf16 v[240:255], a[160:163], a[104:107], v[240:255]
    ds_read_b64_tr_b16 a[188:189], v29 offset:51200
    ds_read_b64_tr_b16 a[190:191], v29 offset:51280
    buffer_load_dwordx4 a[4:7], v2, s[12:15], s66 offen offset:1024 sc1
    v_mfma_f32_32x32x16_bf16 v[208:223], a[164:167], a[108:111], v[208:223]
    ds_read_b64_tr_b16 a[192:193], v29 offset:51232
    ds_read_b64_tr_b16 a[194:195], v29 offset:51312
    s_waitcnt lgkmcnt(10)
    v_mfma_f32_32x32x16_bf16 v[224:239], a[168:171], a[108:111], v[224:239]
    ds_read_b64_tr_b16 a[196:197], v29 offset:51264
    ds_read_b64_tr_b16 a[198:199], v29 offset:51344
    buffer_load_dwordx4 a[8:11], v2, s[12:15], s66 offen offset:2048 sc1
    v_mfma_f32_32x32x16_bf16 v[240:255], a[172:175], a[108:111], v[240:255]
    ds_read_b64_tr_b16 a[160:161], v30 offset:51200
    ds_read_b64_tr_b16 a[162:163], v30 offset:51280
    s_waitcnt lgkmcnt(10)
    v_mfma_f32_32x32x16_bf16 v[208:223], a[176:179], a[112:115], v[208:223]
    ds_read_b64_tr_b16 a[164:165], v30 offset:51232
    ds_read_b64_tr_b16 a[166:167], v30 offset:51312
    buffer_load_dwordx4 a[12:15], v2, s[12:15], s66 offen offset:3072 sc1
    v_mfma_f32_32x32x16_bf16 v[224:239], a[180:183], a[112:115], v[224:239]
    ds_read_b64_tr_b16 a[168:169], v30 offset:51264
    ds_read_b64_tr_b16 a[170:171], v30 offset:51344
    s_waitcnt lgkmcnt(10)
    v_mfma_f32_32x32x16_bf16 v[240:255], a[184:187], a[112:115], v[240:255]
    ds_read_b64_tr_b16 a[172:173], v31 offset:51200
    ds_read_b64_tr_b16 a[174:175], v31 offset:51280
    buffer_load_dwordx4 a[16:19], v16, s[12:15], s66 offen offset:0 sc1
    v_mfma_f32_32x32x16_bf16 v[208:223], a[188:191], a[116:119], v[208:223]
    ds_read_b64_tr_b16 a[176:177], v31 offset:51232
    ds_read_b64_tr_b16 a[178:179], v31 offset:51312
    s_waitcnt lgkmcnt(10)
    v_mfma_f32_32x32x16_bf16 v[224:239], a[192:195], a[116:119], v[224:239]
    ds_read_b64_tr_b16 a[180:181], v31 offset:51264
    ds_read_b64_tr_b16 a[182:183], v31 offset:51344
    buffer_load_dwordx4 a[20:23], v16, s[12:15], s66 offen offset:1024 sc1
    v_mfma_f32_32x32x16_bf16 v[240:255], a[196:199], a[116:119], v[240:255]
    s_waitcnt vmcnt(43)
    s_barrier
    ds_read_b64_tr_b16 a[184:185], v28 offset:0
    ds_read_b64_tr_b16 a[186:187], v28 offset:80
    s_waitcnt lgkmcnt(10)
    v_mfma_f32_32x32x16_bf16 v[208:223], a[160:163], a[120:123], v[208:223]
    ds_read_b64_tr_b16 a[188:189], v28 offset:32
    ds_read_b64_tr_b16 a[190:191], v28 offset:112
    buffer_load_dwordx4 a[24:27], v16, s[12:15], s66 offen offset:2048 sc1
    v_mfma_f32_32x32x16_bf16 v[224:239], a[164:167], a[120:123], v[224:239]
    ds_read_b64_tr_b16 a[192:193], v28 offset:64
    ds_read_b64_tr_b16 a[194:195], v28 offset:144
    s_waitcnt lgkmcnt(10)
    v_mfma_f32_32x32x16_bf16 v[240:255], a[168:171], a[120:123], v[240:255]
    ds_read_b64_tr_b16 a[196:197], v29 offset:0
    ds_read_b64_tr_b16 a[198:199], v29 offset:80
    buffer_load_dwordx4 a[28:31], v16, s[12:15], s66 offen offset:3072 sc1
    v_mfma_f32_32x32x16_bf16 v[208:223], a[172:175], a[124:127], v[208:223]
    ds_read_b64_tr_b16 a[160:161], v29 offset:32
    ds_read_b64_tr_b16 a[162:163], v29 offset:112
    s_waitcnt lgkmcnt(10)
    v_mfma_f32_32x32x16_bf16 v[224:239], a[176:179], a[124:127], v[224:239]
    ds_read_b64_tr_b16 a[164:165], v29 offset:64
    ds_read_b64_tr_b16 a[166:167], v29 offset:144
    buffer_load_dwordx4 a[32:35], v17, s[12:15], s66 offen offset:0 sc1
    v_mfma_f32_32x32x16_bf16 v[240:255], a[180:183], a[124:127], v[240:255]
    ds_read_b64_tr_b16 a[168:169], v30 offset:0
    ds_read_b64_tr_b16 a[170:171], v30 offset:80
    s_waitcnt lgkmcnt(10)
    v_mfma_f32_32x32x16_bf16 v[208:223], a[184:187], a[128:131], v[208:223]
    ds_read_b64_tr_b16 a[172:173], v30 offset:32
    ds_read_b64_tr_b16 a[174:175], v30 offset:112
    buffer_load_dwordx4 a[36:39], v17, s[12:15], s66 offen offset:1024 sc1
    v_mfma_f32_32x32x16_bf16 v[224:239], a[188:191], a[128:131], v[224:239]
    ds_read_b64_tr_b16 a[176:177], v30 offset:64
    ds_read_b64_tr_b16 a[178:179], v30 offset:144
    s_waitcnt lgkmcnt(10)
    v_mfma_f32_32x32x16_bf16 v[240:255], a[192:195], a[128:131], v[240:255]
    ds_read_b64_tr_b16 a[180:181], v31 offset:0
    ds_read_b64_tr_b16 a[182:183], v31 offset:80
    buffer_load_dwordx4 a[40:43], v17, s[12:15], s66 offen offset:2048 sc1
    v_mfma_f32_32x32x16_bf16 v[208:223], a[196:199], a[132:135], v[208:223]
    ds_read_b64_tr_b16 a[184:185], v31 offset:32
    ds_read_b64_tr_b16 a[186:187], v31 offset:112
    s_waitcnt lgkmcnt(10)
    v_mfma_f32_32x32x16_bf16 v[224:239], a[160:163], a[132:135], v[224:239]
    ds_read_b64_tr_b16 a[188:189], v31 offset:64
    ds_read_b64_tr_b16 a[190:191], v31 offset:144
    buffer_load_dwordx4 a[44:47], v17, s[12:15], s66 offen offset:3072 sc1
    v_mfma_f32_32x32x16_bf16 v[240:255], a[164:167], a[132:135], v[240:255]
    ds_read_b64_tr_b16 a[192:193], v28 offset:10240
    ds_read_b64_tr_b16 a[194:195], v28 offset:10320
    s_waitcnt lgkmcnt(10)
    v_mfma_f32_32x32x16_bf16 v[208:223], a[168:171], a[136:139], v[208:223]
    ds_read_b64_tr_b16 a[196:197], v28 offset:10272
    ds_read_b64_tr_b16 a[198:199], v28 offset:10352
    buffer_load_dwordx4 a[48:51], v18, s[12:15], s66 offen offset:0 sc1
    v_mfma_f32_32x32x16_bf16 v[224:239], a[172:175], a[136:139], v[224:239]
    ds_read_b64_tr_b16 a[160:161], v28 offset:10304
    ds_read_b64_tr_b16 a[162:163], v28 offset:10384
    s_waitcnt lgkmcnt(10)
    v_mfma_f32_32x32x16_bf16 v[240:255], a[176:179], a[136:139], v[240:255]
    ds_read_b64_tr_b16 a[164:165], v29 offset:10240
    ds_read_b64_tr_b16 a[166:167], v29 offset:10320
    buffer_load_dwordx4 a[52:55], v18, s[12:15], s66 offen offset:1024 sc1
    v_mfma_f32_32x32x16_bf16 v[208:223], a[180:183], a[140:143], v[208:223]
    ds_read_b64_tr_b16 a[168:169], v29 offset:10272
    ds_read_b64_tr_b16 a[170:171], v29 offset:10352
    s_waitcnt lgkmcnt(10)
    v_mfma_f32_32x32x16_bf16 v[224:239], a[184:187], a[140:143], v[224:239]
    ds_read_b64_tr_b16 a[172:173], v29 offset:10304
    ds_read_b64_tr_b16 a[174:175], v29 offset:10384
    buffer_load_dwordx4 a[56:59], v18, s[12:15], s66 offen offset:2048 sc1
    v_mfma_f32_32x32x16_bf16 v[240:255], a[188:191], a[140:143], v[240:255]
    ds_read_b64_tr_b16 a[176:177], v30 offset:10240
    ds_read_b64_tr_b16 a[178:179], v30 offset:10320
    s_waitcnt lgkmcnt(10)
    v_mfma_f32_32x32x16_bf16 v[208:223], a[192:195], a[144:147], v[208:223]
    ds_read_b64_tr_b16 a[180:181], v30 offset:10272
    ds_read_b64_tr_b16 a[182:183], v30 offset:10352
    buffer_load_dwordx4 a[60:63], v18, s[12:15], s66 offen offset:3072 sc1
    s_waitcnt vmcnt(48)
    v_cvt_pk_bf16_f32 v73, v80, v80
    v_lshlrev_b32 v75, 16, v73
    v_sub_f32 v74, v80, v75
    v_mfma_f32_32x32x16_bf16 v[224:239], a[196:199], a[144:147], v[224:239]
    ds_read_b64_tr_b16 a[184:185], v30 offset:10304
    ds_read_b64_tr_b16 a[186:187], v30 offset:10384
    v_mov_b32 v48, v73
    v_cvt_pk_bf16_f32 v49, v80, v74
    v_and_b32 v75, 0xffff0000, v49
    s_waitcnt lgkmcnt(10)
    v_mfma_f32_32x32x16_bf16 v[240:255], a[160:163], a[144:147], v[240:255]
    ds_read_b64_tr_b16 a[188:189], v31 offset:10240
    ds_read_b64_tr_b16 a[190:191], v31 offset:10320
    buffer_load_dwordx4 a[64:67], v19, s[12:15], s66 offen offset:0 sc1
    v_sub_f32 v75, v74, v75
    v_cvt_pk_bf16_f32 v50, v74, v75
    v_mov_b32 v51, 0
    v_mfma_f32_32x32x16_bf16 v[208:223], a[164:167], a[148:151], v[208:223]
    ds_read_b64_tr_b16 a[192:193], v31 offset:10272
    ds_read_b64_tr_b16 a[194:195], v31 offset:10352
    s_waitcnt vmcnt(48)
    v_cvt_pk_bf16_f32 v73, v81, v81
    v_lshlrev_b32 v75, 16, v73
    v_sub_f32 v74, v81, v75
    s_waitcnt lgkmcnt(10)
    v_mfma_f32_32x32x16_bf16 v[224:239], a[168:171], a[148:151], v[224:239]
    ds_read_b64_tr_b16 a[196:197], v31 offset:10304
    ds_read_b64_tr_b16 a[198:199], v31 offset:10384
    buffer_load_dwordx4 a[68:71], v19, s[12:15], s66 offen offset:1024 sc1
    v_mov_b32 v52, v73
    v_cvt_pk_bf16_f32 v53, v81, v74
    v_and_b32 v75, 0xffff0000, v53
    v_mfma_f32_32x32x16_bf16 v[240:255], a[172:175], a[148:151], v[240:255]
    v_sub_f32 v75, v74, v75
    v_cvt_pk_bf16_f32 v54, v74, v75
    v_mov_b32 v55, 0
    s_waitcnt lgkmcnt(8)
    v_mfma_f32_32x32x16_bf16 v[208:223], a[176:179], a[152:155], v[208:223]
    buffer_load_dwordx4 a[72:75], v19, s[12:15], s66 offen offset:2048 sc1
    s_waitcnt vmcnt(49)
    v_cvt_pk_bf16_f32 v73, v82, v82
    v_lshlrev_b32 v75, 16, v73
    v_sub_f32 v74, v82, v75
    v_mfma_f32_32x32x16_bf16 v[224:239], a[180:183], a[152:155], v[224:239]
    v_mov_b32 v56, v73
    v_cvt_pk_bf16_f32 v57, v82, v74
    v_and_b32 v75, 0xffff0000, v57
    s_waitcnt lgkmcnt(4)
    v_mfma_f32_32x32x16_bf16 v[240:255], a[184:187], a[152:155], v[240:255]
    buffer_load_dwordx4 a[76:79], v19, s[12:15], s66 offen offset:3072 sc1
    v_sub_f32 v75, v74, v75
    v_cvt_pk_bf16_f32 v58, v74, v75
    v_mov_b32 v59, 0
    v_mfma_f32_32x32x16_bf16 v[208:223], a[188:191], a[156:159], v[208:223]
    v_mfma_f32_32x32x16_bf16 v[208:223], v[48:51], v[40:43], v[208:223]
    v_mfma_f32_32x32x16_bf16 v[224:239], v[52:55], v[40:43], v[224:239]
    v_mfma_f32_32x32x16_bf16 v[240:255], v[56:59], v[40:43], v[240:255]
    s_waitcnt lgkmcnt(0)
    v_mfma_f32_32x32x16_bf16 v[224:239], a[192:195], a[156:159], v[224:239]
    v_mfma_f32_32x32x16_bf16 v[240:255], a[196:199], a[156:159], v[240:255]
    s_waitcnt vmcnt(30)
    s_barrier
    buffer_store_dword a255, v15, s[12:15], s100 offen offset:0 sc1
    s_nop 3
    v_cvt_pk_bf16_f32 v48, v208, v209
    buffer_load_dwordx4 a[80:83], v2, s[12:15], s67 offen offset:0 sc1
    v_cvt_pk_bf16_f32 v49, v210, v211
    v_cvt_pk_bf16_f32 v50, v212, v213
    v_cvt_pk_bf16_f32 v51, v214, v215
    v_cvt_pk_bf16_f32 v52, v216, v217
    v_cvt_pk_bf16_f32 v53, v218, v219
    v_cvt_pk_bf16_f32 v54, v220, v221
    v_cvt_pk_bf16_f32 v55, v222, v223
    v_cvt_pk_bf16_f32 v56, v224, v225
    v_cvt_pk_bf16_f32 v57, v226, v227
    v_cvt_pk_bf16_f32 v58, v228, v229
    v_cvt_pk_bf16_f32 v59, v230, v231
    v_cvt_pk_bf16_f32 v60, v232, v233
    v_cvt_pk_bf16_f32 v61, v234, v235
    v_cvt_pk_bf16_f32 v62, v236, v237
    v_cvt_pk_bf16_f32 v63, v238, v239
    v_cvt_pk_bf16_f32 v64, v240, v241
    buffer_load_dwordx4 a[84:87], v2, s[12:15], s67 offen offset:1024 sc1
    v_cvt_pk_bf16_f32 v65, v242, v243
    v_cvt_pk_bf16_f32 v66, v244, v245
    v_cvt_pk_bf16_f32 v67, v246, v247
    v_mfma_f32_32x32x16_bf16 v[128:143], a[200:203], v[48:51], 0
    v_mfma_f32_32x32x16_bf16 v[128:143], a[204:207], v[52:55], v[128:143]
    v_mfma_f32_32x32x16_bf16 v[128:143], a[208:211], v[56:59], v[128:143]
    buffer_load_dwordx4 a[88:91], v2, s[12:15], s67 offen offset:2048 sc1
    v_mfma_f32_32x32x16_bf16 v[144:159], a[212:215], v[48:51], 0
    v_mfma_f32_32x32x16_bf16 v[144:159], a[216:219], v[52:55], v[144:159]
    v_mfma_f32_32x32x16_bf16 v[144:159], a[220:223], v[56:59], v[144:159]
    buffer_load_dwordx4 a[92:95], v2, s[12:15], s67 offen offset:3072 sc1
    v_mfma_f32_32x32x16_bf16 v[144:159], a[224:227], v[60:63], v[144:159]
    v_mfma_f32_32x32x16_bf16 v[144:159], a[228:231], v[64:67], v[144:159]
    v_mfma_f32_32x32x16_bf16 v[160:175], a[232:235], v[56:59], 0
    buffer_load_dwordx4 a[96:99], v16, s[12:15], s67 offen offset:0 sc1
    v_mfma_f32_32x32x16_bf16 v[160:175], a[236:239], v[60:63], v[160:175]
    v_mfma_f32_32x32x16_bf16 v[160:175], a[240:243], v[64:67], v[160:175]
    s_nop 0
    v_max3_f32 v108, v128, v129, v130
    v_min3_f32 v109, v128, v129, v130
    v_max3_f32 v108, v108, v131, v132
    v_min3_f32 v109, v109, v131, v132
    buffer_load_dwordx4 a[100:103], v17, s[12:15], s69 offen offset:2048 sc1
    v_max3_f32 v108, v108, v133, v134
    v_min3_f32 v109, v109, v133, v134
    v_max3_f32 v108, v108, v135, v136
    v_min3_f32 v109, v109, v135, v136
    v_max3_f32 v108, v108, v137, v138
    v_min3_f32 v109, v109, v137, v138
    v_max3_f32 v108, v108, v139, v140
    v_min3_f32 v109, v109, v139, v140
    v_max3_f32 v108, v108, v141, v142
    v_min3_f32 v109, v109, v141, v142
    v_max3_f32 v108, v108, v143, v144
    v_min3_f32 v109, v109, v143, v144
    v_max3_f32 v108, v108, v145, v146
    v_min3_f32 v109, v109, v145, v146
    v_max_f32 v108, v108, v147
    v_min_f32 v109, v109, v147
    buffer_load_dwordx4 a[104:107], v17, s[12:15], s69 offen offset:3072 sc1
    v_mul_f32 v108, v108, v44
    v_mul_f32 v109, v109, v44
    v_pk_fma_f32 v[68:69], v[128:129], v[44:45], v[108:109] op_sel:[0,0,0] op_sel_hi:[1,0,0] neg_lo:[0,0,1] neg_hi:[0,0,1]
    v_pk_fma_f32 v[70:71], v[130:131], v[44:45], v[108:109] op_sel:[0,0,0] op_sel_hi:[1,0,0] neg_lo:[0,0,1] neg_hi:[0,0,1]
    v_pk_fma_f32 v[72:73], v[132:133], v[44:45], v[108:109] op_sel:[0,0,0] op_sel_hi:[1,0,0] neg_lo:[0,0,1] neg_hi:[0,0,1]
    v_pk_fma_f32 v[74:75], v[134:135], v[44:45], v[108:109] op_sel:[0,0,0] op_sel_hi:[1,0,0] neg_lo:[0,0,1] neg_hi:[0,0,1]
    v_pk_fma_f32 v[76:77], v[136:137], v[44:45], v[108:109] op_sel:[0,0,0] op_sel_hi:[1,0,0] neg_lo:[0,0,1] neg_hi:[0,0,1]
    v_pk_fma_f32 v[78:79], v[138:139], v[44:45], v[108:109] op_sel:[0,0,0] op_sel_hi:[1,0,0] neg_lo:[0,0,1] neg_hi:[0,0,1]
    v_pk_fma_f32 v[80:81], v[140:141], v[44:45], v[108:109] op_sel:[0,0,0] op_sel_hi:[1,0,0] neg_lo:[0,0,1] neg_hi:[0,0,1]
    v_pk_fma_f32 v[82:83], v[142:143], v[44:45], v[108:109] op_sel:[0,0,0] op_sel_hi:[1,0,0] neg_lo:[0,0,1] neg_hi:[0,0,1]
    v_pk_fma_f32 v[84:85], v[144:145], v[44:45], v[108:109] op_sel:[0,0,0] op_sel_hi:[1,0,0] neg_lo:[0,0,1] neg_hi:[0,0,1]
    v_pk_fma_f32 v[86:87], v[146:147], v[44:45], v[108:109] op_sel:[0,0,0] op_sel_hi:[1,0,0] neg_lo:[0,0,1] neg_hi:[0,0,1]
    v_pk_fma_f32 v[88:89], v[128:129], v[44:45], v[108:109] op_sel:[0,0,1] op_sel_hi:[1,0,1] neg_lo:[1,0,0] neg_hi:[1,0,0]
    v_pk_fma_f32 v[90:91], v[130:131], v[44:45], v[108:109] op_sel:[0,0,1] op_sel_hi:[1,0,1] neg_lo:[1,0,0] neg_hi:[1,0,0]
    v_pk_fma_f32 v[92:93], v[132:133], v[44:45], v[108:109] op_sel:[0,0,1] op_sel_hi:[1,0,1] neg_lo:[1,0,0] neg_hi:[1,0,0]
    v_pk_fma_f32 v[94:95], v[134:135], v[44:45], v[108:109] op_sel:[0,0,1] op_sel_hi:[1,0,1] neg_lo:[1,0,0] neg_hi:[1,0,0]
    buffer_load_dwordx4 a[108:111], v18, s[12:15], s69 offen offset:0 sc1
    v_pk_fma_f32 v[96:97], v[136:137], v[44:45], v[108:109] op_sel:[0,0,1] op_sel_hi:[1,0,1] neg_lo:[1,0,0] neg_hi:[1,0,0]
    v_pk_fma_f32 v[98:99], v[138:139], v[44:45], v[108:109] op_sel:[0,0,1] op_sel_hi:[1,0,1] neg_lo:[1,0,0] neg_hi:[1,0,0]
    v_pk_fma_f32 v[100:101], v[140:141], v[44:45], v[108:109] op_sel:[0,0,1] op_sel_hi:[1,0,1] neg_lo:[1,0,0] neg_hi:[1,0,0]
    v_pk_fma_f32 v[102:103], v[142:143], v[44:45], v[108:109] op_sel:[0,0,1] op_sel_hi:[1,0,1] neg_lo:[1,0,0] neg_hi:[1,0,0]
    v_pk_fma_f32 v[104:105], v[144:145], v[44:45], v[108:109] op_sel:[0,0,1] op_sel_hi:[1,0,1] neg_lo:[1,0,0] neg_hi:[1,0,0]
    v_pk_fma_f32 v[106:107], v[146:147], v[44:45], v[108:109] op_sel:[0,0,1] op_sel_hi:[1,0,1] neg_lo:[1,0,0] neg_hi:[1,0,0]
    v_exp_f32 v68, v68
    v_exp_f32 v69, v69
    v_exp_f32 v70, v70
    v_exp_f32 v71, v71
    v_exp_f32 v72, v72
    v_exp_f32 v73, v73
    v_exp_f32 v74, v74
    buffer_load_dwordx4 a[112:115], v18, s[12:15], s69 offen offset:1024 sc1
    v_exp_f32 v75, v75
    v_exp_f32 v76, v76
    v_exp_f32 v77, v77
    v_exp_f32 v78, v78
    v_exp_f32 v79, v79
    v_exp_f32 v80, v80
    v_exp_f32 v81, v81
    v_exp_f32 v82, v82
    v_exp_f32 v83, v83
    v_exp_f32 v84, v84
    buffer_load_dwordx4 a[116:119], v18, s[12:15], s69 offen offset:2048 sc1
    v_exp_f32 v85, v85
    v_exp_f32 v86, v86
    v_exp_f32 v87, v87
    v_exp_f32 v88, v88
    v_exp_f32 v89, v89
    v_exp_f32 v90, v90
    v_exp_f32 v91, v91
    v_exp_f32 v92, v92
    v_exp_f32 v93, v93
    v_exp_f32 v94, v94
    buffer_load_dwordx4 a[120:123], v18, s[12:15], s69 offen offset:3072 sc1
    v_exp_f32 v95, v95
    v_exp_f32 v96, v96
    v_exp_f32 v97, v97
    v_exp_f32 v98, v98
    v_exp_f32 v99, v99
    v_exp_f32 v100, v100
    v_exp_f32 v101, v101
    v_exp_f32 v102, v102
    v_exp_f32 v103, v103
    v_exp_f32 v104, v104
    buffer_load_dwordx4 a[124:127], v19, s[12:15], s69 offen offset:0 sc1
    v_exp_f32 v105, v105
    v_exp_f32 v106, v106
    v_exp_f32 v107, v107
    v_pk_add_f32 v[128:129], v[68:69], v[70:71]
    v_pk_add_f32 v[130:131], v[72:73], v[74:75]
    v_pk_add_f32 v[132:133], v[76:77], v[78:79]
    v_pk_add_f32 v[134:135], v[80:81], v[82:83]
    v_pk_add_f32 v[136:137], v[84:85], v[86:87]
    v_pk_add_f32 v[138:139], v[88:89], v[90:91]
    v_pk_add_f32 v[140:141], v[92:93], v[94:95]
    v_pk_add_f32 v[142:143], v[96:97], v[98:99]
    v_pk_add_f32 v[144:145], v[100:101], v[102:103]
    v_pk_add_f32 v[146:147], v[104:105], v[106:107]
    v_pk_add_f32 v[128:129], v[128:129], v[130:131]
    v_pk_add_f32 v[132:133], v[132:133], v[134:135]
    buffer_load_dwordx4 a[128:131], v19, s[12:15], s69 offen offset:1024 sc1
    v_pk_add_f32 v[138:139], v[138:139], v[140:141]
    v_pk_add_f32 v[142:143], v[142:143], v[144:145]
    v_pk_add_f32 v[128:129], v[128:129], v[132:133]
    v_pk_add_f32 v[138:139], v[138:139], v[142:143]
    v_pk_add_f32 v[128:129], v[128:129], v[136:137]
    v_pk_add_f32 v[138:139], v[138:139], v[146:147]
    v_add_f32 v112, v128, v129
    v_add_f32 v113, v138, v139
    v_rcp_f32 v110, v113
    s_nop 0
    v_mul_f32 v110, v110, v112
    v_pk_mul_f32 v[88:89], v[88:89], v[110:111] op_sel_hi:[1,0]
    v_pk_mul_f32 v[90:91], v[90:91], v[110:111] op_sel_hi:[1,0]
    v_pk_mul_f32 v[92:93], v[92:93], v[110:111] op_sel_hi:[1,0]
    v_pk_mul_f32 v[94:95], v[94:95], v[110:111] op_sel_hi:[1,0]
    v_pk_mul_f32 v[96:97], v[96:97], v[110:111] op_sel_hi:[1,0]
    v_pk_mul_f32 v[98:99], v[98:99], v[110:111] op_sel_hi:[1,0]
    buffer_load_dwordx4 a[132:135], v19, s[12:15], s69 offen offset:2048 sc1
    v_pk_mul_f32 v[100:101], v[100:101], v[110:111] op_sel_hi:[1,0]
    v_pk_mul_f32 v[102:103], v[102:103], v[110:111] op_sel_hi:[1,0]
    v_pk_mul_f32 v[104:105], v[104:105], v[110:111] op_sel_hi:[1,0]
    v_pk_mul_f32 v[106:107], v[106:107], v[110:111] op_sel_hi:[1,0]
    v_cvt_pk_bf16_f32 v208, v68, v69
    v_cvt_pk_bf16_f32 v209, v70, v71
    v_cvt_pk_bf16_f32 v210, v72, v73
    v_cvt_pk_bf16_f32 v211, v74, v75
    v_cvt_pk_bf16_f32 v212, v76, v77
    v_cvt_pk_bf16_f32 v213, v78, v79
    v_cvt_pk_bf16_f32 v214, v80, v81
    v_cvt_pk_bf16_f32 v215, v82, v83
    v_cvt_pk_bf16_f32 v216, v84, v85
    v_cvt_pk_bf16_f32 v217, v86, v87
    v_cvt_pk_bf16_f32 v218, v88, v89
    v_cvt_pk_bf16_f32 v219, v90, v91
    buffer_load_dwordx4 a[136:139], v19, s[12:15], s69 offen offset:3072 sc1
    v_cvt_pk_bf16_f32 v220, v92, v93
    v_cvt_pk_bf16_f32 v221, v94, v95
    v_cvt_pk_bf16_f32 v222, v96, v97
    v_cvt_pk_bf16_f32 v223, v98, v99
    v_cvt_pk_bf16_f32 v224, v100, v101
    v_cvt_pk_bf16_f32 v225, v102, v103
    v_cvt_pk_bf16_f32 v226, v104, v105
    v_cvt_pk_bf16_f32 v227, v106, v107
    v_mul_f32 v120, 0x358637bd, v112
    buffer_load_dwordx4 a[140:143], v13, s[12:15], s69 offen offset:0 sc1
    buffer_load_dwordx4 a[144:147], v13, s[12:15], s69 offen offset:1024 sc1
    buffer_load_dwordx4 a[148:151], v13, s[12:15], s69 offen offset:2048 sc1
    buffer_load_dwordx4 a[152:155], v13, s[12:15], s69 offen offset:3072 sc1
    buffer_load_dwordx4 a[156:159], v14, s[12:15], s69 offen offset:0 sc1
    buffer_load_dword v7, v6, s[12:15], s57 offen offset:0 sc1
    buffer_load_dword v127, v126, s[12:15], s79 offen sc1
    s_waitcnt vmcnt(1)
    v_cmp_ne_u32 vcc, 1, v7
    s_nop 0
    s_and_b32 s58, vcc_lo, 0xff
    s_cbranch_scc1 L_slow_p0q
L_back_p0q:
    s_waitcnt vmcnt(0)
    v_cmp_ne_u32 vcc, 1, v127
    s_nop 0
    s_and_b32 s58, vcc_lo, 0xffff
    s_cbranch_scc1 L_slow_kv
L_back_kv:
    s_lshl_b32 s60, s30, 14
    s_add_u32 s60, s60, 12288
    s_lshl_b32 s58, s28, 10
    s_add_u32 s60, s60, s58
    buffer_load_dwordx4 v[176:179], v2, s[12:15], s60 offen sc1
    s_add_u32 s60, s60, 4096
    buffer_load_dwordx4 v[180:183], v2, s[12:15], s60 offen sc1
    s_add_u32 s60, s60, 4096
    buffer_load_dwordx4 v[184:187], v2, s[12:15], s60 offen sc1
    s_add_u32 s60, s60, 4096
    buffer_load_dwordx4 v[188:191], v2, s[12:15], s60 offen sc1
    v_max3_f32 v108, v148, v149, v150
    s_add_u32 s46, s44, 0
    buffer_load_dwordx4 a[160:163], v3, s[12:15], s46 offen offset:0 sc1
    v_min3_f32 v109, v148, v149, v150
    v_max3_f32 v108, v108, v151, v152
    v_min3_f32 v109, v109, v151, v152
    v_max3_f32 v108, v108, v153, v154
    v_min3_f32 v109, v109, v153, v154
    v_max3_f32 v108, v108, v155, v156
    v_min3_f32 v109, v109, v155, v156
    v_max3_f32 v108, v108, v157, v158
    v_min3_f32 v109, v109, v157, v158
    v_max3_f32 v108, v108, v159, v160
    v_min3_f32 v109, v109, v159, v160
    buffer_load_dwordx4 a[164:167], v4, s[12:15], s46 offen offset:0 sc1
    v_max3_f32 v108, v108, v161, v162
    v_min3_f32 v109, v109, v161, v162
    v_max3_f32 v108, v108, v163, v164
    v_min3_f32 v109, v109, v163, v164
    v_max3_f32 v108, v108, v165, v166
    v_min3_f32 v109, v109, v165, v166
    v_max_f32 v108, v108, v167
    v_min_f32 v109, v109, v167
    v_mul_f32 v108, v108, v44
    v_mul_f32 v109, v109, v44
    v_pk_fma_f32 v[68:69], v[148:149], v[44:45], v[108:109] op_sel:[0,0,0] op_sel_hi:[1,0,0] neg_lo:[0,0,1] neg_hi:[0,0,1]
    buffer_load_dwordx4 a[168:171], v5, s[12:15], s46 offen offset:0 sc1
    v_pk_fma_f32 v[70:71], v[150:151], v[44:45], v[108:109] op_sel:[0,0,0] op_sel_hi:[1,0,0] neg_lo:[0,0,1] neg_hi:[0,0,1]
    v_pk_fma_f32 v[72:73], v[152:153], v[44:45], v[108:109] op_sel:[0,0,0] op_sel_hi:[1,0,0] neg_lo:[0,0,1] neg_hi:[0,0,1]
    v_pk_fma_f32 v[74:75], v[154:155], v[44:45], v[108:109] op_sel:[0,0,0] op_sel_hi:[1,0,0] neg_lo:[0,0,1] neg_hi:[0,0,1]
    v_pk_fma_f32 v[76:77], v[156:157], v[44:45], v[108:109] op_sel:[0,0,0] op_sel_hi:[1,0,0] neg_lo:[0,0,1] neg_hi:[0,0,1]
    v_pk_fma_f32 v[78:79], v[158:159], v[44:45], v[108:109] op_sel:[0,0,0] op_sel_hi:[1,0,0] neg_lo:[0,0,1] neg_hi:[0,0,1]
    v_pk_fma_f32 v[80:81], v[160:161], v[44:45], v[108:109] op_sel:[0,0,0] op_sel_hi:[1,0,0] neg_lo:[0,0,1] neg_hi:[0,0,1]
    v_pk_fma_f32 v[82:83], v[162:163], v[44:45], v[108:109] op_sel:[0,0,0] op_sel_hi:[1,0,0] neg_lo:[0,0,1] neg_hi:[0,0,1]
    v_pk_fma_f32 v[84:85], v[164:165], v[44:45], v[108:109] op_sel:[0,0,0] op_sel_hi:[1,0,0] neg_lo:[0,0,1] neg_hi:[0,0,1]
    v_pk_fma_f32 v[86:87], v[166:167], v[44:45], v[108:109] op_sel:[0,0,0] op_sel_hi:[1,0,0] neg_lo:[0,0,1] neg_hi:[0,0,1]
    v_pk_fma_f32 v[88:89], v[148:149], v[44:45], v[108:109] op_sel:[0,0,1] op_sel_hi:[1,0,1] neg_lo:[1,0,0] neg_hi:[1,0,0]
    v_pk_fma_f32 v[90:91], v[150:151], v[44:45], v[108:109] op_sel:[0,0,1] op_sel_hi:[1,0,1] neg_lo:[1,0,0] neg_hi:[1,0,0]
    buffer_load_dwordx4 a[172:175], v20, s[12:15], s46 offen offset:0 sc1
    v_pk_fma_f32 v[92:93], v[152:153], v[44:45], v[108:109] op_sel:[0,0,1] op_sel_hi:[1,0,1] neg_lo:[1,0,0] neg_hi:[1,0,0]
    v_pk_fma_f32 v[94:95], v[154:155], v[44:45], v[108:109] op_sel:[0,0,1] op_sel_hi:[1,0,1] neg_lo:[1,0,0] neg_hi:[1,0,0]
    v_pk_fma_f32 v[96:97], v[156:157], v[44:45], v[108:109] op_sel:[0,0,1] op_sel_hi:[1,0,1] neg_lo:[1,0,0] neg_hi:[1,0,0]
    v_pk_fma_f32 v[98:99], v[158:159], v[44:45], v[108:109] op_sel:[0,0,1] op_sel_hi:[1,0,1] neg_lo:[1,0,0] neg_hi:[1,0,0]
    v_pk_fma_f32 v[100:101], v[160:161], v[44:45], v[108:109] op_sel:[0,0,1] op_sel_hi:[1,0,1] neg_lo:[1,0,0] neg_hi:[1,0,0]
    v_pk_fma_f32 v[102:103], v[162:163], v[44:45], v[108:109] op_sel:[0,0,1] op_sel_hi:[1,0,1] neg_lo:[1,0,0] neg_hi:[1,0,0]
    v_pk_fma_f32 v[104:105], v[164:165], v[44:45], v[108:109] op_sel:[0,0,1] op_sel_hi:[1,0,1] neg_lo:[1,0,0] neg_hi:[1,0,0]
    v_pk_fma_f32 v[106:107], v[166:167], v[44:45], v[108:109] op_sel:[0,0,1] op_sel_hi:[1,0,1] neg_lo:[1,0,0] neg_hi:[1,0,0]
    v_exp_f32 v68, v68
    v_exp_f32 v69, v69
    buffer_load_dwordx4 a[176:179], v3, s[12:15], s46 offen offset:2048 sc1
    v_exp_f32 v70, v70
    v_exp_f32 v71, v71
    v_exp_f32 v72, v72
    v_exp_f32 v73, v73
    v_exp_f32 v74, v74
    v_exp_f32 v75, v75
    v_exp_f32 v76, v76
    buffer_load_dwordx4 a[180:183], v4, s[12:15], s46 offen offset:2048 sc1
    v_exp_f32 v77, v77
    v_exp_f32 v78, v78
    v_exp_f32 v79, v79
    v_exp_f32 v80, v80
    v_exp_f32 v81, v81
    v_exp_f32 v82, v82
    v_exp_f32 v83, v83
    buffer_load_dwordx4 a[184:187], v5, s[12:15], s46 offen offset:2048 sc1
    v_exp_f32 v84, v84
    v_exp_f32 v85, v85
    v_exp_f32 v86, v86
    v_exp_f32 v87, v87
    v_exp_f32 v88, v88
    v_exp_f32 v89, v89
    v_exp_f32 v90, v90
    buffer_load_dwordx4 a[188:191], v20, s[12:15], s46 offen offset:2048 sc1
    v_exp_f32 v91, v91
    v_exp_f32 v92, v92
    v_exp_f32 v93, v93
    v_exp_f32 v94, v94
    v_exp_f32 v95, v95
    v_exp_f32 v96, v96
    v_exp_f32 v97, v97
    s_add_u32 s46, s46, 4096
    buffer_load_dwordx4 a[192:195], v3, s[12:15], s46 offen offset:0 sc1
    v_exp_f32 v98, v98
    v_exp_f32 v99, v99
    v_exp_f32 v100, v100
    v_exp_f32 v101, v101
    v_exp_f32 v102, v102
    v_exp_f32 v103, v103
    v_exp_f32 v104, v104
    buffer_load_dwordx4 a[196:199], v4, s[12:15], s46 offen offset:0 sc1
    v_exp_f32 v105, v105
    v_exp_f32 v106, v106
    v_exp_f32 v107, v107
    v_pk_add_f32 v[148:149], v[68:69], v[70:71]
    v_pk_add_f32 v[150:151], v[72:73], v[74:75]
    v_pk_add_f32 v[152:153], v[76:77], v[78:79]
    v_pk_add_f32 v[154:155], v[80:81], v[82:83]
    v_pk_add_f32 v[156:157], v[84:85], v[86:87]
    v_pk_add_f32 v[158:159], v[88:89], v[90:91]
    v_pk_add_f32 v[160:161], v[92:93], v[94:95]
    buffer_load_dwordx4 a[200:203], v5, s[12:15], s46 offen offset:0 sc1
    v_pk_add_f32 v[162:163], v[96:97], v[98:99]
    v_pk_add_f32 v[164:165], v[100:101], v[102:103]
    v_pk_add_f32 v[166:167], v[104:105], v[106:107]
    v_pk_add_f32 v[148:149], v[148:149], v[150:151]
    v_pk_add_f32 v[152:153], v[152:153], v[154:155]
    v_pk_add_f32 v[158:159], v[158:159], v[160:161]
    v_pk_add_f32 v[162:163], v[162:163], v[164:165]
    v_pk_add_f32 v[148:149], v[148:149], v[152:153]
    v_pk_add_f32 v[158:159], v[158:159], v[162:163]
    v_pk_add_f32 v[148:149], v[148:149], v[156:157]
    v_pk_add_f32 v[158:159], v[158:159], v[166:167]
    buffer_load_dwordx4 a[204:207], v20, s[12:15], s46 offen offset:0 sc1
    v_add_f32 v112, v148, v149
    v_add_f32 v113, v158, v159
    v_rcp_f32 v110, v113
    s_nop 0
    v_mul_f32 v110, v110, v112
    v_pk_mul_f32 v[88:89], v[88:89], v[110:111] op_sel_hi:[1,0]
    v_pk_mul_f32 v[90:91], v[90:91], v[110:111] op_sel_hi:[1,0]
    v_pk_mul_f32 v[92:93], v[92:93], v[110:111] op_sel_hi:[1,0]
    v_pk_mul_f32 v[94:95], v[94:95], v[110:111] op_sel_hi:[1,0]
    v_pk_mul_f32 v[96:97], v[96:97], v[110:111] op_sel_hi:[1,0]
    v_pk_mul_f32 v[98:99], v[98:99], v[110:111] op_sel_hi:[1,0]
    v_pk_mul_f32 v[100:101], v[100:101], v[110:111] op_sel_hi:[1,0]
    buffer_load_dwordx4 a[208:211], v3, s[12:15], s46 offen offset:2048 sc1
    v_pk_mul_f32 v[102:103], v[102:103], v[110:111] op_sel_hi:[1,0]
    v_pk_mul_f32 v[104:105], v[104:105], v[110:111] op_sel_hi:[1,0]
    v_pk_mul_f32 v[106:107], v[106:107], v[110:111] op_sel_hi:[1,0]
    v_cvt_pk_bf16_f32 v228, v68, v69
    v_cvt_pk_bf16_f32 v229, v70, v71
    v_cvt_pk_bf16_f32 v230, v72, v73
    v_cvt_pk_bf16_f32 v231, v74, v75
    v_cvt_pk_bf16_f32 v232, v76, v77
    v_cvt_pk_bf16_f32 v233, v78, v79
    v_cvt_pk_bf16_f32 v234, v80, v81
    v_cvt_pk_bf16_f32 v235, v82, v83
    buffer_load_dwordx4 a[212:215], v4, s[12:15], s46 offen offset:2048 sc1
    v_cvt_pk_bf16_f32 v236, v84, v85
    v_cvt_pk_bf16_f32 v237, v86, v87
    v_cvt_pk_bf16_f32 v238, v88, v89
    v_cvt_pk_bf16_f32 v239, v90, v91
    v_cvt_pk_bf16_f32 v240, v92, v93
    v_cvt_pk_bf16_f32 v241, v94, v95
    v_cvt_pk_bf16_f32 v242, v96, v97
    v_cvt_pk_bf16_f32 v243, v98, v99
    v_cvt_pk_bf16_f32 v244, v100, v101
    v_cvt_pk_bf16_f32 v245, v102, v103
    v_cvt_pk_bf16_f32 v246, v104, v105
    buffer_load_dwordx4 a[216:219], v5, s[12:15], s46 offen offset:2048 sc1
    v_cvt_pk_bf16_f32 v247, v106, v107
    buffer_load_dwordx4 a[220:223], v20, s[12:15], s46 offen offset:2048 sc1
    v_mul_f32 v121, 0x358637bd, v112
    s_waitcnt vmcnt(19)
    v_cvt_pk_bf16_f32 v176, v176, v177
    v_cvt_pk_bf16_f32 v177, v178, v179
    ds_write_b64 v25, v[176:177] offset:0
    s_waitcnt vmcnt(18)
    v_cvt_pk_bf16_f32 v180, v180, v181
    v_cvt_pk_bf16_f32 v181, v182, v183
    ds_write_b64 v25, v[180:181] offset:2048
    s_waitcnt vmcnt(17)
    v_cvt_pk_bf16_f32 v184, v184, v185
    v_cvt_pk_bf16_f32 v185, v186, v187
    ds_write_b64 v25, v[184:185] offset:4096
    s_waitcnt vmcnt(16)
    v_cvt_pk_bf16_f32 v188, v188, v189
    v_cvt_pk_bf16_f32 v189, v190, v191
    ds_write_b64 v25, v[188:189] offset:6144
    s_waitcnt lgkmcnt(0)
    s_barrier
    ds_read_b128 v[128:131], v21 offset:0
    s_add_u32 m0, s93, 44032
    s_nop 0
    buffer_load_dwordx4 v16, s[12:15], s68 offen offset:1024 sc1 lds
    ds_read_b128 v[132:135], v21 offset:16
    ds_read_b128 v[136:139], v21 offset:32
    ds_read_b128 v[140:143], v21 offset:48
    ds_read_b128 v[144:147], v21 offset:64
    ds_read_b128 v[148:151], v22 offset:0
    ds_read_b128 v[152:155], v22 offset:16
    ds_read_b128 v[156:159], v22 offset:32
    ds_read_b128 v[160:163], v22 offset:48
    ds_read_b128 v[164:167], v22 offset:64
    ds_read_b128 v[168:171], v23 offset:0
    buffer_load_dwordx4 v16, s[12:15], s68 offen offset:2048 sc1 lds
    ds_read_b128 v[172:175], v23 offset:16
    ds_read_b128 v[176:179], v23 offset:32
    ds_read_b128 v[180:183], v23 offset:48
    ds_read_b128 v[184:187], v23 offset:64
    ds_read_b128 v[188:191], v24 offset:0
    ds_read_b128 v[192:195], v24 offset:16
    ds_read_b128 v[196:199], v24 offset:32
    ds_read_b128 v[200:203], v24 offset:48
    ds_read_b128 v[204:207], v24 offset:64
    s_waitcnt lgkmcnt(15)
    v_mfma_f32_32x32x16_bf16 v[48:63], v[128:131], v[208:211], 0
    buffer_load_dwordx4 v16, s[12:15], s68 offen offset:3072 sc1 lds
    v_mfma_f32_32x32x16_bf16 v[48:63], v[132:135], v[212:215], v[48:63]
    v_mfma_f32_32x32x16_bf16 v[48:63], v[136:139], v[216:219], v[48:63]
    v_mfma_f32_32x32x16_bf16 v[48:63], v[140:143], v[220:223], v[48:63]
    s_add_u32 m0, s93, 48128
    s_nop 0
    buffer_load_dwordx4 v17, s[12:15], s68 offen offset:0 sc1 lds
    v_mfma_f32_32x32x16_bf16 v[48:63], v[144:147], v[224:227], v[48:63]
    s_waitcnt lgkmcnt(14)
    v_mfma_f32_32x32x16_bf16 v[64:79], v[148:151], v[228:231], 0
    s_waitcnt lgkmcnt(13)
    v_mfma_f32_32x32x16_bf16 v[64:79], v[152:155], v[232:235], v[64:79]
    buffer_load_dwordx4 v17, s[12:15], s68 offen offset:1024 sc1 lds
    s_waitcnt lgkmcnt(12)
    v_mfma_f32_32x32x16_bf16 v[64:79], v[156:159], v[236:239], v[64:79]
    s_waitcnt lgkmcnt(11)
    v_mfma_f32_32x32x16_bf16 v[64:79], v[160:163], v[240:243], v[64:79]
    s_waitcnt lgkmcnt(10)
    v_mfma_f32_32x32x16_bf16 v[64:79], v[164:167], v[244:247], v[64:79]
    buffer_load_dwordx4 v17, s[12:15], s68 offen offset:2048 sc1 lds
    s_waitcnt lgkmcnt(9)
    v_mfma_f32_32x32x16_bf16 v[80:95], v[168:171], v[208:211], 0
    s_waitcnt lgkmcnt(8)
    v_mfma_f32_32x32x16_bf16 v[80:95], v[172:175], v[212:215], v[80:95]
    s_waitcnt lgkmcnt(7)
    v_mfma_f32_32x32x16_bf16 v[80:95], v[176:179], v[216:219], v[80:95]
    buffer_load_dwordx4 v17, s[12:15], s68 offen offset:3072 sc1 lds
    s_waitcnt lgkmcnt(6)
    v_mfma_f32_32x32x16_bf16 v[80:95], v[180:183], v[220:223], v[80:95]
    s_waitcnt lgkmcnt(5)
    v_mfma_f32_32x32x16_bf16 v[80:95], v[184:187], v[224:227], v[80:95]
    s_waitcnt lgkmcnt(4)
    v_mfma_f32_32x32x16_bf16 v[80:95], v[188:191], v[228:231], v[80:95]
    s_add_u32 m0, s93, 52224
    s_nop 0
    buffer_load_dwordx4 v18, s[12:15], s68 offen offset:0 sc1 lds
    s_waitcnt lgkmcnt(3)
    v_mfma_f32_32x32x16_bf16 v[80:95], v[192:195], v[232:235], v[80:95]
    s_waitcnt lgkmcnt(2)
    v_mfma_f32_32x32x16_bf16 v[80:95], v[196:199], v[236:239], v[80:95]
    s_waitcnt lgkmcnt(1)
    v_mfma_f32_32x32x16_bf16 v[80:95], v[200:203], v[240:243], v[80:95]
    buffer_load_dwordx4 v18, s[12:15], s68 offen offset:1024 sc1 lds
    s_waitcnt lgkmcnt(0)
    v_mfma_f32_32x32x16_bf16 v[80:95], v[204:207], v[244:247], v[80:95]
    s_nop 11
    v_add_f32 v120, v84, v120
    v_add_f32 v121, v92, v121
    v_rcp_f32 v122, v120
    v_rcp_f32 v123, v121
    s_nop 0
    v_pk_mul_f32 v[48:49], v[48:49], v[122:123] op_sel_hi:[1,0]
    v_pk_mul_f32 v[50:51], v[50:51], v[122:123] op_sel_hi:[1,0]
    v_pk_mul_f32 v[52:53], v[52:53], v[122:123] op_sel_hi:[1,0]
    v_pk_mul_f32 v[54:55], v[54:55], v[122:123] op_sel_hi:[1,0]
    v_pk_mul_f32 v[56:57], v[56:57], v[122:123] op_sel_hi:[1,0]
    buffer_load_dwordx4 v18, s[12:15], s68 offen offset:2048 sc1 lds
    v_pk_mul_f32 v[58:59], v[58:59], v[122:123] op_sel_hi:[1,0]
    v_pk_mul_f32 v[60:61], v[60:61], v[122:123] op_sel_hi:[1,0]
    v_pk_mul_f32 v[62:63], v[62:63], v[122:123] op_sel_hi:[1,0]
    v_pk_mul_f32 v[80:81], v[80:81], v[122:123] op_sel_hi:[1,0]
    v_pk_mul_f32 v[82:83], v[82:83], v[122:123] op_sel_hi:[1,0]
    v_cvt_pk_bf16_f32 v128, v48, v49
    v_cvt_pk_bf16_f32 v129, v50, v51
    v_cvt_pk_bf16_f32 v130, v52, v53
    v_cvt_pk_bf16_f32 v131, v54, v55
    v_cvt_pk_bf16_f32 v132, v56, v57
    v_cvt_pk_bf16_f32 v133, v58, v59
    v_cvt_pk_bf16_f32 v134, v60, v61
    v_cvt_pk_bf16_f32 v135, v62, v63
    v_cvt_pk_bf16_f32 v136, v80, v81
    v_cvt_pk_bf16_f32 v137, v82, v83
    v_pk_mul_f32 v[64:65], v[64:65], v[122:123] op_sel:[0,1] op_sel_hi:[1,1]
    buffer_load_dwordx4 v18, s[12:15], s68 offen offset:3072 sc1 lds
    v_pk_mul_f32 v[66:67], v[66:67], v[122:123] op_sel:[0,1] op_sel_hi:[1,1]
    v_pk_mul_f32 v[68:69], v[68:69], v[122:123] op_sel:[0,1] op_sel_hi:[1,1]
    v_pk_mul_f32 v[70:71], v[70:71], v[122:123] op_sel:[0,1] op_sel_hi:[1,1]
    v_pk_mul_f32 v[72:73], v[72:73], v[122:123] op_sel:[0,1] op_sel_hi:[1,1]
    v_pk_mul_f32 v[74:75], v[74:75], v[122:123] op_sel:[0,1] op_sel_hi:[1,1]
    v_pk_mul_f32 v[76:77], v[76:77], v[122:123] op_sel:[0,1] op_sel_hi:[1,1]
    v_pk_mul_f32 v[78:79], v[78:79], v[122:123] op_sel:[0,1] op_sel_hi:[1,1]
    v_pk_mul_f32 v[88:89], v[88:89], v[122:123] op_sel:[0,1] op_sel_hi:[1,1]
    v_pk_mul_f32 v[90:91], v[90:91], v[122:123] op_sel:[0,1] op_sel_hi:[1,1]
    v_cvt_pk_bf16_f32 v138, v64, v65
    v_cvt_pk_bf16_f32 v139, v66, v67
    v_cvt_pk_bf16_f32 v140, v68, v69
    v_cvt_pk_bf16_f32 v141, v70, v71
    v_cvt_pk_bf16_f32 v142, v72, v73
    v_cvt_pk_bf16_f32 v143, v74, v75
    v_cvt_pk_bf16_f32 v144, v76, v77
    s_add_u32 m0, s93, 56320
    s_nop 0
    buffer_load_dwordx4 v19, s[12:15], s68 offen offset:0 sc1 lds
    v_cvt_pk_bf16_f32 v145, v78, v79
    v_cvt_pk_bf16_f32 v146, v88, v89
    v_cvt_pk_bf16_f32 v147, v90, v91
    buffer_load_dwordx4 v19, s[12:15], s68 offen offset:1024 sc1 lds
    buffer_load_dword v8, v6, s[12:15], s57 offen offset:128 sc1
    s_mul_i32 s58, s30, 5120
    s_add_u32 s58, s58, s64
    s_add_u32 s58, s58, 98304
    s_add_u32 s59, s58, 4096
    buffer_store_dwordx4 v[128:131], v2, s[12:15], s58 offen offset:0 sc1
    buffer_store_dwordx4 v[132:135], v2, s[12:15], s58 offen offset:1024 sc1
    buffer_store_dwordx4 v[136:139], v2, s[12:15], s58 offen offset:2048 sc1
    buffer_store_dwordx4 v[140:143], v2, s[12:15], s58 offen offset:3072 sc1
    buffer_store_dwordx4 v[144:147], v2, s[12:15], s59 offen sc1
    s_lshl_b32 s79, s29, 9
    s_lshl_b32 s58, s30, 2
    s_add_u32 s79, s79, s58
    s_add_u32 s47, s92, 0
    v_add_u32 v43, s47, v2
    s_add_u32 s47, s93, 0
    v_add_u32 v44, s47, v2
    s_add_u32 s47, s93, 65536
    v_add_u32 v45, s47, v2
    s_waitcnt vmcnt(5)
    v_cmp_ne_u32 vcc, 1, v8
    s_nop 0
    s_and_b32 s58, vcc_lo, 0xff
    s_cselect_b32 s26, 0, 16777216
    s_waitcnt vmcnt(0)
    s_barrier
    buffer_store_dword a255, v15, s[12:15], s79 offen offset:384 sc1
    v_mfma_f32_16x16x32_bf16 v[128:131], a[0:3], a[160:163], 0
    s_add_u32 s46, s44, 32768
    buffer_load_dwordx4 v[64:67], v3, s[24:27], s46 offen offset:0 sc1
    v_mfma_f32_16x16x32_bf16 v[132:135], a[4:7], a[160:163], 0
    v_mfma_f32_16x16x32_bf16 v[136:139], a[8:11], a[160:163], 0
    v_mfma_f32_16x16x32_bf16 v[140:143], a[12:15], a[160:163], 0
    v_mfma_f32_16x16x32_bf16 v[144:147], a[16:19], a[160:163], 0
    buffer_load_dwordx4 v[68:71], v4, s[24:27], s46 offen offset:0 sc1
    v_mfma_f32_16x16x32_bf16 v[148:151], a[0:3], a[164:167], 0
    v_mfma_f32_16x16x32_bf16 v[152:155], a[4:7], a[164:167], 0
    v_mfma_f32_16x16x32_bf16 v[156:159], a[8:11], a[164:167], 0
    v_mfma_f32_16x16x32_bf16 v[160:163], a[12:15], a[164:167], 0
    buffer_load_dwordx4 v[72:75], v5, s[24:27], s46 offen offset:0 sc1
    v_mfma_f32_16x16x32_bf16 v[164:167], a[16:19], a[164:167], 0
    v_mfma_f32_16x16x32_bf16 v[168:171], a[0:3], a[168:171], 0
    v_mfma_f32_16x16x32_bf16 v[172:175], a[4:7], a[168:171], 0
    v_mfma_f32_16x16x32_bf16 v[176:179], a[8:11], a[168:171], 0
    buffer_load_dwordx4 v[76:79], v20, s[24:27], s46 offen offset:0 sc1
    v_mfma_f32_16x16x32_bf16 v[180:183], a[12:15], a[168:171], 0
    v_mfma_f32_16x16x32_bf16 v[184:187], a[16:19], a[168:171], 0
    v_mfma_f32_16x16x32_bf16 v[188:191], a[0:3], a[172:175], 0
    v_mfma_f32_16x16x32_bf16 v[192:195], a[4:7], a[172:175], 0
    buffer_load_dwordx4 v[80:83], v3, s[24:27], s46 offen offset:2048 sc1
    v_mfma_f32_16x16x32_bf16 v[196:199], a[8:11], a[172:175], 0
    v_mfma_f32_16x16x32_bf16 v[200:203], a[12:15], a[172:175], 0
    v_mfma_f32_16x16x32_bf16 v[204:207], a[16:19], a[172:175], 0
    v_mfma_f32_16x16x32_bf16 v[128:131], a[20:23], a[176:179], v[128:131]
    buffer_load_dwordx4 v[84:87], v4, s[24:27], s46 offen offset:2048 sc1
    v_mfma_f32_16x16x32_bf16 v[132:135], a[24:27], a[176:179], v[132:135]
    v_mfma_f32_16x16x32_bf16 v[136:139], a[28:31], a[176:179], v[136:139]
    v_mfma_f32_16x16x32_bf16 v[140:143], a[32:35], a[176:179], v[140:143]
    v_mfma_f32_16x16x32_bf16 v[144:147], a[36:39], a[176:179], v[144:147]
    buffer_load_dwordx4 v[88:91], v5, s[24:27], s46 offen offset:2048 sc1
    v_mfma_f32_16x16x32_bf16 v[148:151], a[20:23], a[180:183], v[148:151]
    v_mfma_f32_16x16x32_bf16 v[152:155], a[24:27], a[180:183], v[152:155]
    v_mfma_f32_16x16x32_bf16 v[156:159], a[28:31], a[180:183], v[156:159]
    v_mfma_f32_16x16x32_bf16 v[160:163], a[32:35], a[180:183], v[160:163]
    buffer_load_dwordx4 v[92:95], v20, s[24:27], s46 offen offset:2048 sc1
    v_mfma_f32_16x16x32_bf16 v[164:167], a[36:39], a[180:183], v[164:167]
    v_mfma_f32_16x16x32_bf16 v[168:171], a[20:23], a[184:187], v[168:171]
    v_mfma_f32_16x16x32_bf16 v[172:175], a[24:27], a[184:187], v[172:175]
    v_mfma_f32_16x16x32_bf16 v[176:179], a[28:31], a[184:187], v[176:179]
    s_add_u32 s46, s46, 4096
    buffer_load_dwordx4 v[96:99], v3, s[24:27], s46 offen offset:0 sc1
    v_mfma_f32_16x16x32_bf16 v[180:183], a[32:35], a[184:187], v[180:183]
    v_mfma_f32_16x16x32_bf16 v[184:187], a[36:39], a[184:187], v[184:187]
    v_mfma_f32_16x16x32_bf16 v[188:191], a[20:23], a[188:191], v[188:191]
    v_mfma_f32_16x16x32_bf16 v[192:195], a[24:27], a[188:191], v[192:195]
    buffer_load_dwordx4 v[100:103], v4, s[24:27], s46 offen offset:0 sc1
    v_mfma_f32_16x16x32_bf16 v[196:199], a[28:31], a[188:191], v[196:199]
    v_mfma_f32_16x16x32_bf16 v[200:203], a[32:35], a[188:191], v[200:203]
    v_mfma_f32_16x16x32_bf16 v[204:207], a[36:39], a[188:191], v[204:207]
    v_mfma_f32_16x16x32_bf16 v[128:131], a[40:43], a[192:195], v[128:131]
    buffer_load_dwordx4 v[104:107], v5, s[24:27], s46 offen offset:0 sc1
    v_mfma_f32_16x16x32_bf16 v[132:135], a[44:47], a[192:195], v[132:135]
    v_mfma_f32_16x16x32_bf16 v[136:139], a[48:51], a[192:195], v[136:139]
    v_mfma_f32_16x16x32_bf16 v[140:143], a[52:55], a[192:195], v[140:143]
    v_mfma_f32_16x16x32_bf16 v[144:147], a[56:59], a[192:195], v[144:147]
    buffer_load_dwordx4 v[108:111], v20, s[24:27], s46 offen offset:0 sc1
    v_mfma_f32_16x16x32_bf16 v[148:151], a[40:43], a[196:199], v[148:151]
    v_mfma_f32_16x16x32_bf16 v[152:155], a[44:47], a[196:199], v[152:155]
    v_mfma_f32_16x16x32_bf16 v[156:159], a[48:51], a[196:199], v[156:159]
    v_mfma_f32_16x16x32_bf16 v[160:163], a[52:55], a[196:199], v[160:163]
    buffer_load_dwordx4 v[112:115], v3, s[24:27], s46 offen offset:2048 sc1
    v_mfma_f32_16x16x32_bf16 v[164:167], a[56:59], a[196:199], v[164:167]
    v_mfma_f32_16x16x32_bf16 v[168:171], a[40:43], a[200:203], v[168:171]
    v_mfma_f32_16x16x32_bf16 v[172:175], a[44:47], a[200:203], v[172:175]
    v_mfma_f32_16x16x32_bf16 v[176:179], a[48:51], a[200:203], v[176:179]
    buffer_load_dwordx4 v[116:119], v4, s[24:27], s46 offen offset:2048 sc1
    v_mfma_f32_16x16x32_bf16 v[180:183], a[52:55], a[200:203], v[180:183]
    v_mfma_f32_16x16x32_bf16 v[184:187], a[56:59], a[200:203], v[184:187]
    v_mfma_f32_16x16x32_bf16 v[188:191], a[40:43], a[204:207], v[188:191]
    v_mfma_f32_16x16x32_bf16 v[192:195], a[44:47], a[204:207], v[192:195]
    buffer_load_dwordx4 v[120:123], v5, s[24:27], s46 offen offset:2048 sc1
    v_mfma_f32_16x16x32_bf16 v[196:199], a[48:51], a[204:207], v[196:199]
    v_mfma_f32_16x16x32_bf16 v[200:203], a[52:55], a[204:207], v[200:203]
    v_mfma_f32_16x16x32_bf16 v[204:207], a[56:59], a[204:207], v[204:207]
    buffer_load_dword v7, v6, s[12:15], s57 offen offset:256 sc1
    v_mfma_f32_16x16x32_bf16 v[128:131], a[60:63], a[208:211], v[128:131]
    buffer_load_dwordx4 v[124:127], v20, s[24:27], s46 offen offset:2048 sc1
    v_mfma_f32_16x16x32_bf16 v[132:135], a[64:67], a[208:211], v[132:135]
    v_mfma_f32_16x16x32_bf16 v[136:139], a[68:71], a[208:211], v[136:139]
    v_mfma_f32_16x16x32_bf16 v[140:143], a[72:75], a[208:211], v[140:143]
    v_mfma_f32_16x16x32_bf16 v[144:147], a[76:79], a[208:211], v[144:147]
    buffer_load_dwordx4 v[208:211], v16, s[12:15], s67 offen offset:1024 sc1
    v_mfma_f32_16x16x32_bf16 v[148:151], a[60:63], a[212:215], v[148:151]
    v_mfma_f32_16x16x32_bf16 v[152:155], a[64:67], a[212:215], v[152:155]
    v_mfma_f32_16x16x32_bf16 v[156:159], a[68:71], a[212:215], v[156:159]
    v_mfma_f32_16x16x32_bf16 v[160:163], a[72:75], a[212:215], v[160:163]
    buffer_load_dwordx4 v[212:215], v16, s[12:15], s67 offen offset:2048 sc1
    v_mfma_f32_16x16x32_bf16 v[164:167], a[76:79], a[212:215], v[164:167]
    v_mfma_f32_16x16x32_bf16 v[168:171], a[60:63], a[216:219], v[168:171]
    v_mfma_f32_16x16x32_bf16 v[172:175], a[64:67], a[216:219], v[172:175]
    v_mfma_f32_16x16x32_bf16 v[176:179], a[68:71], a[216:219], v[176:179]
    buffer_load_dwordx4 v[216:219], v16, s[12:15], s67 offen offset:3072 sc1
    v_mfma_f32_16x16x32_bf16 v[180:183], a[72:75], a[216:219], v[180:183]
    v_mfma_f32_16x16x32_bf16 v[184:187], a[76:79], a[216:219], v[184:187]
    v_mfma_f32_16x16x32_bf16 v[188:191], a[60:63], a[220:223], v[188:191]
    v_mfma_f32_16x16x32_bf16 v[192:195], a[64:67], a[220:223], v[192:195]
    buffer_load_dwordx4 v[220:223], v17, s[12:15], s67 offen offset:0 sc1
    v_mfma_f32_16x16x32_bf16 v[196:199], a[68:71], a[220:223], v[196:199]
    v_mfma_f32_16x16x32_bf16 v[200:203], a[72:75], a[220:223], v[200:203]
    v_mfma_f32_16x16x32_bf16 v[204:207], a[76:79], a[220:223], v[204:207]
    buffer_load_dwordx4 v[224:227], v17, s[12:15], s67 offen offset:1024 sc1
    buffer_load_dwordx4 v[228:231], v17, s[12:15], s67 offen offset:2048 sc1
    buffer_load_dwordx4 v[232:235], v17, s[12:15], s67 offen offset:3072 sc1
    buffer_load_dwordx4 v[236:239], v18, s[12:15], s67 offen offset:0 sc1
    buffer_load_dwordx4 v[240:243], v18, s[12:15], s67 offen offset:1024 sc1
    buffer_load_dwordx4 v[244:247], v18, s[12:15], s67 offen offset:2048 sc1
    s_waitcnt vmcnt(11)
    s_cmp_eq_u32 s26, 0
    s_cbranch_scc1 L_slow_p1q
L_back_p1q:
    v_cmp_ne_u32 vcc, 1, v7
    s_nop 0
    s_and_b32 s58, vcc_lo, 0xff
    s_cselect_b32 s26, 0, 16777216
    s_waitcnt vmcnt(12)
    v_mfma_f32_16x16x32_bf16 v[128:131], a[80:83], v[64:67], v[128:131]
    s_add_u32 s46, s44, 65536
    buffer_load_dwordx4 a[160:163], v3, s[24:27], s46 offen offset:0 sc1
    v_mfma_f32_16x16x32_bf16 v[132:135], a[84:87], v[64:67], v[132:135]
    v_mfma_f32_16x16x32_bf16 v[136:139], a[88:91], v[64:67], v[136:139]
    v_mfma_f32_16x16x32_bf16 v[140:143], a[92:95], v[64:67], v[140:143]
    v_mfma_f32_16x16x32_bf16 v[144:147], a[96:99], v[64:67], v[144:147]
    buffer_load_dwordx4 a[164:167], v4, s[24:27], s46 offen offset:0 sc1
    v_mfma_f32_16x16x32_bf16 v[148:151], a[80:83], v[68:71], v[148:151]
    v_mfma_f32_16x16x32_bf16 v[152:155], a[84:87], v[68:71], v[152:155]
    v_mfma_f32_16x16x32_bf16 v[156:159], a[88:91], v[68:71], v[156:159]
    v_mfma_f32_16x16x32_bf16 v[160:163], a[92:95], v[68:71], v[160:163]
    buffer_load_dwordx4 a[168:171], v5, s[24:27], s46 offen offset:0 sc1
    v_mfma_f32_16x16x32_bf16 v[164:167], a[96:99], v[68:71], v[164:167]
    v_mfma_f32_16x16x32_bf16 v[168:171], a[80:83], v[72:75], v[168:171]
    v_mfma_f32_16x16x32_bf16 v[172:175], a[84:87], v[72:75], v[172:175]
    v_mfma_f32_16x16x32_bf16 v[176:179], a[88:91], v[72:75], v[176:179]
    buffer_load_dwordx4 a[172:175], v20, s[24:27], s46 offen offset:0 sc1
    v_mfma_f32_16x16x32_bf16 v[180:183], a[92:95], v[72:75], v[180:183]
    v_mfma_f32_16x16x32_bf16 v[184:187], a[96:99], v[72:75], v[184:187]
    v_mfma_f32_16x16x32_bf16 v[188:191], a[80:83], v[76:79], v[188:191]
    v_mfma_f32_16x16x32_bf16 v[192:195], a[84:87], v[76:79], v[192:195]
    buffer_load_dwordx4 a[176:179], v3, s[24:27], s46 offen offset:2048 sc1
    v_mfma_f32_16x16x32_bf16 v[196:199], a[88:91], v[76:79], v[196:199]
    v_mfma_f32_16x16x32_bf16 v[200:203], a[92:95], v[76:79], v[200:203]
    v_mfma_f32_16x16x32_bf16 v[204:207], a[96:99], v[76:79], v[204:207]
    s_waitcnt vmcnt(13)
    v_mfma_f32_16x16x32_bf16 v[128:131], v[208:211], v[80:83], v[128:131]
    buffer_load_dwordx4 a[180:183], v4, s[24:27], s46 offen offset:2048 sc1
    v_mfma_f32_16x16x32_bf16 v[132:135], v[212:215], v[80:83], v[132:135]
    s_waitcnt vmcnt(13)
    v_mfma_f32_16x16x32_bf16 v[136:139], v[216:219], v[80:83], v[136:139]
    s_waitcnt vmcnt(12)
    v_mfma_f32_16x16x32_bf16 v[140:143], v[220:223], v[80:83], v[140:143]
    s_waitcnt vmcnt(11)
    v_mfma_f32_16x16x32_bf16 v[144:147], v[224:227], v[80:83], v[144:147]
    buffer_load_dwordx4 a[184:187], v5, s[24:27], s46 offen offset:2048 sc1
    v_mfma_f32_16x16x32_bf16 v[148:151], v[208:211], v[84:87], v[148:151]
    ds_read_b128 a[0:3], v43 offset:3072
    v_mfma_f32_16x16x32_bf16 v[152:155], v[212:215], v[84:87], v[152:155]
    ds_read_b128 a[4:7], v43 offset:4096
    v_mfma_f32_16x16x32_bf16 v[156:159], v[216:219], v[84:87], v[156:159]
    buffer_load_dwordx4 a[188:191], v20, s[24:27], s46 offen offset:2048 sc1
    ds_read_b128 a[8:11], v43 offset:5120
    v_mfma_f32_16x16x32_bf16 v[160:163], v[220:223], v[84:87], v[160:163]
    ds_read_b128 a[12:15], v43 offset:6144
    v_mfma_f32_16x16x32_bf16 v[164:167], v[224:227], v[84:87], v[164:167]
    ds_read_b128 a[16:19], v43 offset:7168
    v_mfma_f32_16x16x32_bf16 v[168:171], v[208:211], v[88:91], v[168:171]
    s_add_u32 s46, s46, 4096
    buffer_load_dwordx4 a[192:195], v3, s[24:27], s46 offen offset:0 sc1
    v_mfma_f32_16x16x32_bf16 v[172:175], v[212:215], v[88:91], v[172:175]
    v_mfma_f32_16x16x32_bf16 v[176:179], v[216:219], v[88:91], v[176:179]
    v_mfma_f32_16x16x32_bf16 v[180:183], v[220:223], v[88:91], v[180:183]
    v_mfma_f32_16x16x32_bf16 v[184:187], v[224:227], v[88:91], v[184:187]
    buffer_load_dwordx4 a[196:199], v4, s[24:27], s46 offen offset:0 sc1
    v_mfma_f32_16x16x32_bf16 v[188:191], v[208:211], v[92:95], v[188:191]
    v_mfma_f32_16x16x32_bf16 v[192:195], v[212:215], v[92:95], v[192:195]
    v_mfma_f32_16x16x32_bf16 v[196:199], v[216:219], v[92:95], v[196:199]
    v_mfma_f32_16x16x32_bf16 v[200:203], v[220:223], v[92:95], v[200:203]
    buffer_load_dwordx4 a[200:203], v5, s[24:27], s46 offen offset:0 sc1
    v_mfma_f32_16x16x32_bf16 v[204:207], v[224:227], v[92:95], v[204:207]
    s_waitcnt vmcnt(15)
    v_mfma_f32_16x16x32_bf16 v[128:131], v[228:231], v[96:99], v[128:131]
    s_waitcnt vmcnt(14)
    v_mfma_f32_16x16x32_bf16 v[132:135], v[232:235], v[96:99], v[132:135]
    s_waitcnt vmcnt(13)
    v_mfma_f32_16x16x32_bf16 v[136:139], v[236:239], v[96:99], v[136:139]
    buffer_load_dwordx4 a[204:207], v20, s[24:27], s46 offen offset:0 sc1
    s_waitcnt vmcnt(13)
    v_mfma_f32_16x16x32_bf16 v[140:143], v[240:243], v[96:99], v[140:143]
    s_waitcnt vmcnt(12)
    v_mfma_f32_16x16x32_bf16 v[144:147], v[244:247], v[96:99], v[144:147]
    v_mfma_f32_16x16x32_bf16 v[148:151], v[228:231], v[100:103], v[148:151]
    ds_read_b128 a[20:23], v43 offset:8192
    v_mfma_f32_16x16x32_bf16 v[152:155], v[232:235], v[100:103], v[152:155]
    buffer_load_dwordx4 a[208:211], v3, s[24:27], s46 offen offset:2048 sc1
    ds_read_b128 a[24:27], v43 offset:9216
    v_mfma_f32_16x16x32_bf16 v[156:159], v[236:239], v[100:103], v[156:159]
    ds_read_b128 a[28:31], v43 offset:10240
    v_mfma_f32_16x16x32_bf16 v[160:163], v[240:243], v[100:103], v[160:163]
    ds_read_b128 a[32:35], v43 offset:11264
    v_mfma_f32_16x16x32_bf16 v[164:167], v[244:247], v[100:103], v[164:167]
    buffer_load_dwordx4 a[212:215], v4, s[24:27], s46 offen offset:2048 sc1
    ds_read_b128 a[36:39], v43 offset:12288
    v_mfma_f32_16x16x32_bf16 v[168:171], v[228:231], v[104:107], v[168:171]
    v_mfma_f32_16x16x32_bf16 v[172:175], v[232:235], v[104:107], v[172:175]
    v_mfma_f32_16x16x32_bf16 v[176:179], v[236:239], v[104:107], v[176:179]
    v_mfma_f32_16x16x32_bf16 v[180:183], v[240:243], v[104:107], v[180:183]
    buffer_load_dwordx4 a[216:219], v5, s[24:27], s46 offen offset:2048 sc1
    v_mfma_f32_16x16x32_bf16 v[184:187], v[244:247], v[104:107], v[184:187]
    v_mfma_f32_16x16x32_bf16 v[188:191], v[228:231], v[108:111], v[188:191]
    v_mfma_f32_16x16x32_bf16 v[192:195], v[232:235], v[108:111], v[192:195]
    v_mfma_f32_16x16x32_bf16 v[196:199], v[236:239], v[108:111], v[196:199]
    buffer_load_dwordx4 a[220:223], v20, s[24:27], s46 offen offset:2048 sc1
    v_mfma_f32_16x16x32_bf16 v[200:203], v[240:243], v[108:111], v[200:203]
    v_mfma_f32_16x16x32_bf16 v[204:207], v[244:247], v[108:111], v[204:207]
    s_waitcnt vmcnt(16)
    buffer_load_dword v8, v6, s[12:15], s57 offen offset:384 sc1
    s_waitcnt lgkmcnt(9)
    v_mfma_f32_16x16x32_bf16 v[128:131], a[0:3], v[112:115], v[128:131]
    s_add_u32 m0, s93, 56320
    s_nop 0
    buffer_load_dwordx4 v19, s[12:15], s68 offen offset:2048 sc1 lds
    s_waitcnt lgkmcnt(8)
    v_mfma_f32_16x16x32_bf16 v[132:135], a[4:7], v[112:115], v[132:135]
    s_waitcnt lgkmcnt(7)
    v_mfma_f32_16x16x32_bf16 v[136:139], a[8:11], v[112:115], v[136:139]
    s_waitcnt lgkmcnt(6)
    v_mfma_f32_16x16x32_bf16 v[140:143], a[12:15], v[112:115], v[140:143]
    s_waitcnt lgkmcnt(5)
    v_mfma_f32_16x16x32_bf16 v[144:147], a[16:19], v[112:115], v[144:147]
    buffer_load_dwordx4 v19, s[12:15], s68 offen offset:3072 sc1 lds
    v_mfma_f32_16x16x32_bf16 v[148:151], a[0:3], v[116:119], v[148:151]
    ds_read_b128 a[40:43], v44 offset:45056
    v_mfma_f32_16x16x32_bf16 v[152:155], a[4:7], v[116:119], v[152:155]
    ds_read_b128 a[44:47], v44 offset:46080
    v_mfma_f32_16x16x32_bf16 v[156:159], a[8:11], v[116:119], v[156:159]
    s_add_u32 m0, s93, 60416
    s_nop 0
    buffer_load_dwordx4 v2, s[12:15], s69 offen offset:0 sc1 lds
    ds_read_b128 a[48:51], v44 offset:47104
    v_mfma_f32_16x16x32_bf16 v[160:163], a[12:15], v[116:119], v[160:163]
    ds_read_b128 a[52:55], v44 offset:48128
    v_mfma_f32_16x16x32_bf16 v[164:167], a[16:19], v[116:119], v[164:167]
    ds_read_b128 a[56:59], v44 offset:49152
    v_mfma_f32_16x16x32_bf16 v[168:171], a[0:3], v[120:123], v[168:171]
    buffer_load_dwordx4 v2, s[12:15], s69 offen offset:1024 sc1 lds
    v_mfma_f32_16x16x32_bf16 v[172:175], a[4:7], v[120:123], v[172:175]
    v_mfma_f32_16x16x32_bf16 v[176:179], a[8:11], v[120:123], v[176:179]
    v_mfma_f32_16x16x32_bf16 v[180:183], a[12:15], v[120:123], v[180:183]
    v_mfma_f32_16x16x32_bf16 v[184:187], a[16:19], v[120:123], v[184:187]
    buffer_load_dwordx4 v2, s[12:15], s69 offen offset:2048 sc1 lds
    v_mfma_f32_16x16x32_bf16 v[188:191], a[0:3], v[124:127], v[188:191]
    v_mfma_f32_16x16x32_bf16 v[192:195], a[4:7], v[124:127], v[192:195]
    v_mfma_f32_16x16x32_bf16 v[196:199], a[8:11], v[124:127], v[196:199]
    v_mfma_f32_16x16x32_bf16 v[200:203], a[12:15], v[124:127], v[200:203]
    buffer_load_dwordx4 v2, s[12:15], s69 offen offset:3072 sc1 lds
    v_mfma_f32_16x16x32_bf16 v[204:207], a[16:19], v[124:127], v[204:207]
    s_add_u32 m0, s93, 64512
    s_nop 0
    buffer_load_dwordx4 v16, s[12:15], s69 offen offset:0 sc1 lds
    buffer_load_dwordx4 v16, s[12:15], s69 offen offset:1024 sc1 lds
    buffer_load_dwordx4 v16, s[12:15], s69 offen offset:2048 sc1 lds
    buffer_load_dwordx4 v16, s[12:15], s69 offen offset:3072 sc1 lds
    s_add_u32 m0, s93, 68608
    s_nop 0
    buffer_load_dwordx4 v17, s[12:15], s69 offen offset:0 sc1 lds
    buffer_load_dwordx4 v17, s[12:15], s69 offen offset:1024 sc1 lds
    s_waitcnt vmcnt(12)
    s_cmp_eq_u32 s26, 0
    s_cbranch_scc1 L_slow_p2q
L_back_p2q:
    v_cmp_ne_u32 vcc, 1, v8
    s_nop 0
    s_and_b32 s58, vcc_lo, 0xff
    s_cselect_b32 s26, 0, 16777216
    s_waitcnt vmcnt(12)
    s_waitcnt lgkmcnt(9)
    v_mfma_f32_16x16x32_bf16 v[128:131], a[20:23], a[160:163], v[128:131]
    s_mov_b32 s46, s45
    s_add_u32 s47, s45, 4096
    s_add_u32 s48, s45, 8192
    buffer_load_dwordx4 v[52:55], v4, s[24:27], s46 offen offset:0 sc1
    s_waitcnt lgkmcnt(8)
    v_mfma_f32_16x16x32_bf16 v[132:135], a[24:27], a[160:163], v[132:135]
    s_waitcnt lgkmcnt(7)
    v_mfma_f32_16x16x32_bf16 v[136:139], a[28:31], a[160:163], v[136:139]
    s_waitcnt lgkmcnt(6)
    v_mfma_f32_16x16x32_bf16 v[140:143], a[32:35], a[160:163], v[140:143]
    s_waitcnt lgkmcnt(5)
    v_mfma_f32_16x16x32_bf16 v[144:147], a[36:39], a[160:163], v[144:147]
    buffer_load_dwordx4 v[68:71], v4, s[24:27], s46 offen offset:2048 sc1
    v_mfma_f32_16x16x32_bf16 v[148:151], a[20:23], a[164:167], v[148:151]
    ds_read_b128 a[60:63], v44 offset:50176
    v_mfma_f32_16x16x32_bf16 v[152:155], a[24:27], a[164:167], v[152:155]
    ds_read_b128 a[64:67], v44 offset:51200
    v_mfma_f32_16x16x32_bf16 v[156:159], a[28:31], a[164:167], v[156:159]
    buffer_load_dwordx4 v[84:87], v4, s[24:27], s47 offen offset:0 sc1
    ds_read_b128 a[68:71], v44 offset:52224
    v_mfma_f32_16x16x32_bf16 v[160:163], a[32:35], a[164:167], v[160:163]
    ds_read_b128 a[72:75], v44 offset:53248
    v_mfma_f32_16x16x32_bf16 v[164:167], a[36:39], a[164:167], v[164:167]
    ds_read_b128 a[76:79], v44 offset:54272
    v_mfma_f32_16x16x32_bf16 v[168:171], a[20:23], a[168:171], v[168:171]
    buffer_load_dwordx4 v[100:103], v4, s[24:27], s47 offen offset:2048 sc1
    v_mfma_f32_16x16x32_bf16 v[172:175], a[24:27], a[168:171], v[172:175]
    v_mfma_f32_16x16x32_bf16 v[176:179], a[28:31], a[168:171], v[176:179]
    v_mfma_f32_16x16x32_bf16 v[180:183], a[32:35], a[168:171], v[180:183]
    v_mfma_f32_16x16x32_bf16 v[184:187], a[36:39], a[168:171], v[184:187]
    buffer_load_dwordx4 v[116:119], v4, s[24:27], s48 offen offset:0 sc1
    v_mfma_f32_16x16x32_bf16 v[188:191], a[20:23], a[172:175], v[188:191]
    v_mfma_f32_16x16x32_bf16 v[192:195], a[24:27], a[172:175], v[192:195]
    v_mfma_f32_16x16x32_bf16 v[196:199], a[28:31], a[172:175], v[196:199]
    v_mfma_f32_16x16x32_bf16 v[200:203], a[32:35], a[172:175], v[200:203]
    buffer_load_dwordx4 v[56:59], v5, s[24:27], s46 offen offset:0 sc1
    v_mfma_f32_16x16x32_bf16 v[204:207], a[36:39], a[172:175], v[204:207]
    s_waitcnt vmcnt(14)
    s_waitcnt lgkmcnt(9)
    v_mfma_f32_16x16x32_bf16 v[128:131], a[40:43], a[176:179], v[128:131]
    s_waitcnt lgkmcnt(8)
    v_mfma_f32_16x16x32_bf16 v[132:135], a[44:47], a[176:179], v[132:135]
    s_waitcnt lgkmcnt(7)
    v_mfma_f32_16x16x32_bf16 v[136:139], a[48:51], a[176:179], v[136:139]
    buffer_load_dwordx4 v[72:75], v5, s[24:27], s46 offen offset:2048 sc1
    s_waitcnt lgkmcnt(6)
    v_mfma_f32_16x16x32_bf16 v[140:143], a[52:55], a[176:179], v[140:143]
    s_waitcnt lgkmcnt(5)
    v_mfma_f32_16x16x32_bf16 v[144:147], a[56:59], a[176:179], v[144:147]
    v_mfma_f32_16x16x32_bf16 v[148:151], a[40:43], a[180:183], v[148:151]
    ds_read_b128 a[80:83], v44 offset:55296
    v_mfma_f32_16x16x32_bf16 v[152:155], a[44:47], a[180:183], v[152:155]
    buffer_load_dwordx4 v[88:91], v5, s[24:27], s47 offen offset:0 sc1
    ds_read_b128 a[84:87], v44 offset:56320
    v_mfma_f32_16x16x32_bf16 v[156:159], a[48:51], a[180:183], v[156:159]
    ds_read_b128 a[88:91], v44 offset:57344
    v_mfma_f32_16x16x32_bf16 v[160:163], a[52:55], a[180:183], v[160:163]
    ds_read_b128 a[92:95], v44 offset:58368
    v_mfma_f32_16x16x32_bf16 v[164:167], a[56:59], a[180:183], v[164:167]
    buffer_load_dwordx4 v[104:107], v5, s[24:27], s47 offen offset:2048 sc1
    ds_read_b128 a[96:99], v44 offset:59392
    v_mfma_f32_16x16x32_bf16 v[168:171], a[40:43], a[184:187], v[168:171]
    v_mfma_f32_16x16x32_bf16 v[172:175], a[44:47], a[184:187], v[172:175]
    v_mfma_f32_16x16x32_bf16 v[176:179], a[48:51], a[184:187], v[176:179]
    v_mfma_f32_16x16x32_bf16 v[180:183], a[52:55], a[184:187], v[180:183]
    buffer_load_dwordx4 v[120:123], v5, s[24:27], s48 offen offset:0 sc1
    v_mfma_f32_16x16x32_bf16 v[184:187], a[56:59], a[184:187], v[184:187]
    v_mfma_f32_16x16x32_bf16 v[188:191], a[40:43], a[188:191], v[188:191]
    v_mfma_f32_16x16x32_bf16 v[192:195], a[44:47], a[188:191], v[192:195]
    v_mfma_f32_16x16x32_bf16 v[196:199], a[48:51], a[188:191], v[196:199]
    buffer_load_dwordx4 v[60:63], v20, s[24:27], s46 offen offset:0 sc1
    v_mfma_f32_16x16x32_bf16 v[200:203], a[52:55], a[188:191], v[200:203]
    v_mfma_f32_16x16x32_bf16 v[204:207], a[56:59], a[188:191], v[204:207]
    s_waitcnt vmcnt(15)
    s_waitcnt lgkmcnt(9)
    v_mfma_f32_16x16x32_bf16 v[128:131], a[60:63], a[192:195], v[128:131]
    s_waitcnt lgkmcnt(8)
    v_mfma_f32_16x16x32_bf16 v[132:135], a[64:67], a[192:195], v[132:135]
    buffer_load_dwordx4 v[76:79], v20, s[24:27], s46 offen offset:2048 sc1
    s_waitcnt lgkmcnt(7)
    v_mfma_f32_16x16x32_bf16 v[136:139], a[68:71], a[192:195], v[136:139]
    s_waitcnt lgkmcnt(6)
    v_mfma_f32_16x16x32_bf16 v[140:143], a[72:75], a[192:195], v[140:143]
    s_waitcnt lgkmcnt(5)
    v_mfma_f32_16x16x32_bf16 v[144:147], a[76:79], a[192:195], v[144:147]
    v_mfma_f32_16x16x32_bf16 v[148:151], a[60:63], a[196:199], v[148:151]
    buffer_load_dwordx4 v[92:95], v20, s[24:27], s47 offen offset:0 sc1
    ds_read_b128 v[208:211], v44 offset:60416
    v_mfma_f32_16x16x32_bf16 v[152:155], a[64:67], a[196:199], v[152:155]
    ds_read_b128 v[212:215], v44 offset:61440
    v_mfma_f32_16x16x32_bf16 v[156:159], a[68:71], a[196:199], v[156:159]
    ds_read_b128 v[216:219], v44 offset:62464
    v_mfma_f32_16x16x32_bf16 v[160:163], a[72:75], a[196:199], v[160:163]
    buffer_load_dwordx4 v[108:111], v20, s[24:27], s47 offen offset:2048 sc1
    ds_read_b128 v[220:223], v44 offset:63488
    v_mfma_f32_16x16x32_bf16 v[164:167], a[76:79], a[196:199], v[164:167]
    ds_read_b128 v[224:227], v44 offset:64512
    v_mfma_f32_16x16x32_bf16 v[168:171], a[60:63], a[200:203], v[168:171]
    v_mfma_f32_16x16x32_bf16 v[172:175], a[64:67], a[200:203], v[172:175]
    buffer_load_dwordx4 v[124:127], v20, s[24:27], s48 offen offset:0 sc1
    v_mfma_f32_16x16x32_bf16 v[176:179], a[68:71], a[200:203], v[176:179]
    v_mfma_f32_16x16x32_bf16 v[180:183], a[72:75], a[200:203], v[180:183]
    v_mfma_f32_16x16x32_bf16 v[184:187], a[76:79], a[200:203], v[184:187]
    v_mfma_f32_16x16x32_bf16 v[188:191], a[60:63], a[204:207], v[188:191]
    buffer_load_dwordx4 v[48:51], v3, s[24:27], s46 offen offset:0 sc1
    v_mfma_f32_16x16x32_bf16 v[192:195], a[64:67], a[204:207], v[192:195]
    v_mfma_f32_16x16x32_bf16 v[196:199], a[68:71], a[204:207], v[196:199]
    v_mfma_f32_16x16x32_bf16 v[200:203], a[72:75], a[204:207], v[200:203]
    v_mfma_f32_16x16x32_bf16 v[204:207], a[76:79], a[204:207], v[204:207]
    s_waitcnt vmcnt(16)
    s_waitcnt lgkmcnt(9)
    v_mfma_f32_16x16x32_bf16 v[128:131], a[80:83], a[208:211], v[128:131]
    buffer_load_dwordx4 v[64:67], v3, s[24:27], s46 offen offset:2048 sc1
    s_waitcnt lgkmcnt(8)
    v_mfma_f32_16x16x32_bf16 v[132:135], a[84:87], a[208:211], v[132:135]
    s_waitcnt lgkmcnt(7)
    v_mfma_f32_16x16x32_bf16 v[136:139], a[88:91], a[208:211], v[136:139]
    s_waitcnt lgkmcnt(6)
    v_mfma_f32_16x16x32_bf16 v[140:143], a[92:95], a[208:211], v[140:143]
    s_waitcnt lgkmcnt(5)
    v_mfma_f32_16x16x32_bf16 v[144:147], a[96:99], a[208:211], v[144:147]
    buffer_load_dwordx4 v[80:83], v3, s[24:27], s47 offen offset:0 sc1
    v_mfma_f32_16x16x32_bf16 v[148:151], a[80:83], a[212:215], v[148:151]
    ds_read_b128 v[228:231], v45 offset:0
    v_mfma_f32_16x16x32_bf16 v[152:155], a[84:87], a[212:215], v[152:155]
    ds_read_b128 v[232:235], v45 offset:1024
    v_mfma_f32_16x16x32_bf16 v[156:159], a[88:91], a[212:215], v[156:159]
    buffer_load_dwordx4 v[96:99], v3, s[24:27], s47 offen offset:2048 sc1
    ds_read_b128 v[236:239], v45 offset:2048
    v_mfma_f32_16x16x32_bf16 v[160:163], a[92:95], a[212:215], v[160:163]
    ds_read_b128 v[240:243], v45 offset:3072
    v_mfma_f32_16x16x32_bf16 v[164:167], a[96:99], a[212:215], v[164:167]
    ds_read_b128 v[244:247], v45 offset:4096
    v_mfma_f32_16x16x32_bf16 v[168:171], a[80:83], a[216:219], v[168:171]
    buffer_load_dwordx4 v[112:115], v3, s[24:27], s48 offen offset:0 sc1
    v_mfma_f32_16x16x32_bf16 v[172:175], a[84:87], a[216:219], v[172:175]
    v_mfma_f32_16x16x32_bf16 v[176:179], a[88:91], a[216:219], v[176:179]
    v_mfma_f32_16x16x32_bf16 v[180:183], a[92:95], a[216:219], v[180:183]
    v_mfma_f32_16x16x32_bf16 v[184:187], a[96:99], a[216:219], v[184:187]
    v_mfma_f32_16x16x32_bf16 v[188:191], a[80:83], a[220:223], v[188:191]
    v_mfma_f32_16x16x32_bf16 v[192:195], a[84:87], a[220:223], v[192:195]
    v_mfma_f32_16x16x32_bf16 v[196:199], a[88:91], a[220:223], v[196:199]
    v_mfma_f32_16x16x32_bf16 v[200:203], a[92:95], a[220:223], v[200:203]
    v_mfma_f32_16x16x32_bf16 v[204:207], a[96:99], a[220:223], v[204:207]
    s_cmp_eq_u32 s26, 0
    s_cbranch_scc1 L_slow_p3q
L_back_p3q:
    s_waitcnt lgkmcnt(0)
    s_barrier
    s_waitcnt vmcnt(19)
    v_mfma_f32_16x16x32_bf16 v[148:151], v[208:211], v[52:55], v[148:151]
    s_add_u32 s58, s28, 1
    s_and_b32 s58, s58, 3
    s_mul_i32 s58, s58, 15360
    s_add_u32 s58, s58, 0
    v_mfma_f32_16x16x32_bf16 v[152:155], v[212:215], v[52:55], v[152:155]
    v_add_u32 v37, s58, v2
    s_add_u32 s58, s28, 2
    s_and_b32 s58, s58, 3
    s_mul_i32 s58, s58, 15360
    s_add_u32 s58, s58, 5120
    v_mfma_f32_16x16x32_bf16 v[156:159], v[216:219], v[52:55], v[156:159]
    v_add_u32 v38, s58, v2
    s_add_u32 s58, s28, 3
    s_and_b32 s58, s58, 3
    s_mul_i32 s58, s58, 15360
    s_add_u32 s58, s58, 10240
    v_mfma_f32_16x16x32_bf16 v[160:163], v[220:223], v[52:55], v[160:163]
    v_mfma_f32_16x16x32_bf16 v[164:167], v[224:227], v[52:55], v[164:167]
    v_add_u32 v39, s58, v2
    s_mul_i32 s58, s28, 15360
    s_waitcnt vmcnt(18)
    v_mfma_f32_16x16x32_bf16 v[148:151], v[228:231], v[68:71], v[148:151]
    v_add_u32 v36, s58, v2
    v_mfma_f32_16x16x32_bf16 v[152:155], v[232:235], v[68:71], v[152:155]
    v_mfma_f32_16x16x32_bf16 v[156:159], v[236:239], v[68:71], v[156:159]
    v_accvgpr_read_b32 v24, a244
    v_mfma_f32_16x16x32_bf16 v[160:163], v[240:243], v[68:71], v[160:163]
    v_accvgpr_read_b32 v25, a245
    v_mfma_f32_16x16x32_bf16 v[164:167], v[244:247], v[68:71], v[164:167]
    s_waitcnt vmcnt(17)
    v_mfma_f32_16x16x32_bf16 v[148:151], a[100:103], v[84:87], v[148:151]
    v_accvgpr_read_b32 v26, a246
    v_mfma_f32_16x16x32_bf16 v[152:155], a[104:107], v[84:87], v[152:155]
    v_accvgpr_read_b32 v27, a247
    v_mfma_f32_16x16x32_bf16 v[156:159], a[108:111], v[84:87], v[156:159]
    v_accvgpr_read_b32 v28, a248
    v_mfma_f32_16x16x32_bf16 v[160:163], a[112:115], v[84:87], v[160:163]
    v_mfma_f32_16x16x32_bf16 v[164:167], a[116:119], v[84:87], v[164:167]
    v_accvgpr_read_b32 v29, a249
    s_waitcnt vmcnt(16)
    v_mfma_f32_16x16x32_bf16 v[148:151], a[120:123], v[100:103], v[148:151]
    v_accvgpr_read_b32 v30, a250
    v_mfma_f32_16x16x32_bf16 v[152:155], a[124:127], v[100:103], v[152:155]
    v_mfma_f32_16x16x32_bf16 v[156:159], a[128:131], v[100:103], v[156:159]
    v_accvgpr_read_b32 v31, a251
    v_mfma_f32_16x16x32_bf16 v[160:163], a[132:135], v[100:103], v[160:163]
    v_accvgpr_read_b32 v32, a252
    v_mfma_f32_16x16x32_bf16 v[164:167], a[136:139], v[100:103], v[164:167]
    s_waitcnt vmcnt(15)
    v_mfma_f32_16x16x32_bf16 v[148:151], a[140:143], v[116:119], v[148:151]
    v_accvgpr_read_b32 v33, a253
    v_mfma_f32_16x16x32_bf16 v[152:155], a[144:147], v[116:119], v[152:155]
    v_mfma_f32_16x16x32_bf16 v[156:159], a[148:151], v[116:119], v[156:159]
    v_mfma_f32_16x16x32_bf16 v[160:163], a[152:155], v[116:119], v[160:163]
    v_mfma_f32_16x16x32_bf16 v[164:167], a[156:159], v[116:119], v[164:167]
    s_waitcnt vmcnt(14)
    v_mfma_f32_16x16x32_bf16 v[168:171], v[208:211], v[56:59], v[168:171]
    v_mfma_f32_16x16x32_bf16 v[172:175], v[212:215], v[56:59], v[172:175]
    v_mfma_f32_16x16x32_bf16 v[176:179], v[216:219], v[56:59], v[176:179]
    v_mfma_f32_16x16x32_bf16 v[180:183], v[220:223], v[56:59], v[180:183]
    ds_write_b128 v37, v[148:151] offset:0
    v_mfma_f32_16x16x32_bf16 v[184:187], v[224:227], v[56:59], v[184:187]
    s_waitcnt vmcnt(13)
    v_mfma_f32_16x16x32_bf16 v[168:171], v[228:231], v[72:75], v[168:171]
    v_mfma_f32_16x16x32_bf16 v[172:175], v[232:235], v[72:75], v[172:175]
    v_mfma_f32_16x16x32_bf16 v[176:179], v[236:239], v[72:75], v[176:179]
    v_mfma_f32_16x16x32_bf16 v[180:183], v[240:243], v[72:75], v[180:183]
    ds_write_b128 v37, v[152:155] offset:1024
    v_mfma_f32_16x16x32_bf16 v[184:187], v[244:247], v[72:75], v[184:187]
    s_waitcnt vmcnt(12)
    v_mfma_f32_16x16x32_bf16 v[168:171], a[100:103], v[88:91], v[168:171]
    v_mfma_f32_16x16x32_bf16 v[172:175], a[104:107], v[88:91], v[172:175]
    v_mfma_f32_16x16x32_bf16 v[176:179], a[108:111], v[88:91], v[176:179]
    v_mfma_f32_16x16x32_bf16 v[180:183], a[112:115], v[88:91], v[180:183]
    ds_write_b128 v37, v[156:159] offset:2048
    v_mfma_f32_16x16x32_bf16 v[184:187], a[116:119], v[88:91], v[184:187]
    s_waitcnt vmcnt(11)
    v_mfma_f32_16x16x32_bf16 v[168:171], a[120:123], v[104:107], v[168:171]
    v_mfma_f32_16x16x32_bf16 v[172:175], a[124:127], v[104:107], v[172:175]
    v_mfma_f32_16x16x32_bf16 v[176:179], a[128:131], v[104:107], v[176:179]
    v_mfma_f32_16x16x32_bf16 v[180:183], a[132:135], v[104:107], v[180:183]
    ds_write_b128 v37, v[160:163] offset:3072
    v_mfma_f32_16x16x32_bf16 v[184:187], a[136:139], v[104:107], v[184:187]
    s_waitcnt vmcnt(10)
    v_mfma_f32_16x16x32_bf16 v[168:171], a[140:143], v[120:123], v[168:171]
    v_mfma_f32_16x16x32_bf16 v[172:175], a[144:147], v[120:123], v[172:175]
    v_mfma_f32_16x16x32_bf16 v[176:179], a[148:151], v[120:123], v[176:179]
    v_mfma_f32_16x16x32_bf16 v[180:183], a[152:155], v[120:123], v[180:183]
    ds_write_b128 v37, v[164:167] offset:4096
    v_mfma_f32_16x16x32_bf16 v[184:187], a[156:159], v[120:123], v[184:187]
    s_waitcnt vmcnt(9)
    v_mfma_f32_16x16x32_bf16 v[188:191], v[208:211], v[60:63], v[188:191]
    v_mfma_f32_16x16x32_bf16 v[192:195], v[212:215], v[60:63], v[192:195]
    v_mfma_f32_16x16x32_bf16 v[196:199], v[216:219], v[60:63], v[196:199]
    v_mfma_f32_16x16x32_bf16 v[200:203], v[220:223], v[60:63], v[200:203]
    ds_write_b128 v38, v[168:171] offset:0
    v_lshlrev_b32 v148, 16, v24
    v_mfma_f32_16x16x32_bf16 v[204:207], v[224:227], v[60:63], v[204:207]
    v_and_b32 v149, 0xffff0000, v24
    s_waitcnt vmcnt(8)
    v_mfma_f32_16x16x32_bf16 v[188:191], v[228:231], v[76:79], v[188:191]
    v_lshlrev_b32 v150, 16, v25
    v_mfma_f32_16x16x32_bf16 v[192:195], v[232:235], v[76:79], v[192:195]
    v_and_b32 v151, 0xffff0000, v25
    v_mfma_f32_16x16x32_bf16 v[196:199], v[236:239], v[76:79], v[196:199]
    v_lshlrev_b32 v152, 16, v26
    v_mfma_f32_16x16x32_bf16 v[200:203], v[240:243], v[76:79], v[200:203]
    ds_write_b128 v38, v[172:175] offset:1024
    v_and_b32 v153, 0xffff0000, v26
    v_mfma_f32_16x16x32_bf16 v[204:207], v[244:247], v[76:79], v[204:207]
    v_lshlrev_b32 v154, 16, v27
    s_waitcnt vmcnt(7)
    v_mfma_f32_16x16x32_bf16 v[188:191], a[100:103], v[92:95], v[188:191]
    v_and_b32 v155, 0xffff0000, v27
    v_mfma_f32_16x16x32_bf16 v[192:195], a[104:107], v[92:95], v[192:195]
    v_mfma_f32_16x16x32_bf16 v[196:199], a[108:111], v[92:95], v[196:199]
    v_lshlrev_b32 v156, 16, v28
    v_mfma_f32_16x16x32_bf16 v[200:203], a[112:115], v[92:95], v[200:203]
    ds_write_b128 v38, v[176:179] offset:2048
    v_and_b32 v157, 0xffff0000, v28
    v_mfma_f32_16x16x32_bf16 v[204:207], a[116:119], v[92:95], v[204:207]
    v_lshlrev_b32 v158, 16, v29
    s_waitcnt vmcnt(6)
    v_mfma_f32_16x16x32_bf16 v[188:191], a[120:123], v[108:111], v[188:191]
    v_and_b32 v159, 0xffff0000, v29
    v_mfma_f32_16x16x32_bf16 v[192:195], a[124:127], v[108:111], v[192:195]
    v_lshlrev_b32 v160, 16, v30
    v_mfma_f32_16x16x32_bf16 v[196:199], a[128:131], v[108:111], v[196:199]
    v_and_b32 v161, 0xffff0000, v30
    v_mfma_f32_16x16x32_bf16 v[200:203], a[132:135], v[108:111], v[200:203]
    ds_write_b128 v38, v[180:183] offset:3072
    v_lshlrev_b32 v162, 16, v31
    v_mfma_f32_16x16x32_bf16 v[204:207], a[136:139], v[108:111], v[204:207]
    v_and_b32 v163, 0xffff0000, v31
    s_waitcnt vmcnt(5)
    v_mfma_f32_16x16x32_bf16 v[188:191], a[140:143], v[124:127], v[188:191]
    v_lshlrev_b32 v164, 16, v32
    v_mfma_f32_16x16x32_bf16 v[192:195], a[144:147], v[124:127], v[192:195]
    v_mfma_f32_16x16x32_bf16 v[196:199], a[148:151], v[124:127], v[196:199]
    v_and_b32 v165, 0xffff0000, v32
    v_mfma_f32_16x16x32_bf16 v[200:203], a[152:155], v[124:127], v[200:203]
    ds_write_b128 v38, v[184:187] offset:4096
    v_lshlrev_b32 v166, 16, v33
    v_mfma_f32_16x16x32_bf16 v[204:207], a[156:159], v[124:127], v[204:207]
    v_and_b32 v167, 0xffff0000, v33
    s_waitcnt vmcnt(4)
    v_mfma_f32_16x16x32_bf16 v[128:131], v[208:211], v[48:51], v[128:131]
    v_mfma_f32_16x16x32_bf16 v[132:135], v[212:215], v[48:51], v[132:135]
    v_mfma_f32_16x16x32_bf16 v[136:139], v[216:219], v[48:51], v[136:139]
    ds_write_b128 v39, v[188:191] offset:0
    v_mfma_f32_16x16x32_bf16 v[140:143], v[220:223], v[48:51], v[140:143]
    v_mfma_f32_16x16x32_bf16 v[144:147], v[224:227], v[48:51], v[144:147]
    ds_write_b128 v39, v[192:195] offset:1024
    s_waitcnt vmcnt(3)
    v_mfma_f32_16x16x32_bf16 v[128:131], v[228:231], v[64:67], v[128:131]
    v_mfma_f32_16x16x32_bf16 v[132:135], v[232:235], v[64:67], v[132:135]
    ds_write_b128 v39, v[196:199] offset:2048
    v_mfma_f32_16x16x32_bf16 v[136:139], v[236:239], v[64:67], v[136:139]
    v_mfma_f32_16x16x32_bf16 v[140:143], v[240:243], v[64:67], v[140:143]
    ds_write_b128 v39, v[200:203] offset:3072
    v_mfma_f32_16x16x32_bf16 v[144:147], v[244:247], v[64:67], v[144:147]
    s_waitcnt vmcnt(2)
    v_mfma_f32_16x16x32_bf16 v[128:131], a[100:103], v[80:83], v[128:131]
    ds_write_b128 v39, v[204:207] offset:4096
    v_mfma_f32_16x16x32_bf16 v[132:135], a[104:107], v[80:83], v[132:135]
    v_mfma_f32_16x16x32_bf16 v[136:139], a[108:111], v[80:83], v[136:139]
    v_mfma_f32_16x16x32_bf16 v[140:143], a[112:115], v[80:83], v[140:143]
    v_mfma_f32_16x16x32_bf16 v[144:147], a[116:119], v[80:83], v[144:147]
    s_waitcnt vmcnt(1)
    v_mfma_f32_16x16x32_bf16 v[128:131], a[120:123], v[96:99], v[128:131]
    s_waitcnt lgkmcnt(0)
    s_barrier
    ds_read_b128 v[52:55], v36 offset:0
    ds_read_b128 v[68:71], v36 offset:1024
    v_mfma_f32_16x16x32_bf16 v[132:135], a[124:127], v[96:99], v[132:135]
    ds_read_b128 v[84:87], v36 offset:2048
    ds_read_b128 v[100:103], v36 offset:3072
    v_mfma_f32_16x16x32_bf16 v[136:139], a[128:131], v[96:99], v[136:139]
    ds_read_b128 v[116:119], v36 offset:4096
    ds_read_b128 v[56:59], v36 offset:5120
    v_mfma_f32_16x16x32_bf16 v[140:143], a[132:135], v[96:99], v[140:143]
    ds_read_b128 v[72:75], v36 offset:6144
    ds_read_b128 v[88:91], v36 offset:7168
    v_mfma_f32_16x16x32_bf16 v[144:147], a[136:139], v[96:99], v[144:147]
    ds_read_b128 v[104:107], v36 offset:8192
    ds_read_b128 v[120:123], v36 offset:9216
    s_waitcnt vmcnt(0)
    v_mfma_f32_16x16x32_bf16 v[128:131], a[140:143], v[112:115], v[128:131]
    ds_read_b128 v[60:63], v36 offset:10240
    ds_read_b128 v[76:79], v36 offset:11264
    v_mfma_f32_16x16x32_bf16 v[132:135], a[144:147], v[112:115], v[132:135]
    ds_read_b128 v[92:95], v36 offset:12288
    ds_read_b128 v[108:111], v36 offset:13312
    v_mfma_f32_16x16x32_bf16 v[136:139], a[148:151], v[112:115], v[136:139]
    ds_read_b128 v[124:127], v36 offset:14336
    v_mfma_f32_16x16x32_bf16 v[140:143], a[152:155], v[112:115], v[140:143]
    v_mfma_f32_16x16x32_bf16 v[144:147], a[156:159], v[112:115], v[144:147]
    s_waitcnt lgkmcnt(14)
    v_pk_add_f32 v[148:149], v[148:149], v[52:53]
    v_pk_add_f32 v[150:151], v[150:151], v[54:55]
    s_waitcnt lgkmcnt(13)
    v_pk_add_f32 v[152:153], v[152:153], v[68:69]
    v_pk_add_f32 v[154:155], v[154:155], v[70:71]
    s_waitcnt lgkmcnt(12)
    v_pk_add_f32 v[156:157], v[156:157], v[84:85]
    v_pk_add_f32 v[158:159], v[158:159], v[86:87]
    s_waitcnt lgkmcnt(11)
    v_pk_add_f32 v[160:161], v[160:161], v[100:101]
    v_pk_add_f32 v[162:163], v[162:163], v[102:103]
    s_waitcnt lgkmcnt(10)
    v_pk_add_f32 v[164:165], v[164:165], v[116:117]
    v_pk_add_f32 v[166:167], v[166:167], v[118:119]
    s_waitcnt lgkmcnt(9)
    v_pk_add_f32 v[148:149], v[148:149], v[56:57]
    v_pk_add_f32 v[150:151], v[150:151], v[58:59]
    s_waitcnt lgkmcnt(8)
    v_pk_add_f32 v[152:153], v[152:153], v[72:73]
    v_pk_add_f32 v[154:155], v[154:155], v[74:75]
    s_waitcnt lgkmcnt(7)
    v_pk_add_f32 v[156:157], v[156:157], v[88:89]
    v_pk_add_f32 v[158:159], v[158:159], v[90:91]
    s_waitcnt lgkmcnt(6)
    v_pk_add_f32 v[160:161], v[160:161], v[104:105]
    v_pk_add_f32 v[162:163], v[162:163], v[106:107]
    s_waitcnt lgkmcnt(5)
    v_pk_add_f32 v[164:165], v[164:165], v[120:121]
    v_pk_add_f32 v[166:167], v[166:167], v[122:123]
    s_waitcnt lgkmcnt(4)
    v_pk_add_f32 v[148:149], v[148:149], v[60:61]
    v_pk_add_f32 v[150:151], v[150:151], v[62:63]
    s_waitcnt lgkmcnt(3)
    v_pk_add_f32 v[152:153], v[152:153], v[76:77]
    v_pk_add_f32 v[154:155], v[154:155], v[78:79]
    s_waitcnt lgkmcnt(2)
    v_pk_add_f32 v[156:157], v[156:157], v[92:93]
    v_pk_add_f32 v[158:159], v[158:159], v[94:95]
    s_waitcnt lgkmcnt(1)
    v_pk_add_f32 v[160:161], v[160:161], v[108:109]
    v_pk_add_f32 v[162:163], v[162:163], v[110:111]
    s_waitcnt lgkmcnt(0)
    v_pk_add_f32 v[164:165], v[164:165], v[124:125]
    v_pk_add_f32 v[166:167], v[166:167], v[126:127]
    v_pk_add_f32 v[148:149], v[148:149], v[128:129]
    v_pk_add_f32 v[150:151], v[150:151], v[130:131]
    v_pk_add_f32 v[152:153], v[152:153], v[132:133]
    v_pk_add_f32 v[154:155], v[154:155], v[134:135]
    v_pk_add_f32 v[156:157], v[156:157], v[136:137]
    v_pk_add_f32 v[158:159], v[158:159], v[138:139]
    v_pk_add_f32 v[160:161], v[160:161], v[140:141]
    v_pk_add_f32 v[162:163], v[162:163], v[142:143]
    v_pk_add_f32 v[164:165], v[164:165], v[144:145]
    v_pk_add_f32 v[166:167], v[166:167], v[146:147]
    v_cvt_pk_bf16_f32 v24, v148, v149
    v_cvt_pk_bf16_f32 v25, v150, v151
    buffer_store_dwordx2 v[24:25], v9, s[20:23], s76 offen offset:0
    v_cvt_pk_bf16_f32 v26, v152, v153
    v_cvt_pk_bf16_f32 v27, v154, v155
    buffer_store_dwordx2 v[26:27], v9, s[20:23], s76 offen offset:32
    v_cvt_pk_bf16_f32 v28, v156, v157
    v_cvt_pk_bf16_f32 v29, v158, v159
    buffer_store_dwordx2 v[28:29], v9, s[20:23], s76 offen offset:64
    v_cvt_pk_bf16_f32 v30, v160, v161
    v_cvt_pk_bf16_f32 v31, v162, v163
    buffer_store_dwordx2 v[30:31], v9, s[20:23], s76 offen offset:96
    v_cvt_pk_bf16_f32 v32, v164, v165
    v_cvt_pk_bf16_f32 v33, v166, v167
    buffer_store_dwordx2 v[32:33], v9, s[20:23], s76 offen offset:128
    s_endpgm
L_slow_kg:
    s_mov_b32 s74, 0x8000
L_spin_kg:
    s_sleep 6
    buffer_load_dwordx2 v[84:85], v86, s[12:15], s101 offen sc1
    s_waitcnt vmcnt(0)
    s_sub_u32 s74, s74, 1
    s_cbranch_scc1 L_out_kg
    v_and_b32 v84, v84, v85
    v_cmp_ne_u32 vcc, 1, v84
    s_nop 1
    s_and_b32 s58, vcc_lo, 0xffffffff
    s_and_b32 s59, vcc_hi, 0xffffffff
    s_or_b32 s58, s58, s59
    s_cbranch_scc1 L_spin_kg
L_out_kg:
    s_branch L_back_kg
L_slow_ig:
    s_mov_b32 s74, 0x8000
L_spin_ig:
    s_sleep 6
    buffer_load_dword v84, v86, s[16:19], 0 offen sc1
    s_waitcnt vmcnt(0)
    s_sub_u32 s74, s74, 1
    s_cbranch_scc1 L_out_ig
    v_cmp_ne_u32 vcc, 1, v84
    s_nop 1
    s_and_b32 s58, vcc_lo, 0xffff
    s_cbranch_scc1 L_spin_ig
L_out_ig:
    s_branch L_back_ig
L_slow_cs0g:
    s_mov_b32 s74, 0x8000
L_spin_cs0g:
    s_sleep 6
    buffer_load_dword v75, v34, s[12:15], 0 offen offset:0 sc1
    s_waitcnt vmcnt(0)
    s_sub_u32 s74, s74, 1
    s_cbranch_scc1 L_out_cs0g
    v_cmp_ne_u32 vcc, 1, v75
    s_nop 1
    s_and_b32 s58, vcc_lo, 0x1f03ff
    s_cbranch_scc1 L_spin_cs0g
L_out_cs0g:
    s_branch L_back_cs0g
L_slow_cs1g:
    s_mov_b32 s74, 0x8000
L_spin_cs1g:
    s_sleep 6
    buffer_load_dword v75, v34, s[12:15], 0 offen offset:128 sc1
    s_waitcnt vmcnt(0)
    s_sub_u32 s74, s74, 1
    s_cbranch_scc1 L_out_cs1g
    v_cmp_ne_u32 vcc, 1, v75
    s_nop 1
    s_and_b32 s58, vcc_lo, 0x3ff
    s_cbranch_scc1 L_spin_cs1g
L_out_cs1g:
    s_branch L_back_cs1g
L_slow_cs2g:
    s_mov_b32 s74, 0x8000
L_spin_cs2g:
    s_sleep 6
    buffer_load_dword v75, v34, s[12:15], 0 offen offset:256 sc1
    s_waitcnt vmcnt(0)
    s_sub_u32 s74, s74, 1
    s_cbranch_scc1 L_out_cs2g
    v_cmp_ne_u32 vcc, 1, v75
    s_nop 1
    s_and_b32 s58, vcc_lo, 0x3ff
    s_cbranch_scc1 L_spin_cs2g
L_out_cs2g:
    s_branch L_back_cs2g
L_slow_p0g:
    s_mov_b32 s74, 0x8000
L_spin_p0g:
    s_sleep 6
    buffer_load_dword v7, v6, s[12:15], s57 offen offset:0 sc1
    s_waitcnt vmcnt(0)
    s_sub_u32 s74, s74, 1
    s_cbranch_scc1 L_out_p0g
    v_cmp_ne_u32 vcc, 1, v7
    s_nop 1
    s_and_b32 s58, vcc_lo, 0xff
    s_cbranch_scc1 L_spin_p0g
L_out_p0g:
    s_branch L_back_p0g
L_slow_p1g:
    s_mov_b32 s74, 0x8000
L_spin_p1g:
    s_sleep 3
    buffer_load_dword v8, v6, s[12:15], s57 offen offset:128 sc1
    buffer_load_dword v7, v6, s[12:15], s57 offen offset:256 sc1
    s_waitcnt vmcnt(0)
    s_sub_u32 s74, s74, 1
    s_cbranch_scc1 L_out_p1g
    v_cmp_ne_u32 vcc, 1, v8
    s_nop 1
    s_and_b32 s58, vcc_lo, 0xff
    s_cbranch_scc1 L_spin_p1g
L_out_p1g:
    s_add_u32 s46, s44, 32768
    buffer_load_dwordx4 v[64:67], v29, s[12:15], s46 offen offset:0 sc1
    buffer_load_dwordx4 v[68:71], v30, s[12:15], s46 offen offset:0 sc1
    buffer_load_dwordx4 v[72:75], v31, s[12:15], s46 offen offset:0 sc1
    buffer_load_dwordx4 v[76:79], v32, s[12:15], s46 offen offset:0 sc1
    buffer_load_dwordx4 v[80:83], v29, s[12:15], s46 offen offset:2048 sc1
    buffer_load_dwordx4 v[84:87], v30, s[12:15], s46 offen offset:2048 sc1
    buffer_load_dwordx4 v[88:91], v31, s[12:15], s46 offen offset:2048 sc1
    buffer_load_dwordx4 v[92:95], v32, s[12:15], s46 offen offset:2048 sc1
    s_add_u32 s46, s46, 4096
    buffer_load_dwordx4 v[96:99], v29, s[12:15], s46 offen offset:0 sc1
    buffer_load_dwordx4 v[100:103], v30, s[12:15], s46 offen offset:0 sc1
    buffer_load_dwordx4 v[104:107], v31, s[12:15], s46 offen offset:0 sc1
    buffer_load_dwordx4 v[108:111], v32, s[12:15], s46 offen offset:0 sc1
    buffer_load_dwordx4 v[112:115], v29, s[12:15], s46 offen offset:2048 sc1
    buffer_load_dwordx4 v[116:119], v30, s[12:15], s46 offen offset:2048 sc1
    buffer_load_dwordx4 v[120:123], v31, s[12:15], s46 offen offset:2048 sc1
    buffer_load_dwordx4 v[124:127], v32, s[12:15], s46 offen offset:2048 sc1
    s_branch L_back_p1g
L_slow_p2g:
    s_mov_b32 s74, 0x8000
L_spin_p2g:
    s_sleep 3
    buffer_load_dword v7, v6, s[12:15], s57 offen offset:256 sc1
    buffer_load_dword v8, v6, s[12:15], s57 offen offset:384 sc1
    s_waitcnt vmcnt(0)
    s_sub_u32 s74, s74, 1
    s_cbranch_scc1 L_out_p2g
    v_cmp_ne_u32 vcc, 1, v7
    s_nop 1
    s_and_b32 s58, vcc_lo, 0xff
    s_cbranch_scc1 L_spin_p2g
L_out_p2g:
    s_add_u32 s46, s44, 65536
    buffer_load_dwordx4 v[192:195], v29, s[12:15], s46 offen offset:0 sc1
    buffer_load_dwordx4 v[196:199], v30, s[12:15], s46 offen offset:0 sc1
    buffer_load_dwordx4 v[200:203], v31, s[12:15], s46 offen offset:0 sc1
    buffer_load_dwordx4 v[204:207], v32, s[12:15], s46 offen offset:0 sc1
    buffer_load_dwordx4 v[208:211], v29, s[12:15], s46 offen offset:2048 sc1
    buffer_load_dwordx4 v[212:215], v30, s[12:15], s46 offen offset:2048 sc1
    buffer_load_dwordx4 v[216:219], v31, s[12:15], s46 offen offset:2048 sc1
    buffer_load_dwordx4 v[220:223], v32, s[12:15], s46 offen offset:2048 sc1
    s_add_u32 s46, s46, 4096
    buffer_load_dwordx4 v[224:227], v29, s[12:15], s46 offen offset:0 sc1
    buffer_load_dwordx4 v[228:231], v30, s[12:15], s46 offen offset:0 sc1
    buffer_load_dwordx4 v[232:235], v31, s[12:15], s46 offen offset:0 sc1
    buffer_load_dwordx4 v[236:239], v32, s[12:15], s46 offen offset:0 sc1
    buffer_load_dwordx4 v[240:243], v29, s[12:15], s46 offen offset:2048 sc1
    buffer_load_dwordx4 v[244:247], v30, s[12:15], s46 offen offset:2048 sc1
    buffer_load_dwordx4 v[248:251], v31, s[12:15], s46 offen offset:2048 sc1
    buffer_load_dwordx4 v[252:255], v32, s[12:15], s46 offen offset:2048 sc1
    s_branch L_back_p2g
L_slow_p3g:
    s_mov_b32 s74, 0x8000
L_spin_p3g:
    s_sleep 3
    buffer_load_dword v8, v6, s[12:15], s57 offen offset:384 sc1
    s_waitcnt vmcnt(0)
    s_sub_u32 s74, s74, 1
    s_cbranch_scc1 L_out_p3g
    v_cmp_ne_u32 vcc, 1, v8
    s_nop 1
    s_and_b32 s58, vcc_lo, 0xff
    s_cbranch_scc1 L_spin_p3g
L_out_p3g:
    s_mov_b32 s46, s45
    s_add_u32 s47, s45, 4096
    s_add_u32 s48, s45, 8192
    buffer_load_dwordx4 v[52:55], v30, s[12:15], s46 offen offset:0 sc1
    buffer_load_dwordx4 v[68:71], v30, s[12:15], s46 offen offset:2048 sc1
    buffer_load_dwordx4 v[84:87], v30, s[12:15], s47 offen offset:0 sc1
    buffer_load_dwordx4 v[100:103], v30, s[12:15], s47 offen offset:2048 sc1
    buffer_load_dwordx4 v[116:119], v30, s[12:15], s48 offen offset:0 sc1
    buffer_load_dwordx4 v[56:59], v31, s[12:15], s46 offen offset:0 sc1
    buffer_load_dwordx4 v[72:75], v31, s[12:15], s46 offen offset:2048 sc1
    buffer_load_dwordx4 v[88:91], v31, s[12:15], s47 offen offset:0 sc1
    buffer_load_dwordx4 v[104:107], v31, s[12:15], s47 offen offset:2048 sc1
    buffer_load_dwordx4 v[120:123], v31, s[12:15], s48 offen offset:0 sc1
    buffer_load_dwordx4 v[60:63], v32, s[12:15], s46 offen offset:0 sc1
    buffer_load_dwordx4 v[76:79], v32, s[12:15], s46 offen offset:2048 sc1
    buffer_load_dwordx4 v[92:95], v32, s[12:15], s47 offen offset:0 sc1
    buffer_load_dwordx4 v[108:111], v32, s[12:15], s47 offen offset:2048 sc1
    buffer_load_dwordx4 v[124:127], v32, s[12:15], s48 offen offset:0 sc1
    buffer_load_dwordx4 v[48:51], v29, s[12:15], s46 offen offset:0 sc1
    buffer_load_dwordx4 v[64:67], v29, s[12:15], s46 offen offset:2048 sc1
    buffer_load_dwordx4 v[80:83], v29, s[12:15], s47 offen offset:0 sc1
    buffer_load_dwordx4 v[96:99], v29, s[12:15], s47 offen offset:2048 sc1
    buffer_load_dwordx4 v[112:115], v29, s[12:15], s48 offen offset:0 sc1
    s_branch L_back_p3g
L_slow_iq:
    s_mov_b32 s74, 0x8000
L_spin_iq:
    s_sleep 6
    buffer_load_dword v84, v86, s[16:19], 0 offen sc1
    s_waitcnt vmcnt(0)
    s_sub_u32 s74, s74, 1
    s_cbranch_scc1 L_out_iq
    v_cmp_ne_u32 vcc, 1, v84
    s_nop 1
    s_and_b32 s58, vcc_lo, 0xffff
    s_cbranch_scc1 L_spin_iq
L_out_iq:
    s_branch L_back_iq
L_slow_cs0q:
    s_mov_b32 s74, 0x8000
L_spin_cs0q:
    s_sleep 6
    buffer_load_dword v120, v118, s[12:15], 0 offen offset:0 sc1
    s_waitcnt vmcnt(0)
    s_sub_u32 s74, s74, 1
    s_cbranch_scc1 L_out_cs0q
    v_cmp_ne_u32 vcc, 1, v120
    s_nop 1
    s_and_b32 s58, vcc_lo, 0x1f001f
    s_cbranch_scc1 L_spin_cs0q
L_out_cs0q:
    s_branch L_back_cs0q
L_slow_kq:
    s_mov_b32 s74, 0x8000
L_spin_kq:
    s_sleep 6
    buffer_load_dwordx2 v[84:85], v86, s[12:15], s101 offen sc1
    s_waitcnt vmcnt(0)
    s_sub_u32 s74, s74, 1
    s_cbranch_scc1 L_out_kq
    v_and_b32 v84, v84, v85
    v_cmp_ne_u32 vcc, 1, v84
    s_nop 1
    s_and_b32 s58, vcc_lo, 0xffffffff
    s_and_b32 s59, vcc_hi, 0xffffffff
    s_or_b32 s58, s58, s59
    s_cbranch_scc1 L_spin_kq
L_out_kq:
    s_branch L_back_kq
L_slow_cs1q:
    s_mov_b32 s74, 0x8000
L_spin_cs1q:
    s_sleep 6
    buffer_load_dword v72, v70, s[12:15], 0 offen offset:128 sc1
    s_waitcnt vmcnt(0)
    s_sub_u32 s74, s74, 1
    s_cbranch_scc1 L_out_cs1q
    v_cmp_ne_u32 vcc, 1, v72
    s_nop 1
    s_and_b32 s58, vcc_lo, 0x1f
    s_cbranch_scc1 L_spin_cs1q
L_out_cs1q:
    s_branch L_back_cs1q
L_slow_p0q:
    s_mov_b32 s74, 0x8000
L_spin_p0q:
    s_sleep 6
    buffer_load_dword v7, v6, s[12:15], s57 offen offset:0 sc1
    s_waitcnt vmcnt(0)
    s_sub_u32 s74, s74, 1
    s_cbranch_scc1 L_out_p0q
    v_cmp_ne_u32 vcc, 1, v7
    s_nop 1
    s_and_b32 s58, vcc_lo, 0xff
    s_cbranch_scc1 L_spin_p0q
L_out_p0q:
    s_branch L_back_p0q
L_slow_kv:
    s_mov_b32 s74, 0x8000
L_spin_kv:
    s_sleep 6
    buffer_load_dword v127, v126, s[12:15], s79 offen sc1
    s_waitcnt vmcnt(0)
    s_sub_u32 s74, s74, 1
    s_cbranch_scc1 L_out_kv
    v_cmp_ne_u32 vcc, 1, v127
    s_nop 1
    s_and_b32 s58, vcc_lo, 0xffff
    s_cbranch_scc1 L_spin_kv
L_out_kv:
    s_branch L_back_kv
L_slow_p1q:
    s_mov_b32 s74, 0x8000
L_spin_p1q:
    s_sleep 3
    buffer_load_dword v8, v6, s[12:15], s57 offen offset:128 sc1
    buffer_load_dword v7, v6, s[12:15], s57 offen offset:256 sc1
    s_waitcnt vmcnt(0)
    s_sub_u32 s74, s74, 1
    s_cbranch_scc1 L_out_p1q
    v_cmp_ne_u32 vcc, 1, v8
    s_nop 1
    s_and_b32 s58, vcc_lo, 0xff
    s_cbranch_scc1 L_spin_p1q
L_out_p1q:
    s_add_u32 s46, s44, 32768
    buffer_load_dwordx4 v[64:67], v3, s[12:15], s46 offen offset:0 sc1
    buffer_load_dwordx4 v[68:71], v4, s[12:15], s46 offen offset:0 sc1
    buffer_load_dwordx4 v[72:75], v5, s[12:15], s46 offen offset:0 sc1
    buffer_load_dwordx4 v[76:79], v20, s[12:15], s46 offen offset:0 sc1
    buffer_load_dwordx4 v[80:83], v3, s[12:15], s46 offen offset:2048 sc1
    buffer_load_dwordx4 v[84:87], v4, s[12:15], s46 offen offset:2048 sc1
    buffer_load_dwordx4 v[88:91], v5, s[12:15], s46 offen offset:2048 sc1
    buffer_load_dwordx4 v[92:95], v20, s[12:15], s46 offen offset:2048 sc1
    s_add_u32 s46, s46, 4096
    buffer_load_dwordx4 v[96:99], v3, s[12:15], s46 offen offset:0 sc1
    buffer_load_dwordx4 v[100:103], v4, s[12:15], s46 offen offset:0 sc1
    buffer_load_dwordx4 v[104:107], v5, s[12:15], s46 offen offset:0 sc1
    buffer_load_dwordx4 v[108:111], v20, s[12:15], s46 offen offset:0 sc1
    buffer_load_dwordx4 v[112:115], v3, s[12:15], s46 offen offset:2048 sc1
    buffer_load_dwordx4 v[116:119], v4, s[12:15], s46 offen offset:2048 sc1
    buffer_load_dwordx4 v[120:123], v5, s[12:15], s46 offen offset:2048 sc1
    buffer_load_dwordx4 v[124:127], v20, s[12:15], s46 offen offset:2048 sc1
    s_branch L_back_p1q
L_slow_p2q:
    s_mov_b32 s74, 0x8000
L_spin_p2q:
    s_sleep 3
    buffer_load_dword v7, v6, s[12:15], s57 offen offset:256 sc1
    buffer_load_dword v8, v6, s[12:15], s57 offen offset:384 sc1
    s_waitcnt vmcnt(0)
    s_sub_u32 s74, s74, 1
    s_cbranch_scc1 L_out_p2q
    v_cmp_ne_u32 vcc, 1, v7
    s_nop 1
    s_and_b32 s58, vcc_lo, 0xff
    s_cbranch_scc1 L_spin_p2q
L_out_p2q:
    s_add_u32 s46, s44, 65536
    buffer_load_dwordx4 a[160:163], v3, s[12:15], s46 offen offset:0 sc1
    buffer_load_dwordx4 a[164:167], v4, s[12:15], s46 offen offset:0 sc1
    buffer_load_dwordx4 a[168:171], v5, s[12:15], s46 offen offset:0 sc1
    buffer_load_dwordx4 a[172:175], v20, s[12:15], s46 offen offset:0 sc1
    buffer_load_dwordx4 a[176:179], v3, s[12:15], s46 offen offset:2048 sc1
    buffer_load_dwordx4 a[180:183], v4, s[12:15], s46 offen offset:2048 sc1
    buffer_load_dwordx4 a[184:187], v5, s[12:15], s46 offen offset:2048 sc1
    buffer_load_dwordx4 a[188:191], v20, s[12:15], s46 offen offset:2048 sc1
    s_add_u32 s46, s46, 4096
    buffer_load_dwordx4 a[192:195], v3, s[12:15], s46 offen offset:0 sc1
    buffer_load_dwordx4 a[196:199], v4, s[12:15], s46 offen offset:0 sc1
    buffer_load_dwordx4 a[200:203], v5, s[12:15], s46 offen offset:0 sc1
    buffer_load_dwordx4 a[204:207], v20, s[12:15], s46 offen offset:0 sc1
    buffer_load_dwordx4 a[208:211], v3, s[12:15], s46 offen offset:2048 sc1
    buffer_load_dwordx4 a[212:215], v4, s[12:15], s46 offen offset:2048 sc1
    buffer_load_dwordx4 a[216:219], v5, s[12:15], s46 offen offset:2048 sc1
    buffer_load_dwordx4 a[220:223], v20, s[12:15], s46 offen offset:2048 sc1
    s_branch L_back_p2q
L_slow_p3q:
    s_mov_b32 s74, 0x8000
L_spin_p3q:
    s_sleep 3
    buffer_load_dword v8, v6, s[12:15], s57 offen offset:384 sc1
    s_waitcnt vmcnt(0)
    s_sub_u32 s74, s74, 1
    s_cbranch_scc1 L_out_p3q
    v_cmp_ne_u32 vcc, 1, v8
    s_nop 1
    s_and_b32 s58, vcc_lo, 0xff
    s_cbranch_scc1 L_spin_p3q
L_out_p3q:
    s_mov_b32 s46, s45
    s_add_u32 s47, s45, 4096
    s_add_u32 s48, s45, 8192
    buffer_load_dwordx4 v[52:55], v4, s[12:15], s46 offen offset:0 sc1
    buffer_load_dwordx4 v[68:71], v4, s[12:15], s46 offen offset:2048 sc1
    buffer_load_dwordx4 v[84:87], v4, s[12:15], s47 offen offset:0 sc1
    buffer_load_dwordx4 v[100:103], v4, s[12:15], s47 offen offset:2048 sc1
    buffer_load_dwordx4 v[116:119], v4, s[12:15], s48 offen offset:0 sc1
    buffer_load_dwordx4 v[56:59], v5, s[12:15], s46 offen offset:0 sc1
    buffer_load_dwordx4 v[72:75], v5, s[12:15], s46 offen offset:2048 sc1
    buffer_load_dwordx4 v[88:91], v5, s[12:15], s47 offen offset:0 sc1
    buffer_load_dwordx4 v[104:107], v5, s[12:15], s47 offen offset:2048 sc1
    buffer_load_dwordx4 v[120:123], v5, s[12:15], s48 offen offset:0 sc1
    buffer_load_dwordx4 v[60:63], v20, s[12:15], s46 offen offset:0 sc1
    buffer_load_dwordx4 v[76:79], v20, s[12:15], s46 offen offset:2048 sc1
    buffer_load_dwordx4 v[92:95], v20, s[12:15], s47 offen offset:0 sc1
    buffer_load_dwordx4 v[108:111], v20, s[12:15], s47 offen offset:2048 sc1
    buffer_load_dwordx4 v[124:127], v20, s[12:15], s48 offen offset:0 sc1
    buffer_load_dwordx4 v[48:51], v3, s[12:15], s46 offen offset:0 sc1
    buffer_load_dwordx4 v[64:67], v3, s[12:15], s46 offen offset:2048 sc1
    buffer_load_dwordx4 v[80:83], v3, s[12:15], s47 offen offset:0 sc1
    buffer_load_dwordx4 v[96:99], v3, s[12:15], s47 offen offset:2048 sc1
    buffer_load_dwordx4 v[112:115], v3, s[12:15], s48 offen offset:0 sc1
    s_branch L_back_p3q
L_end:
    s_endpgm
.section .rodata,"a"
.p2align 6
.amdhsa_kernel parallel_sum__linear_kernel_hedgehog__glu_gated_glu__prompt_kernel
  .amdhsa_next_free_vgpr 512
  .amdhsa_next_free_sgpr 102
  .amdhsa_accum_offset 256
  .amdhsa_group_segment_fixed_size 0
  .amdhsa_kernarg_size 88
  .amdhsa_user_sgpr_count 2
  .amdhsa_user_sgpr_kernarg_segment_ptr 1
  .amdhsa_system_sgpr_workgroup_id_x 1
.end_amdhsa_kernel
```
